```python
import torch

def _softmax(x, axis=-1):
    return torch.softmax(x, dim=axis)

def _gelu(x):
    return torch.nn.functional.gelu(x, approximate='tanh')

def _silu(x):
    return torch.nn.functional.silu(x)

def _sigmoid(x):
    return torch.sigmoid(x)

def _layernorm(x, axis=-1, eps=1e-05):
    m = x.mean(dim=axis, keepdim=True)
    v = x.var(dim=axis, keepdim=True, unbiased=False)
    return (x - m) / torch.sqrt(v + eps)

def _scatter_add(tgt, idx, src, axis=0):
    return tgt.clone().index_add_(axis, idx, src)

def _segment_sum(src, seg, n):
    out = torch.zeros((n,) + src.shape[1:], dtype=src.dtype)
    return out.index_add_(0, seg, src)

def _pad(x, pw):
    flat = tuple((v for pair in reversed(pw) for v in pair))
    return torch.nn.functional.pad(x, flat)
kernel_name = 'gated_mix__memory_aug_recurrent_mem_tr__moe_arch_mod__prompt'

def setup_inputs():

    _w = lambda a: (lambda t: t.to(torch.bfloat16) if t.is_floating_point() else t)(torch.as_tensor(a))

    def _A_setup():
        B, S, Dm = (1, 2048, 576)
        H, Dh = (32, 128)
        M, seg = (8, 32)
        seg = min(seg, S)
        S = S // seg * seg
        return {'x': _w((lambda *s: torch.randn(*s, dtype=torch.bfloat16) * 0.05)(B, S, Dm)), 'mem0': _w((lambda *s: torch.randn(*s, dtype=torch.bfloat16) * 0.8)(B, M, Dm)), 'Wq': _w((lambda *s: torch.randn(*s, dtype=torch.bfloat16) * 3.2)(Dm, H, Dh) * Dm ** (-0.5)), 'Wk': _w((lambda *s: torch.randn(*s, dtype=torch.bfloat16) * 3.2)(Dm, H, Dh) * Dm ** (-0.5)), 'Wv': _w((lambda *s: torch.randn(*s, dtype=torch.bfloat16) * 0.8)(Dm, H, Dh) * Dm ** (-0.5)), 'Wo': _w((lambda *s: torch.randn(*s, dtype=torch.bfloat16) * 0.8)(H, Dh, Dm) * (H * Dh) ** (-0.5)), 'seg_len': seg}
    _A_in = _A_setup()

    def _B_setup():
        B, S, D, F, C = (1, 2048, 576, 4608, 8)
        return {'x': _w((lambda *s: torch.randn(*s, dtype=torch.bfloat16) * 0.05)(B, S, D)), 'w_r': _w((lambda *s: torch.randn(*s, dtype=torch.bfloat16) * 3.2)(D)), 'w_gate': _w((lambda *s: torch.randn(*s, dtype=torch.bfloat16) * 0.1)(D, F)), 'w_up': _w((lambda *s: torch.randn(*s, dtype=torch.bfloat16) * 0.1)(D, F)), 'w_down': _w((lambda *s: torch.randn(*s, dtype=torch.bfloat16) * 0.1)(F, D))}
    _B_in = _B_setup()
    return {'A_x': _A_in['x'], 'A_mem0': _A_in['mem0'], 'A_Wq': _A_in['Wq'], 'A_Wk': _A_in['Wk'], 'A_Wv': _A_in['Wv'], 'A_Wo': _A_in['Wo'], 'A_seg_len': _A_in['seg_len'], 'B_x': _B_in['x'], 'B_w_r': _B_in['w_r'], 'B_w_gate': _B_in['w_gate'], 'B_w_up': _B_in['w_up'], 'B_w_down': _B_in['w_down'], 'gate_w': _w((lambda *s: torch.randn(*s, dtype=torch.bfloat16) * 0.05)(576) * 16.0)}

def reference(A_x, A_mem0, A_Wq, A_Wk, A_Wv, A_Wo, A_seg_len, B_x, B_w_r, B_w_gate, B_w_up, B_w_down, gate_w):

    def _A_ref(x, mem0, Wq, Wk, Wv, Wo, seg_len):
        B, S, Dm = x.shape
        H, Dh = (Wq.shape[1], Wq.shape[2])
        M = mem0.shape[1]
        scale = Dh ** (-0.5)
        n_seg = S // seg_len
        L = M + seg_len
        idx = torch.arange(L)
        mask = (idx[:, None] < M) | (idx[:, None] >= idx[None, :])
        mem = mem0
        outs = []
        for s in range(n_seg):
            xs = x[:, s * seg_len:(s + 1) * seg_len, :].clone()
            h = torch.concatenate([mem, xs], axis=1)
            q = torch.einsum('btd,dhe->bhte', h, Wq)
            k = torch.einsum('btd,dhe->bhte', h, Wk)
            v = torch.einsum('btd,dhe->bhte', h, Wv)
            scores = torch.einsum('bhqe,bhke->bhqk', q, k) * scale
            scores = torch.where(mask[None, None], scores, -1000000000.0)
            p = _softmax(scores, axis=-1)
            o = torch.einsum('bhqk,bhke->bhqe', p, v)
            o = torch.einsum('bhte,hed->btd', o, Wo)
            mem = o[:, :M, :].clone()
            outs.append(o[:, M:, :])
        return torch.concatenate(outs, axis=1)

    def _B_ref(x, w_r, w_gate, w_up, w_down):
        B, S, D = x.shape
        C = 8
        r = x @ w_r
        idx = torch.argsort(-r, axis=-1)[:, :C]
        idx_e = (lambda x, n, axis: torch.repeat_interleave(x, n, dim=axis))(idx.reshape(B, C, 1), D, axis=2)
        x_sel = (lambda x, i, axis: torch.take_along_dim(x, i, dim=axis))(x, idx_e, axis=1)
        g = _silu(x_sel @ w_gate)
        u = x_sel @ w_up
        y = g * u @ w_down
        r_sel = _sigmoid((lambda x, i, axis: torch.take_along_dim(x, i, dim=axis))(r, idx, axis=1))
        y = y * r_sel.reshape(B, C, 1)
        b_off = (torch.arange(B) * S).reshape(B, 1)
        flat_idx = (idx + b_off).reshape(B * C)
        zero = (x * 0.0).reshape(B * S, D)
        upd = _scatter_add(zero, flat_idx, y.reshape(B * C, D), axis=0)
        return x + upd.reshape(B, S, D)
    x = A_x
    g = _sigmoid((x * gate_w).sum(-1, keepdims=True))
    a = _A_ref(x, A_mem0, A_Wq, A_Wk, A_Wv, A_Wo, A_seg_len)
    b = _B_ref(x, B_w_r, B_w_gate, B_w_up, B_w_down)
    return g * a + (1 - g) * b
```

```asm
; @launch kernel=gated_mix__memory_aug_recurrent_mem_tr__moe_arch_mod__prompt_kernel grid=(256,1,1) block=(256,1,1) lds=163840
.amdgcn_target "amdgcn-amd-amdhsa--gfx950"
.text
.globl gated_mix__memory_aug_recurrent_mem_tr__moe_arch_mod__prompt_kernel
.p2align 8
.type gated_mix__memory_aug_recurrent_mem_tr__moe_arch_mod__prompt_kernel,@function
gated_mix__memory_aug_recurrent_mem_tr__moe_arch_mod__prompt_kernel:
    s_cmp_ge_u32 s2, 256
    s_cbranch_scc1 L_exit
    s_load_dwordx2 s[4:5], s[0:1], 112
    s_getreg_b32 s6, hwreg(HW_REG_XCC_ID)
    s_and_b32 s6, s6, 15
    s_waitcnt lgkmcnt(0)
    s_mov_b32 s32, s4
    s_and_b32 s33, s5, 0xffff
    s_mov_b32 s34, 0x100
    s_mov_b32 s35, 0x20000
    v_cmp_eq_u32 vcc, 0, v0
    s_nop 0
    s_and_saveexec_b64 s[70:71], vcc
    s_cbranch_execz T_join
    s_cmp_lg_u32 s6, 3
    s_cbranch_scc1 T_work
    v_mov_b32 v2, 1
    buffer_atomic_add v2, off, s[32:35], 0 offset:0 sc0
    s_waitcnt vmcnt(0)
    v_readfirstlane_b32 s7, v2
    s_nop 0
    s_cmp_lt_u32 s7, 32
    s_cbranch_scc1 T_pub
T_work:
    v_mov_b32 v2, 1
    buffer_atomic_add v2, off, s[32:35], 0 offset:128 sc0
    s_waitcnt vmcnt(0)
    v_readfirstlane_b32 s7, v2
    v_add_u32 v2, 32, v2
    s_cmp_lt_u32 s7, 224
    s_cbranch_scc1 T_pub
    v_mov_b32 v2, 1
    buffer_atomic_add v2, off, s[32:35], 0 offset:0 sc0
    s_waitcnt vmcnt(0)
    v_cmp_gt_u32 vcc, 32, v2
    v_mov_b32 v3, 256
    s_nop 0
    v_cndmask_b32 v2, v3, v2, vcc
T_pub:
    v_mov_b32 v1, 0
    ds_write_b32 v1, v2
    s_waitcnt lgkmcnt(0)
T_join:
    s_mov_b64 exec, -1
    s_waitcnt vmcnt(0)
    s_barrier
    v_mov_b32 v1, 0
    ds_read_b32 v2, v1
    s_waitcnt lgkmcnt(0)
    v_readfirstlane_b32 s37, v2
    s_barrier
    s_cmp_ge_u32 s37, 32
    s_cbranch_scc1 L_worker
    s_cmp_eq_u32 s6, 3
    s_cselect_b32 s7, 1, 0x10001
    s_mov_b32 s3, 999
    s_load_dwordx4 s[76:79], s[0:1], 8
    s_load_dwordx4 s[80:83], s[0:1], 24
    s_load_dwordx2 s[84:85], s[0:1], 40
    s_load_dwordx2 s[90:91], s[0:1], 120
    v_lshrrev_b32 v12, 6, v0
    v_and_b32 v13, 63, v0
    v_readfirstlane_b32 s36, v12
    v_and_b32 v14, 15, v13
    v_lshrrev_b32 v15, 4, v13
    v_lshlrev_b32 v1, 4, v0
    v_lshrrev_b32 v16, 2, v14
    v_and_b32 v17, 3, v14
    v_lshrrev_b32 v18, 1, v15
    v_and_b32 v19, 1, v15
    v_lshrrev_b32 v20, 1, v16
    v_and_b32 v21, 1, v16
    s_lshl_b32 s70, s36, 2
    v_lshlrev_b32 v22, 1, v19
    v_or_b32 v22, s70, v22
    v_xor_b32 v22, v22, v14
    v_lshrrev_b32 v23, 2, v22
    v_add_u32 v24, s70, v15
    v_lshlrev_b32 v24, 13, v24
    v_lshl_or_b32 v32, v22, 4, v24
    s_and_b32 s71, s36, 1
    s_lshl_b32 s71, s71, 2
    v_bfe_u32 v24, v22, 1, 1
    v_lshl_add_u32 v24, v24, 4, v15
    v_add_u32 v24, s71, v24
    v_mul_u32_u24 v24, 1152, v24
    v_lshl_add_u32 v24, v23, 5, v24
    v_and_b32 v25, 1, v22
    v_lshl_add_u32 v24, v25, 4, v24
    s_lshr_b32 s70, s36, 1
    s_lshl_b32 s71, s70, 7
    v_add_u32 v33, s71, v24
    s_mul_i32 s71, s70, 73728
    v_add_u32 v29, s71, v24
    s_lshl_b32 s72, s37, 8
    s_mul_i32 s73, s37, 147456
    s_lshl_b32 s75, s36, 10
    s_waitcnt lgkmcnt(0)
    s_mov_b32 s28, s76
    s_and_b32 s29, s77, 0xffff
    s_mov_b32 s30, 0x2400
    s_mov_b32 s31, 0x20000
    s_mov_b32 s12, s78
    s_and_b32 s13, s79, 0xffff
    s_mov_b32 s14, 0x480000
    s_mov_b32 s15, 0x20000
    s_mov_b32 s16, s80
    s_and_b32 s17, s81, 0xffff
    s_mov_b32 s18, 0x480000
    s_mov_b32 s19, 0x20000
    s_mov_b32 s20, s82
    s_and_b32 s21, s83, 0xffff
    s_mov_b32 s22, 0x480000
    s_mov_b32 s23, 0x20000
    s_mov_b32 s24, s84
    s_and_b32 s25, s85, 0xffff
    s_mov_b32 s26, 0x480000
    s_mov_b32 s27, 0x20000
    s_mov_b32 s8, s90
    s_and_b32 s9, s91, 0xffff
    s_mov_b32 s10, 0x10000000
    s_mov_b32 s11, 0x20000
    s_add_u32 m0, s75, 0x4000
    s_add_u32 s70, s72, 0x80000
    buffer_load_dwordx4 v32, s[12:15], s70 offen lds
    s_add_u32 m0, s75, 0x5000
    s_add_u32 s70, s72, 0xa0000
    buffer_load_dwordx4 v32, s[12:15], s70 offen lds
    s_add_u32 m0, s75, 0x6000
    s_add_u32 s70, s72, 0xc0000
    buffer_load_dwordx4 v32, s[12:15], s70 offen lds
    s_add_u32 m0, s75, 0x7000
    s_add_u32 s70, s72, 0xe0000
    buffer_load_dwordx4 v32, s[12:15], s70 offen lds
    s_add_u32 m0, s75, 0x8000
    s_add_u32 s70, s72, 0x180000
    buffer_load_dwordx4 v32, s[12:15], s70 offen lds
    s_add_u32 m0, s75, 0x9000
    s_add_u32 s70, s72, 0x1a0000
    buffer_load_dwordx4 v32, s[12:15], s70 offen lds
    s_add_u32 m0, s75, 0xa000
    s_add_u32 s70, s72, 0x1c0000
    buffer_load_dwordx4 v32, s[12:15], s70 offen lds
    s_add_u32 m0, s75, 0xb000
    s_add_u32 s70, s72, 0x1e0000
    buffer_load_dwordx4 v32, s[12:15], s70 offen lds
    s_add_u32 m0, s75, 0xc000
    s_add_u32 s70, s72, 0x200000
    buffer_load_dwordx4 v32, s[12:15], s70 offen lds
    s_add_u32 m0, s75, 0xd000
    s_add_u32 s70, s72, 0x220000
    buffer_load_dwordx4 v32, s[12:15], s70 offen lds
    s_add_u32 m0, s75, 0xe000
    s_add_u32 s70, s72, 0x240000
    buffer_load_dwordx4 v32, s[12:15], s70 offen lds
    s_add_u32 m0, s75, 0xf000
    s_add_u32 s70, s72, 0x260000
    buffer_load_dwordx4 v32, s[12:15], s70 offen lds
    s_add_u32 m0, s75, 0x10000
    s_add_u32 s70, s72, 0x280000
    buffer_load_dwordx4 v32, s[12:15], s70 offen lds
    s_add_u32 m0, s75, 0x11000
    s_add_u32 s70, s72, 0x2a0000
    buffer_load_dwordx4 v32, s[12:15], s70 offen lds
    s_add_u32 m0, s75, 0x12000
    s_add_u32 s70, s72, 0x2c0000
    buffer_load_dwordx4 v32, s[12:15], s70 offen lds
    s_add_u32 m0, s75, 0x13000
    s_add_u32 s70, s72, 0x2e0000
    buffer_load_dwordx4 v32, s[12:15], s70 offen lds
    s_add_u32 m0, s75, 0x14000
    s_add_u32 s70, s72, 0x300000
    buffer_load_dwordx4 v32, s[12:15], s70 offen lds
    s_add_u32 m0, s75, 0x15000
    s_add_u32 s70, s72, 0x320000
    buffer_load_dwordx4 v32, s[12:15], s70 offen lds
    s_add_u32 m0, s75, 0x16000
    s_add_u32 s70, s72, 0x340000
    buffer_load_dwordx4 v32, s[12:15], s70 offen lds
    s_add_u32 m0, s75, 0x17000
    s_add_u32 s70, s72, 0x360000
    buffer_load_dwordx4 v32, s[12:15], s70 offen lds
    s_add_u32 m0, s75, 0x18000
    s_add_u32 s70, s72, 0x400000
    buffer_load_dwordx4 v32, s[12:15], s70 offen lds
    s_add_u32 m0, s75, 0x19000
    s_add_u32 s70, s72, 0x420000
    buffer_load_dwordx4 v32, s[12:15], s70 offen lds
    s_add_u32 m0, s75, 0x1a000
    s_add_u32 s70, s72, 0x440000
    buffer_load_dwordx4 v32, s[12:15], s70 offen lds
    s_add_u32 m0, s75, 0x1b000
    s_add_u32 s70, s72, 0x460000
    buffer_load_dwordx4 v32, s[12:15], s70 offen lds
    s_add_u32 m0, s75, 0x1c000
    s_add_u32 s70, s72, 0x100000
    buffer_load_dwordx4 v32, s[16:19], s70 offen lds
    s_add_u32 m0, s75, 0x1d000
    s_add_u32 s70, s72, 0x120000
    buffer_load_dwordx4 v32, s[16:19], s70 offen lds
    s_add_u32 m0, s75, 0x1e000
    s_add_u32 s70, s72, 0x140000
    buffer_load_dwordx4 v32, s[16:19], s70 offen lds
    s_add_u32 m0, s75, 0x1f000
    s_add_u32 s70, s72, 0x160000
    buffer_load_dwordx4 v32, s[16:19], s70 offen lds
    s_add_u32 m0, s75, 0x20000
    s_add_u32 s70, s72, 0x200000
    buffer_load_dwordx4 v32, s[16:19], s70 offen lds
    s_add_u32 m0, s75, 0x21000
    s_add_u32 s70, s72, 0x220000
    buffer_load_dwordx4 v32, s[16:19], s70 offen lds
    s_add_u32 m0, s75, 0x22000
    s_add_u32 s70, s72, 0x240000
    buffer_load_dwordx4 v32, s[16:19], s70 offen lds
    s_add_u32 m0, s75, 0x23000
    s_add_u32 s70, s72, 0x260000
    buffer_load_dwordx4 v32, s[16:19], s70 offen lds
    s_add_u32 m0, s75, 0x24000
    s_add_u32 s70, s72, 0x300000
    buffer_load_dwordx4 v32, s[16:19], s70 offen lds
    s_add_u32 m0, s75, 0x25000
    s_add_u32 s70, s72, 0x320000
    buffer_load_dwordx4 v32, s[16:19], s70 offen lds
    s_add_u32 m0, s75, 0x26000
    s_add_u32 s70, s72, 0x340000
    buffer_load_dwordx4 v32, s[16:19], s70 offen lds
    s_add_u32 m0, s75, 0x27000
    s_add_u32 s70, s72, 0x360000
    buffer_load_dwordx4 v32, s[16:19], s70 offen lds
    v_lshlrev_b32 v2, 4, v13
    v_mov_b32 v30, v13
    v_lshrrev_b32 v3, 2, v1
    v_and_b32 v22, 2, v13
    v_cmp_ne_u32 s[40:41], 0, v22
    s_cmp_eq_u32 s36, 2
    s_cselect_b32 s70, 2, 8
    v_cmp_gt_u32 s[42:43], s70, v14
    v_cmp_gt_u32 s[44:45], 18, v13
    v_lshrrev_b32 v22, 1, v14
    v_cmp_eq_u32 s[46:47], 0, v22
    v_cmp_eq_u32 s[48:49], 1, v22
    v_cmp_eq_u32 s[50:51], 2, v22
    v_and_b32 v22, 1, v13
    v_cmp_ne_u32 s[52:53], 0, v22
    v_cmp_gt_u32 s[96:97], 32, v13
    v_mov_b32 v22, 0x44444444
    v_mov_b32 v23, 0x5e4eeeee
    v_mov_b32 v24, 0xe4e5eeee
    v_cndmask_b32 v23, v23, v24, s[96:97]
    v_cndmask_b32 v0, v22, v23, s[40:41]
    v_lshl_or_b32 v22, v18, 4, v21
    v_lshl_or_b32 v22, v19, 2, v22
    v_lshl_or_b32 v22, v20, 3, v22
    v_lshl_or_b32 v23, v19, 1, v21
    v_lshl_or_b32 v23, v20, 2, v23
    s_lshl_b32 s70, s36, 1
    v_xor_b32 v23, s70, v23
    v_lshlrev_b32 v22, 8, v22
    v_lshl_or_b32 v22, v23, 5, v22
    v_lshl_or_b32 v22, v17, 3, v22
    v_xor_b32 v23, 32, v22
    v_add_u32 v34, 0x4000, v22
    v_add_u32 v35, 0x4000, v23
    v_add_u32 v36, 0x10000, v22
    v_add_u32 v37, 0x10000, v23
    v_add_u32 v38, 0x1c000, v22
    v_add_u32 v39, 0x1c000, v23
    v_add_u32 v4, 0x10000, v1
    v_add_u32 v5, 0x20000, v1
    v_lshlrev_b32 v22, 3, v14
    v_lshl_or_b32 v22, v19, 7, v22
    v_lshlrev_b32 v23, 4, v19
    v_xor_b32 v22, v22, v23
    v_lshl_or_b32 v8, v18, 10, v22
    v_lshl_or_b32 v22, v18, 9, v22
    v_or_b32 v9, s75, v22
    v_lshlrev_b32 v22, 5, v17
    v_lshl_or_b32 v22, v21, 8, v22
    v_lshl_or_b32 v22, v20, 7, v22
    v_or_b32 v22, s75, v22
    v_lshl_or_b32 v6, v15, 3, v22
    v_lshl_or_b32 v22, v18, 3, v22
    v_lshl_or_b32 v7, v19, 4, v22
    v_lshlrev_b32 v23, 4, v20
    v_xor_b32 v6, v6, v23
    v_xor_b32 v7, v7, v23
    v_lshrrev_b32 v22, 3, v13
    v_and_b32 v23, 0x70, v1
    v_lshl_or_b32 v11, v22, 12, v23
    s_lshl_b32 s70, s36, 15
    s_lshl_b32 s71, s37, 7
    s_add_u32 s59, s70, s71
    s_add_u32 s59, s59, 0x3920000
    s_add_u32 s65, s59, 0x20000
    s_add_u32 s70, s70, s71
    s_lshr_b32 s70, s70, 1
    s_add_u32 s66, s70, 0x3960000
    s_lshl_b32 s70, s36, 5
    s_add_u32 s70, s70, s37
    s_lshl_b32 s70, s70, 12
    s_add_u32 s60, s70, 0x3920000
    s_lshl_b32 s70, s37, 11
    s_add_u32 s70, s70, 0x3960000
    s_cmp_eq_u32 s36, 2
    s_cselect_b32 s60, s70, s60
    s_lshl_b32 s70, s36, 12
    s_lshl_b32 s71, s37, 5
    s_add_u32 s70, s70, s71
    s_add_u32 s100, s70, 0x3880000
    s_mul_i32 s70, s37, 288
    s_add_u32 s67, s70, 0x3880000
    s_lshl_b32 s70, s37, 14
    s_add_u32 s54, s70, 0x0
    s_add_u32 s55, s54, 4096
    s_add_u32 s56, s54, 8192
    s_add_u32 s57, s54, 12288
    s_lshl_b32 s70, s37, 12
    s_add_u32 s58, s70, 0x3040000
    s_mov_b32 s68, 0x3e0293ee
    s_mov_b32 s69, 0x3e0293ee
    s_mov_b32 s74, 0
    s_mov_b32 s98, 0x3f803f80
    s_mov_b32 s99, 0x3f803f80
    v_mov_b64 v[24:25], 0
    v_mov_b64 v[26:27], 0
    s_mov_b32 s71, 0
    s_add_u32 s70, s60, s71
    s_cmp_eq_u32 s36, 3
    s_cbranch_scc1 R_init3
    buffer_store_dwordx4 v[24:27], v2, s[8:11], s70 offen offset:0 sc1
    buffer_store_dwordx4 v[24:27], v2, s[8:11], s70 offen offset:1024 sc1
    buffer_store_dwordx4 v[24:27], v2, s[8:11], s70 offen offset:2048 sc1
    buffer_store_dwordx4 v[24:27], v2, s[8:11], s70 offen offset:3072 sc1
    s_branch R_init_done
R_init3:
    v_mov_b64 v[24:25], -1
    v_mov_b64 v[26:27], -1
    s_mov_b64 exec, s[44:45]
    s_add_u32 s64, s67, 0
    s_add_u32 s64, s64, s71
    buffer_store_dwordx4 v[24:27], v2, s[8:11], s64 offen sc1
    s_add_u32 s64, s67, 16384
    s_add_u32 s64, s64, s71
    buffer_store_dwordx4 v[24:27], v2, s[8:11], s64 offen sc1
    s_add_u32 s64, s67, 32768
    s_add_u32 s64, s64, s71
    buffer_store_dwordx4 v[24:27], v2, s[8:11], s64 offen sc1
    s_add_u32 s64, s67, 49152
    s_add_u32 s64, s64, s71
    buffer_store_dwordx4 v[24:27], v2, s[8:11], s64 offen sc1
    s_mov_b64 exec, -1
R_init_done:
    v_bfe_u32 v22, v30, 2, 2
    v_and_b32 v23, 1, v30
    v_lshl_or_b32 v22, v22, 1, v23
    v_mul_u32_u24 v22, 1152, v22
    v_lshrrev_b32 v23, 4, v30
    v_lshl_add_u32 v22, v23, 5, v22
    v_and_b32 v23, 2, v30
    v_lshl_add_u32 v31, v23, 3, v22
    s_lshl_b32 s70, s36, 7
    buffer_load_dwordx4 v[76:79], v31, s[28:31], s70 offen offset:0
    buffer_load_dwordx4 v[72:75], v31, s[28:31], s70 offen offset:512
    buffer_load_dwordx4 v[12:15], v31, s[28:31], 0 offen offset:1024
    buffer_load_dword v10, off, s[32:35], 0 offset:8 sc1
    s_lshl_b32 s4, s37, 7
    s_add_u32 s4, s4, 0x3b10000
    s_add_u32 s6, s4, 4096
    s_cmp_eq_u32 s36, 3
    s_cselect_b32 s6, s6, 0x10000000
    s_waitcnt vmcnt(32)
    s_barrier
    ds_read_b64_tr_b16 v[80:81], v34 offset:0
    ds_read_b64_tr_b16 v[82:83], v34 offset:512
    ds_read_b64_tr_b16 v[84:85], v34 offset:8192
    ds_read_b64_tr_b16 v[86:87], v34 offset:8704
    ds_read_b64_tr_b16 v[88:89], v35 offset:0
    ds_read_b64_tr_b16 v[90:91], v35 offset:512
    ds_read_b64_tr_b16 v[92:93], v35 offset:8192
    ds_read_b64_tr_b16 v[94:95], v35 offset:8704
    ds_read_b64_tr_b16 v[96:97], v34 offset:16384
    ds_read_b64_tr_b16 v[98:99], v34 offset:16896
    ds_read_b64_tr_b16 v[100:101], v34 offset:24576
    ds_read_b64_tr_b16 v[102:103], v34 offset:25088
    ds_read_b64_tr_b16 v[104:105], v35 offset:16384
    ds_read_b64_tr_b16 v[106:107], v35 offset:16896
    ds_read_b64_tr_b16 v[108:109], v35 offset:24576
    ds_read_b64_tr_b16 v[110:111], v35 offset:25088
    ds_read_b64_tr_b16 v[112:113], v34 offset:32768
    ds_read_b64_tr_b16 v[114:115], v34 offset:33280
    ds_read_b64_tr_b16 v[116:117], v34 offset:40960
    ds_read_b64_tr_b16 v[118:119], v34 offset:41472
    ds_read_b64_tr_b16 v[120:121], v35 offset:32768
    ds_read_b64_tr_b16 v[122:123], v35 offset:33280
    ds_read_b64_tr_b16 v[124:125], v35 offset:40960
    ds_read_b64_tr_b16 v[126:127], v35 offset:41472
    s_waitcnt lgkmcnt(0)
    s_barrier
    s_add_u32 m0, s75, 0x4000
    s_add_u32 s70, s72, 0x380000
    buffer_load_dwordx4 v32, s[16:19], s70 offen lds
    s_add_u32 m0, s75, 0x5000
    s_add_u32 s70, s72, 0x3a0000
    buffer_load_dwordx4 v32, s[16:19], s70 offen lds
    s_add_u32 m0, s75, 0x6000
    s_add_u32 s70, s72, 0x3c0000
    buffer_load_dwordx4 v32, s[16:19], s70 offen lds
    s_add_u32 m0, s75, 0x7000
    s_add_u32 s70, s72, 0x3e0000
    buffer_load_dwordx4 v32, s[16:19], s70 offen lds
    s_add_u32 m0, s75, 0x8000
    s_add_u32 s70, s72, 0x400000
    buffer_load_dwordx4 v32, s[16:19], s70 offen lds
    s_add_u32 m0, s75, 0x9000
    s_add_u32 s70, s72, 0x420000
    buffer_load_dwordx4 v32, s[16:19], s70 offen lds
    s_add_u32 m0, s75, 0xa000
    s_add_u32 s70, s72, 0x440000
    buffer_load_dwordx4 v32, s[16:19], s70 offen lds
    s_add_u32 m0, s75, 0xb000
    s_add_u32 s70, s72, 0x460000
    buffer_load_dwordx4 v32, s[16:19], s70 offen lds
    s_add_u32 m0, s75, 0xc000
    s_add_u32 s70, s72, 0x0
    buffer_load_dwordx4 v32, s[20:23], s70 offen lds
    s_add_u32 m0, s75, 0xd000
    s_add_u32 s70, s72, 0x20000
    buffer_load_dwordx4 v32, s[20:23], s70 offen lds
    s_add_u32 m0, s75, 0xe000
    s_add_u32 s70, s72, 0x40000
    buffer_load_dwordx4 v32, s[20:23], s70 offen lds
    s_add_u32 m0, s75, 0xf000
    s_add_u32 s70, s72, 0x60000
    buffer_load_dwordx4 v32, s[20:23], s70 offen lds
    s_waitcnt vmcnt(32)
    s_barrier
    ds_read_b64_tr_b16 v[128:129], v36 offset:0
    ds_read_b64_tr_b16 v[130:131], v36 offset:512
    ds_read_b64_tr_b16 v[132:133], v36 offset:8192
    ds_read_b64_tr_b16 v[134:135], v36 offset:8704
    ds_read_b64_tr_b16 v[136:137], v37 offset:0
    ds_read_b64_tr_b16 v[138:139], v37 offset:512
    ds_read_b64_tr_b16 v[140:141], v37 offset:8192
    ds_read_b64_tr_b16 v[142:143], v37 offset:8704
    ds_read_b64_tr_b16 v[144:145], v36 offset:16384
    ds_read_b64_tr_b16 v[146:147], v36 offset:16896
    ds_read_b64_tr_b16 v[148:149], v36 offset:24576
    ds_read_b64_tr_b16 v[150:151], v36 offset:25088
    ds_read_b64_tr_b16 v[152:153], v37 offset:16384
    ds_read_b64_tr_b16 v[154:155], v37 offset:16896
    ds_read_b64_tr_b16 v[156:157], v37 offset:24576
    ds_read_b64_tr_b16 v[158:159], v37 offset:25088
    ds_read_b64_tr_b16 v[160:161], v36 offset:32768
    ds_read_b64_tr_b16 v[162:163], v36 offset:33280
    ds_read_b64_tr_b16 v[164:165], v36 offset:40960
    ds_read_b64_tr_b16 v[166:167], v36 offset:41472
    ds_read_b64_tr_b16 v[168:169], v37 offset:32768
    ds_read_b64_tr_b16 v[170:171], v37 offset:33280
    ds_read_b64_tr_b16 v[172:173], v37 offset:40960
    ds_read_b64_tr_b16 v[174:175], v37 offset:41472
    s_waitcnt lgkmcnt(0)
    s_barrier
    s_add_u32 m0, s75, 0x10000
    s_add_u32 s70, s72, 0x80000
    buffer_load_dwordx4 v32, s[20:23], s70 offen lds
    s_add_u32 m0, s75, 0x11000
    s_add_u32 s70, s72, 0xa0000
    buffer_load_dwordx4 v32, s[20:23], s70 offen lds
    s_add_u32 m0, s75, 0x12000
    s_add_u32 s70, s72, 0xc0000
    buffer_load_dwordx4 v32, s[20:23], s70 offen lds
    s_add_u32 m0, s75, 0x13000
    s_add_u32 s70, s72, 0xe0000
    buffer_load_dwordx4 v32, s[20:23], s70 offen lds
    s_add_u32 m0, s75, 0x14000
    s_add_u32 s70, s72, 0x100000
    buffer_load_dwordx4 v32, s[20:23], s70 offen lds
    s_add_u32 m0, s75, 0x15000
    s_add_u32 s70, s72, 0x120000
    buffer_load_dwordx4 v32, s[20:23], s70 offen lds
    s_add_u32 m0, s75, 0x16000
    s_add_u32 s70, s72, 0x140000
    buffer_load_dwordx4 v32, s[20:23], s70 offen lds
    s_add_u32 m0, s75, 0x17000
    s_add_u32 s70, s72, 0x160000
    buffer_load_dwordx4 v32, s[20:23], s70 offen lds
    s_add_u32 m0, s75, 0x18000
    s_add_u32 s70, s72, 0x180000
    buffer_load_dwordx4 v32, s[20:23], s70 offen lds
    s_add_u32 m0, s75, 0x19000
    s_add_u32 s70, s72, 0x1a0000
    buffer_load_dwordx4 v32, s[20:23], s70 offen lds
    s_add_u32 m0, s75, 0x1a000
    s_add_u32 s70, s72, 0x1c0000
    buffer_load_dwordx4 v32, s[20:23], s70 offen lds
    s_add_u32 m0, s75, 0x1b000
    s_add_u32 s70, s72, 0x1e0000
    buffer_load_dwordx4 v32, s[20:23], s70 offen lds
    s_waitcnt vmcnt(32)
    s_barrier
    ds_read_b64_tr_b16 v[176:177], v38 offset:0
    ds_read_b64_tr_b16 v[178:179], v38 offset:512
    ds_read_b64_tr_b16 v[180:181], v38 offset:8192
    ds_read_b64_tr_b16 v[182:183], v38 offset:8704
    ds_read_b64_tr_b16 v[184:185], v39 offset:0
    ds_read_b64_tr_b16 v[186:187], v39 offset:512
    ds_read_b64_tr_b16 v[188:189], v39 offset:8192
    ds_read_b64_tr_b16 v[190:191], v39 offset:8704
    ds_read_b64_tr_b16 v[192:193], v38 offset:16384
    ds_read_b64_tr_b16 v[194:195], v38 offset:16896
    ds_read_b64_tr_b16 v[196:197], v38 offset:24576
    ds_read_b64_tr_b16 v[198:199], v38 offset:25088
    ds_read_b64_tr_b16 v[200:201], v39 offset:16384
    ds_read_b64_tr_b16 v[202:203], v39 offset:16896
    ds_read_b64_tr_b16 v[204:205], v39 offset:24576
    ds_read_b64_tr_b16 v[206:207], v39 offset:25088
    ds_read_b64_tr_b16 v[208:209], v38 offset:32768
    ds_read_b64_tr_b16 v[210:211], v38 offset:33280
    ds_read_b64_tr_b16 v[212:213], v38 offset:40960
    ds_read_b64_tr_b16 v[214:215], v38 offset:41472
    ds_read_b64_tr_b16 v[216:217], v39 offset:32768
    ds_read_b64_tr_b16 v[218:219], v39 offset:33280
    ds_read_b64_tr_b16 v[220:221], v39 offset:40960
    ds_read_b64_tr_b16 v[222:223], v39 offset:41472
    s_waitcnt lgkmcnt(0)
    s_barrier
    s_add_u32 m0, s75, 0x1c000
    s_add_u32 s70, s72, 0x200000
    buffer_load_dwordx4 v32, s[20:23], s70 offen lds
    s_add_u32 m0, s75, 0x1d000
    s_add_u32 s70, s72, 0x220000
    buffer_load_dwordx4 v32, s[20:23], s70 offen lds
    s_add_u32 m0, s75, 0x1e000
    s_add_u32 s70, s72, 0x240000
    buffer_load_dwordx4 v32, s[20:23], s70 offen lds
    s_add_u32 m0, s75, 0x1f000
    s_add_u32 s70, s72, 0x260000
    buffer_load_dwordx4 v32, s[20:23], s70 offen lds
    s_add_u32 m0, s75, 0x20000
    s_add_u32 s70, s72, 0x280000
    buffer_load_dwordx4 v32, s[20:23], s70 offen lds
    s_add_u32 m0, s75, 0x21000
    s_add_u32 s70, s72, 0x2a0000
    buffer_load_dwordx4 v32, s[20:23], s70 offen lds
    s_add_u32 m0, s75, 0x22000
    s_add_u32 s70, s72, 0x2c0000
    buffer_load_dwordx4 v32, s[20:23], s70 offen lds
    s_add_u32 m0, s75, 0x23000
    s_add_u32 s70, s72, 0x2e0000
    buffer_load_dwordx4 v32, s[20:23], s70 offen lds
    s_add_u32 m0, s75, 0x24000
    s_add_u32 s70, s72, 0x300000
    buffer_load_dwordx4 v32, s[20:23], s70 offen lds
    s_add_u32 m0, s75, 0x25000
    s_add_u32 s70, s72, 0x320000
    buffer_load_dwordx4 v32, s[20:23], s70 offen lds
    s_add_u32 m0, s75, 0x26000
    s_add_u32 s70, s72, 0x340000
    buffer_load_dwordx4 v32, s[20:23], s70 offen lds
    s_add_u32 m0, s75, 0x27000
    s_add_u32 s70, s72, 0x360000
    buffer_load_dwordx4 v32, s[20:23], s70 offen lds
    s_waitcnt vmcnt(24)
    s_barrier
    ds_read_b64_tr_b16 v[224:225], v34 offset:0
    ds_read_b64_tr_b16 v[226:227], v34 offset:512
    ds_read_b64_tr_b16 v[228:229], v34 offset:8192
    ds_read_b64_tr_b16 v[230:231], v34 offset:8704
    ds_read_b64_tr_b16 v[232:233], v35 offset:0
    ds_read_b64_tr_b16 v[234:235], v35 offset:512
    ds_read_b64_tr_b16 v[236:237], v35 offset:8192
    ds_read_b64_tr_b16 v[238:239], v35 offset:8704
    ds_read_b64_tr_b16 v[240:241], v34 offset:16384
    ds_read_b64_tr_b16 v[242:243], v34 offset:16896
    ds_read_b64_tr_b16 v[244:245], v34 offset:24576
    ds_read_b64_tr_b16 v[246:247], v34 offset:25088
    ds_read_b64_tr_b16 v[248:249], v35 offset:16384
    ds_read_b64_tr_b16 v[250:251], v35 offset:16896
    ds_read_b64_tr_b16 v[252:253], v35 offset:24576
    ds_read_b64_tr_b16 v[254:255], v35 offset:25088
    ds_read_b64_tr_b16 a[0:1], v34 offset:32768
    ds_read_b64_tr_b16 a[2:3], v34 offset:33280
    ds_read_b64_tr_b16 a[4:5], v34 offset:40960
    ds_read_b64_tr_b16 a[6:7], v34 offset:41472
    ds_read_b64_tr_b16 a[8:9], v35 offset:32768
    ds_read_b64_tr_b16 a[10:11], v35 offset:33280
    ds_read_b64_tr_b16 a[12:13], v35 offset:40960
    ds_read_b64_tr_b16 a[14:15], v35 offset:41472
    v_cmp_eq_u32 vcc, 0, v1
    s_nop 0
    s_and_saveexec_b64 s[70:71], vcc
    s_cbranch_execz R_init_sig
    v_mov_b32 v24, s7
    buffer_atomic_add v24, off, s[32:35], 0 offset:4
R_init_sig:
    s_mov_b64 exec, -1
    v_min_u32 v76, -2, v76
    v_min_u32 v77, -2, v77
    v_min_u32 v78, -2, v78
    v_min_u32 v79, -2, v79
    v_min_u32 v72, -2, v72
    v_min_u32 v73, -2, v73
    v_min_u32 v74, -2, v74
    v_min_u32 v75, -2, v75
    v_min_u32 v12, -2, v12
    v_min_u32 v13, -2, v13
    v_min_u32 v14, -2, v14
    v_min_u32 v15, -2, v15
    s_lshl_b32 s62, s37, 14
    s_add_u32 s62, s62, 0x3890000
    s_add_u32 s63, s62, 4096
    s_add_u32 s70, s62, 8192
    buffer_store_dwordx4 v[72:75], v1, s[8:11], s63 offen
    buffer_store_dwordx4 v[12:15], v2, s[8:11], s70 offen
R_init:
    v_readfirstlane_b32 s70, v10
    s_nop 0
    s_cmp_ge_u32 s70, 1
    s_cbranch_scc1 R_initok
    buffer_load_dword v10, off, s[32:35], 0 offset:8 sc1
    s_add_u32 s74, s74, 1
    s_cmp_gt_u32 s74, 0x400000
    s_cbranch_scc1 L_exit
    s_waitcnt vmcnt(0)
    s_branch R_init
R_initok:
    s_waitcnt lgkmcnt(0)
    s_barrier
    s_add_u32 m0, s75, 0x4000
    s_add_u32 s70, s72, 0x380000
    buffer_load_dwordx4 v32, s[20:23], s70 offen lds
    s_add_u32 m0, s75, 0x5000
    s_add_u32 s70, s72, 0x3a0000
    buffer_load_dwordx4 v32, s[20:23], s70 offen lds
    s_add_u32 m0, s75, 0x6000
    s_add_u32 s70, s72, 0x3c0000
    buffer_load_dwordx4 v32, s[20:23], s70 offen lds
    s_add_u32 m0, s75, 0x7000
    s_add_u32 s70, s72, 0x3e0000
    buffer_load_dwordx4 v32, s[20:23], s70 offen lds
    s_add_u32 m0, s75, 0x8000
    s_add_u32 s70, s72, 0x400000
    buffer_load_dwordx4 v32, s[20:23], s70 offen lds
    s_add_u32 m0, s75, 0x9000
    s_add_u32 s70, s72, 0x420000
    buffer_load_dwordx4 v32, s[20:23], s70 offen lds
    s_add_u32 m0, s75, 0xa000
    s_add_u32 s70, s72, 0x440000
    buffer_load_dwordx4 v32, s[20:23], s70 offen lds
    s_add_u32 m0, s75, 0xb000
    s_add_u32 s70, s72, 0x460000
    buffer_load_dwordx4 v32, s[20:23], s70 offen lds
    s_add_u32 m0, s75, 0xc000
    s_add_u32 s70, s73, 0x0
    buffer_load_dwordx4 v33, s[24:27], s70 offen lds
    s_add_u32 m0, s75, 0xd000
    s_add_u32 s70, s73, 0x2400
    buffer_load_dwordx4 v33, s[24:27], s70 offen lds
    s_add_u32 m0, s75, 0xe000
    s_add_u32 s70, s73, 0x9000
    buffer_load_dwordx4 v33, s[24:27], s70 offen lds
    s_add_u32 m0, s75, 0xf000
    s_add_u32 s70, s73, 0xb400
    buffer_load_dwordx4 v33, s[24:27], s70 offen lds
    s_waitcnt vmcnt(26)
    s_barrier
    ds_read_b64_tr_b16 a[16:17], v36 offset:0
    ds_read_b64_tr_b16 a[18:19], v36 offset:512
    ds_read_b64_tr_b16 a[20:21], v36 offset:8192
    ds_read_b64_tr_b16 a[22:23], v36 offset:8704
    ds_read_b64_tr_b16 a[24:25], v37 offset:0
    ds_read_b64_tr_b16 a[26:27], v37 offset:512
    ds_read_b64_tr_b16 a[28:29], v37 offset:8192
    ds_read_b64_tr_b16 a[30:31], v37 offset:8704
    ds_read_b64_tr_b16 a[32:33], v36 offset:16384
    ds_read_b64_tr_b16 a[34:35], v36 offset:16896
    ds_read_b64_tr_b16 a[36:37], v36 offset:24576
    ds_read_b64_tr_b16 a[38:39], v36 offset:25088
    ds_read_b64_tr_b16 a[40:41], v37 offset:16384
    ds_read_b64_tr_b16 a[42:43], v37 offset:16896
    ds_read_b64_tr_b16 a[44:45], v37 offset:24576
    ds_read_b64_tr_b16 a[46:47], v37 offset:25088
    ds_read_b64_tr_b16 a[48:49], v36 offset:32768
    ds_read_b64_tr_b16 a[50:51], v36 offset:33280
    ds_read_b64_tr_b16 a[52:53], v36 offset:40960
    ds_read_b64_tr_b16 a[54:55], v36 offset:41472
    ds_read_b64_tr_b16 a[56:57], v37 offset:32768
    ds_read_b64_tr_b16 a[58:59], v37 offset:33280
    ds_read_b64_tr_b16 a[60:61], v37 offset:40960
    ds_read_b64_tr_b16 a[62:63], v37 offset:41472
    s_waitcnt lgkmcnt(0)
    s_barrier
    s_add_u32 m0, s75, 0x10000
    s_add_u32 s70, s73, 0x12000
    buffer_load_dwordx4 v33, s[24:27], s70 offen lds
    s_add_u32 m0, s75, 0x11000
    s_add_u32 s70, s73, 0x14400
    buffer_load_dwordx4 v33, s[24:27], s70 offen lds
    s_add_u32 m0, s75, 0x12000
    s_add_u32 s70, s73, 0x1b000
    buffer_load_dwordx4 v33, s[24:27], s70 offen lds
    s_add_u32 m0, s75, 0x13000
    s_add_u32 s70, s73, 0x1d400
    buffer_load_dwordx4 v33, s[24:27], s70 offen lds
    s_add_u32 m0, s75, 0x14000
    s_add_u32 s70, s73, 0x100
    buffer_load_dwordx4 v33, s[24:27], s70 offen lds
    s_add_u32 m0, s75, 0x15000
    s_add_u32 s70, s73, 0x2500
    buffer_load_dwordx4 v33, s[24:27], s70 offen lds
    s_add_u32 m0, s75, 0x16000
    s_add_u32 s70, s73, 0x9100
    buffer_load_dwordx4 v33, s[24:27], s70 offen lds
    s_add_u32 m0, s75, 0x17000
    s_add_u32 s70, s73, 0xb500
    buffer_load_dwordx4 v33, s[24:27], s70 offen lds
    s_add_u32 m0, s75, 0x18000
    s_add_u32 s70, s73, 0x12100
    buffer_load_dwordx4 v33, s[24:27], s70 offen lds
    s_add_u32 m0, s75, 0x19000
    s_add_u32 s70, s73, 0x14500
    buffer_load_dwordx4 v33, s[24:27], s70 offen lds
    s_add_u32 m0, s75, 0x1a000
    s_add_u32 s70, s73, 0x1b100
    buffer_load_dwordx4 v33, s[24:27], s70 offen lds
    s_add_u32 m0, s75, 0x1b000
    s_add_u32 s70, s73, 0x1d500
    buffer_load_dwordx4 v33, s[24:27], s70 offen lds
    s_waitcnt vmcnt(26)
    s_barrier
    ds_read_b64_tr_b16 a[64:65], v38 offset:0
    ds_read_b64_tr_b16 a[66:67], v38 offset:512
    ds_read_b64_tr_b16 a[68:69], v38 offset:8192
    ds_read_b64_tr_b16 a[70:71], v38 offset:8704
    ds_read_b64_tr_b16 a[72:73], v39 offset:0
    ds_read_b64_tr_b16 a[74:75], v39 offset:512
    ds_read_b64_tr_b16 a[76:77], v39 offset:8192
    ds_read_b64_tr_b16 a[78:79], v39 offset:8704
    ds_read_b64_tr_b16 a[80:81], v38 offset:16384
    ds_read_b64_tr_b16 a[82:83], v38 offset:16896
    ds_read_b64_tr_b16 a[84:85], v38 offset:24576
    ds_read_b64_tr_b16 a[86:87], v38 offset:25088
    ds_read_b64_tr_b16 a[88:89], v39 offset:16384
    ds_read_b64_tr_b16 a[90:91], v39 offset:16896
    ds_read_b64_tr_b16 a[92:93], v39 offset:24576
    ds_read_b64_tr_b16 a[94:95], v39 offset:25088
    ds_read_b64_tr_b16 a[96:97], v38 offset:32768
    ds_read_b64_tr_b16 a[98:99], v38 offset:33280
    ds_read_b64_tr_b16 a[100:101], v38 offset:40960
    ds_read_b64_tr_b16 a[102:103], v38 offset:41472
    ds_read_b64_tr_b16 a[104:105], v39 offset:32768
    ds_read_b64_tr_b16 a[106:107], v39 offset:33280
    ds_read_b64_tr_b16 a[108:109], v39 offset:40960
    ds_read_b64_tr_b16 a[110:111], v39 offset:41472
    s_waitcnt lgkmcnt(0)
    s_barrier
    s_add_u32 m0, s75, 0x1c000
    s_add_u32 s70, s73, 0x12200
    buffer_load_dwordx4 v33, s[24:27], s70 offen lds
    s_add_u32 m0, s75, 0x1d000
    s_add_u32 s70, s73, 0x14600
    buffer_load_dwordx4 v33, s[24:27], s70 offen lds
    s_add_u32 m0, s75, 0x1e000
    s_add_u32 s70, s73, 0x1b200
    buffer_load_dwordx4 v33, s[24:27], s70 offen lds
    s_add_u32 m0, s75, 0x1f000
    s_add_u32 s70, s73, 0x1d600
    buffer_load_dwordx4 v33, s[24:27], s70 offen lds
    s_add_u32 m0, s75, 0x20000
    s_add_u32 s70, s73, 0x300
    buffer_load_dwordx4 v33, s[24:27], s70 offen lds
    s_add_u32 m0, s75, 0x21000
    s_add_u32 s70, s73, 0x2700
    buffer_load_dwordx4 v33, s[24:27], s70 offen lds
    s_add_u32 m0, s75, 0x22000
    s_add_u32 s70, s73, 0x9300
    buffer_load_dwordx4 v33, s[24:27], s70 offen lds
    s_add_u32 m0, s75, 0x23000
    s_add_u32 s70, s73, 0xb700
    buffer_load_dwordx4 v33, s[24:27], s70 offen lds
    s_add_u32 m0, s75, 0x24000
    s_add_u32 s70, s73, 0x12300
    buffer_load_dwordx4 v33, s[24:27], s70 offen lds
    s_add_u32 m0, s75, 0x25000
    s_add_u32 s70, s73, 0x14700
    buffer_load_dwordx4 v33, s[24:27], s70 offen lds
    s_add_u32 m0, s75, 0x26000
    s_add_u32 s70, s73, 0x1b300
    buffer_load_dwordx4 v33, s[24:27], s70 offen lds
    s_add_u32 m0, s75, 0x27000
    s_add_u32 s70, s73, 0x1d700
    buffer_load_dwordx4 v33, s[24:27], s70 offen lds
    s_waitcnt vmcnt(24)
    s_barrier
    ds_read_b64_tr_b16 a[112:113], v34 offset:0
    ds_read_b64_tr_b16 a[114:115], v34 offset:512
    ds_read_b64_tr_b16 a[116:117], v34 offset:8192
    ds_read_b64_tr_b16 a[118:119], v34 offset:8704
    ds_read_b64_tr_b16 a[120:121], v35 offset:0
    ds_read_b64_tr_b16 a[122:123], v35 offset:512
    ds_read_b64_tr_b16 a[124:125], v35 offset:8192
    ds_read_b64_tr_b16 a[126:127], v35 offset:8704
    ds_read_b64_tr_b16 a[128:129], v34 offset:16384
    ds_read_b64_tr_b16 a[130:131], v34 offset:16896
    ds_read_b64_tr_b16 a[132:133], v34 offset:24576
    ds_read_b64_tr_b16 a[134:135], v34 offset:25088
    ds_read_b64_tr_b16 a[136:137], v35 offset:16384
    ds_read_b64_tr_b16 a[138:139], v35 offset:16896
    ds_read_b64_tr_b16 a[140:141], v35 offset:24576
    ds_read_b64_tr_b16 a[142:143], v35 offset:25088
    ds_read_b64_tr_b16 a[144:145], v34 offset:32768
    ds_read_b64_tr_b16 a[146:147], v34 offset:33280
    ds_read_b64_tr_b16 a[148:149], v34 offset:40960
    ds_read_b64_tr_b16 a[150:151], v34 offset:41472
    ds_read_b64_tr_b16 a[152:153], v35 offset:32768
    ds_read_b64_tr_b16 a[154:155], v35 offset:33280
    ds_read_b64_tr_b16 a[156:157], v35 offset:40960
    ds_read_b64_tr_b16 a[158:159], v35 offset:41472
    s_waitcnt lgkmcnt(0)
    s_barrier
    s_add_u32 m0, s75, 0x4000
    s_add_u32 s70, s72, 0x0
    buffer_load_dwordx4 v32, s[12:15], s70 offen lds
    s_add_u32 m0, s75, 0x5000
    s_add_u32 s70, s72, 0x20000
    buffer_load_dwordx4 v32, s[12:15], s70 offen lds
    s_add_u32 m0, s75, 0x6000
    s_add_u32 s70, s72, 0x40000
    buffer_load_dwordx4 v32, s[12:15], s70 offen lds
    s_add_u32 m0, s75, 0x7000
    s_add_u32 s70, s72, 0x60000
    buffer_load_dwordx4 v32, s[12:15], s70 offen lds
    s_add_u32 m0, s75, 0x8000
    s_add_u32 s70, s72, 0x0
    buffer_load_dwordx4 v32, s[16:19], s70 offen lds
    s_add_u32 m0, s75, 0x9000
    s_add_u32 s70, s72, 0x20000
    buffer_load_dwordx4 v32, s[16:19], s70 offen lds
    s_add_u32 m0, s75, 0xa000
    s_add_u32 s70, s72, 0x40000
    buffer_load_dwordx4 v32, s[16:19], s70 offen lds
    s_add_u32 m0, s75, 0xb000
    s_add_u32 s70, s72, 0x60000
    buffer_load_dwordx4 v32, s[16:19], s70 offen lds
    s_add_u32 m0, s75, 0xc000
    s_add_u32 s70, s72, 0x100000
    buffer_load_dwordx4 v32, s[12:15], s70 offen lds
    s_add_u32 m0, s75, 0xd000
    s_add_u32 s70, s72, 0x120000
    buffer_load_dwordx4 v32, s[12:15], s70 offen lds
    s_add_u32 m0, s75, 0xe000
    s_add_u32 s70, s72, 0x140000
    buffer_load_dwordx4 v32, s[12:15], s70 offen lds
    s_add_u32 m0, s75, 0xf000
    s_add_u32 s70, s72, 0x160000
    buffer_load_dwordx4 v32, s[12:15], s70 offen lds
    s_waitcnt vmcnt(24)
    s_barrier
    ds_read_b64_tr_b16 a[160:161], v36 offset:0
    ds_read_b64_tr_b16 a[162:163], v36 offset:512
    ds_read_b64_tr_b16 a[164:165], v36 offset:8192
    ds_read_b64_tr_b16 a[166:167], v36 offset:8704
    ds_read_b64_tr_b16 a[168:169], v37 offset:0
    ds_read_b64_tr_b16 a[170:171], v37 offset:512
    ds_read_b64_tr_b16 a[172:173], v37 offset:8192
    ds_read_b64_tr_b16 a[174:175], v37 offset:8704
    ds_read_b64_tr_b16 a[176:177], v36 offset:16384
    ds_read_b64_tr_b16 a[178:179], v36 offset:16896
    ds_read_b64_tr_b16 a[180:181], v36 offset:24576
    ds_read_b64_tr_b16 a[182:183], v36 offset:25088
    ds_read_b64_tr_b16 a[184:185], v37 offset:16384
    ds_read_b64_tr_b16 a[186:187], v37 offset:16896
    ds_read_b64_tr_b16 a[188:189], v37 offset:24576
    ds_read_b64_tr_b16 a[190:191], v37 offset:25088
    ds_read_b64_tr_b16 a[192:193], v36 offset:32768
    ds_read_b64_tr_b16 a[194:195], v36 offset:33280
    ds_read_b64_tr_b16 a[196:197], v36 offset:40960
    ds_read_b64_tr_b16 a[198:199], v36 offset:41472
    ds_read_b64_tr_b16 a[200:201], v37 offset:32768
    ds_read_b64_tr_b16 a[202:203], v37 offset:33280
    ds_read_b64_tr_b16 a[204:205], v37 offset:40960
    ds_read_b64_tr_b16 a[206:207], v37 offset:41472
    buffer_load_dword v10, off, s[8:11], s4 sc1
    s_waitcnt lgkmcnt(0)
    s_barrier
    s_add_u32 m0, s75, 0x10000
    s_add_u32 s70, s72, 0x80000
    buffer_load_dwordx4 v32, s[16:19], s70 offen lds
    s_add_u32 m0, s75, 0x11000
    s_add_u32 s70, s72, 0xa0000
    buffer_load_dwordx4 v32, s[16:19], s70 offen lds
    s_add_u32 m0, s75, 0x12000
    s_add_u32 s70, s72, 0xc0000
    buffer_load_dwordx4 v32, s[16:19], s70 offen lds
    s_add_u32 m0, s75, 0x13000
    s_add_u32 s70, s72, 0xe0000
    buffer_load_dwordx4 v32, s[16:19], s70 offen lds
    s_add_u32 m0, s75, 0x14000
    s_add_u32 s70, s72, 0x180000
    buffer_load_dwordx4 v32, s[16:19], s70 offen lds
    s_add_u32 m0, s75, 0x15000
    s_add_u32 s70, s72, 0x1a0000
    buffer_load_dwordx4 v32, s[16:19], s70 offen lds
    s_add_u32 m0, s75, 0x16000
    s_add_u32 s70, s72, 0x1c0000
    buffer_load_dwordx4 v32, s[16:19], s70 offen lds
    s_add_u32 m0, s75, 0x17000
    s_add_u32 s70, s72, 0x1e0000
    buffer_load_dwordx4 v32, s[16:19], s70 offen lds
    s_add_u32 m0, s75, 0x18000
    s_add_u32 s70, s72, 0x380000
    buffer_load_dwordx4 v32, s[12:15], s70 offen lds
    s_add_u32 m0, s75, 0x19000
    s_add_u32 s70, s72, 0x3a0000
    buffer_load_dwordx4 v32, s[12:15], s70 offen lds
    s_add_u32 m0, s75, 0x1a000
    s_add_u32 s70, s72, 0x3c0000
    buffer_load_dwordx4 v32, s[12:15], s70 offen lds
    s_add_u32 m0, s75, 0x1b000
    s_add_u32 s70, s72, 0x3e0000
    buffer_load_dwordx4 v32, s[12:15], s70 offen lds
    s_waitcnt vmcnt(25)
    s_barrier
    ds_read_b64_tr_b16 a[208:209], v38 offset:0
    ds_read_b64_tr_b16 a[210:211], v38 offset:512
    ds_read_b64_tr_b16 a[212:213], v38 offset:8192
    ds_read_b64_tr_b16 a[214:215], v38 offset:8704
    ds_read_b64_tr_b16 a[216:217], v39 offset:0
    ds_read_b64_tr_b16 a[218:219], v39 offset:512
    ds_read_b64_tr_b16 a[220:221], v39 offset:8192
    ds_read_b64_tr_b16 a[222:223], v39 offset:8704
    ds_read_b64_tr_b16 a[224:225], v38 offset:16384
    ds_read_b64_tr_b16 a[226:227], v38 offset:16896
    ds_read_b64_tr_b16 a[228:229], v38 offset:24576
    ds_read_b64_tr_b16 a[230:231], v38 offset:25088
    ds_read_b64_tr_b16 a[232:233], v39 offset:16384
    ds_read_b64_tr_b16 a[234:235], v39 offset:16896
    ds_read_b64_tr_b16 a[236:237], v39 offset:24576
    ds_read_b64_tr_b16 a[238:239], v39 offset:25088
    ds_read_b64_tr_b16 a[240:241], v38 offset:32768
    ds_read_b64_tr_b16 a[242:243], v38 offset:33280
    ds_read_b64_tr_b16 a[244:245], v38 offset:40960
    ds_read_b64_tr_b16 a[246:247], v38 offset:41472
    ds_read_b64_tr_b16 a[248:249], v39 offset:32768
    ds_read_b64_tr_b16 a[250:251], v39 offset:33280
    ds_read_b64_tr_b16 a[252:253], v39 offset:40960
    ds_read_b64_tr_b16 a[254:255], v39 offset:41472
    buffer_load_dwordx4 v[72:75], off, s[32:35], 0 sc1
    s_waitcnt lgkmcnt(0)
    s_barrier
    s_add_u32 m0, s75, 0x1c000
    s_add_u32 s70, s72, 0x280000
    buffer_load_dwordx4 v32, s[16:19], s70 offen lds
    s_add_u32 m0, s75, 0x1d000
    s_add_u32 s70, s72, 0x2a0000
    buffer_load_dwordx4 v32, s[16:19], s70 offen lds
    s_add_u32 m0, s75, 0x1e000
    s_add_u32 s70, s72, 0x2c0000
    buffer_load_dwordx4 v32, s[16:19], s70 offen lds
    s_add_u32 m0, s75, 0x1f000
    s_add_u32 s70, s72, 0x2e0000
    buffer_load_dwordx4 v32, s[16:19], s70 offen lds
    s_add_u32 m0, s75, 0x20000
    s_add_u32 s70, s73, 0x200
    buffer_load_dwordx4 v33, s[24:27], s70 offen lds
    s_add_u32 m0, s75, 0x21000
    s_add_u32 s70, s73, 0x2600
    buffer_load_dwordx4 v33, s[24:27], s70 offen lds
    s_add_u32 m0, s75, 0x22000
    s_add_u32 s70, s73, 0x9200
    buffer_load_dwordx4 v33, s[24:27], s70 offen lds
    s_add_u32 m0, s75, 0x23000
    s_add_u32 s70, s73, 0xb600
    buffer_load_dwordx4 v33, s[24:27], s70 offen lds
    s_add_u32 m0, s75, 0x24000
    s_add_u32 s70, s73, 0x400
    buffer_load_dwordx4 v29, s[24:27], s70 offen lds
    s_add_u32 m0, s75, 0x25000
    s_add_u32 s70, s73, 0x2800
    buffer_load_dwordx4 v29, s[24:27], s70 offen lds
    s_add_u32 m0, s75, 0x26000
    s_add_u32 s70, s73, 0x9400
    buffer_load_dwordx4 v29, s[24:27], s70 offen lds
    s_add_u32 m0, s75, 0x27000
    s_add_u32 s70, s73, 0xb800
    buffer_load_dwordx4 v29, s[24:27], s70 offen lds
    s_mov_b32 s12, s6
    s_lshl_b32 s13, s36, 8
    s_add_u32 s13, s13, 8192
    s_add_u32 s16, s62, 8192
    s_add_u32 s75, s75, 4096
    s_mov_b32 s38, 0
    s_mov_b32 s14, 3
    s_add_u32 s73, s38, s14
    s_waitcnt vmcnt(26)
    s_barrier
    ds_read_b64_tr_b16 v[40:41], v34 offset:0
    ds_read_b64_tr_b16 v[42:43], v34 offset:512
    ds_read_b64_tr_b16 v[44:45], v34 offset:8192
    ds_read_b64_tr_b16 v[46:47], v34 offset:8704
    ds_read_b64_tr_b16 v[48:49], v35 offset:0
    ds_read_b64_tr_b16 v[50:51], v35 offset:512
    ds_read_b64_tr_b16 v[52:53], v35 offset:8192
    ds_read_b64_tr_b16 v[54:55], v35 offset:8704
    ds_read_b64_tr_b16 v[16:17], v34 offset:16384
    ds_read_b64_tr_b16 v[18:19], v34 offset:16896
    ds_read_b64_tr_b16 v[20:21], v34 offset:24576
    ds_read_b64_tr_b16 v[22:23], v34 offset:25088
    ds_read_b64_tr_b16 v[24:25], v35 offset:16384
    ds_read_b64_tr_b16 v[26:27], v35 offset:16896
    ds_read_b64_tr_b16 v[28:29], v35 offset:24576
    ds_read_b64_tr_b16 v[30:31], v35 offset:25088
    ds_read_b64_tr_b16 v[56:57], v34 offset:32768
    ds_read_b64_tr_b16 v[58:59], v34 offset:33280
    ds_read_b64_tr_b16 v[60:61], v34 offset:40960
    ds_read_b64_tr_b16 v[62:63], v34 offset:41472
    ds_read_b64_tr_b16 v[64:65], v35 offset:32768
    ds_read_b64_tr_b16 v[66:67], v35 offset:33280
    ds_read_b64_tr_b16 v[68:69], v35 offset:40960
    ds_read_b64_tr_b16 v[70:71], v35 offset:41472
    s_waitcnt lgkmcnt(0)
    s_barrier
    ds_write_b128 v1, v[40:43] offset:16384
    ds_write_b128 v1, v[44:47] offset:20480
    ds_write_b128 v1, v[48:51] offset:24576
    ds_write_b128 v1, v[52:55] offset:28672
    ds_write_b128 v1, v[16:19] offset:32768
    ds_write_b128 v1, v[20:23] offset:36864
    ds_write_b128 v1, v[24:27] offset:40960
    ds_write_b128 v1, v[28:31] offset:45056
    ds_write_b128 v1, v[56:59] offset:49152
    ds_write_b128 v1, v[60:63] offset:53248
    ds_write_b128 v1, v[64:67] offset:57344
    ds_write_b128 v1, v[68:71] offset:61440
    s_waitcnt vmcnt(13)
    s_barrier
    ds_read_b64_tr_b16 v[40:41], v36 offset:0
    ds_read_b64_tr_b16 v[42:43], v36 offset:512
    ds_read_b64_tr_b16 v[44:45], v36 offset:8192
    ds_read_b64_tr_b16 v[46:47], v36 offset:8704
    ds_read_b64_tr_b16 v[48:49], v37 offset:0
    ds_read_b64_tr_b16 v[50:51], v37 offset:512
    ds_read_b64_tr_b16 v[52:53], v37 offset:8192
    ds_read_b64_tr_b16 v[54:55], v37 offset:8704
    ds_read_b64_tr_b16 v[16:17], v36 offset:16384
    ds_read_b64_tr_b16 v[18:19], v36 offset:16896
    ds_read_b64_tr_b16 v[20:21], v36 offset:24576
    ds_read_b64_tr_b16 v[22:23], v36 offset:25088
    ds_read_b64_tr_b16 v[24:25], v37 offset:16384
    ds_read_b64_tr_b16 v[26:27], v37 offset:16896
    ds_read_b64_tr_b16 v[28:29], v37 offset:24576
    ds_read_b64_tr_b16 v[30:31], v37 offset:25088
    ds_read_b64_tr_b16 v[56:57], v36 offset:32768
    ds_read_b64_tr_b16 v[58:59], v36 offset:33280
    ds_read_b64_tr_b16 v[60:61], v36 offset:40960
    ds_read_b64_tr_b16 v[62:63], v36 offset:41472
    ds_read_b64_tr_b16 v[64:65], v37 offset:32768
    ds_read_b64_tr_b16 v[66:67], v37 offset:33280
    ds_read_b64_tr_b16 v[68:69], v37 offset:40960
    ds_read_b64_tr_b16 v[70:71], v37 offset:41472
    v_readfirstlane_b32 s5, v10
    s_nop 0
    s_lshr_b32 s71, s5, 16
    s_and_b32 s5, s5, 0xffff
    s_min_u32 s5, s5, s71
    s_cmp_ge_u32 s5, s73
    s_cbranch_scc1 R_kv0ok
R_kv0:
    buffer_load_dword v10, off, s[8:11], s4 sc1
    s_add_u32 s74, s74, 1
    s_cmp_gt_u32 s74, 0x400000
    s_cbranch_scc1 L_exit
    s_waitcnt vmcnt(0)
    v_readfirstlane_b32 s5, v10
    s_nop 0
    s_lshr_b32 s71, s5, 16
    s_and_b32 s5, s5, 0xffff
    s_min_u32 s5, s5, s71
    s_cmp_lt_u32 s5, s73
    s_cbranch_scc1 R_kv0
R_kv0ok:
    v_lshlrev_b32 v10, 2, v1
    s_mov_b32 s70, 0x3880000
    buffer_load_dword v12, v10, s[8:11], s70 offen sc1
    s_mov_b32 s70, 0x3884000
    buffer_load_dword v12, v10, s[8:11], s70 offen sc1
    s_mov_b32 s70, 0x3888000
    buffer_load_dword v12, v10, s[8:11], s70 offen sc1
    s_mov_b32 s70, 0x388c000
    buffer_load_dword v12, v10, s[8:11], s70 offen sc1
    buffer_load_dword v10, v10, s[8:11], s54 offen
    s_waitcnt lgkmcnt(0)
    s_barrier
    ds_write_b128 v4, v[40:43] offset:0
    ds_write_b128 v4, v[44:47] offset:4096
    ds_write_b128 v4, v[48:51] offset:8192
    ds_write_b128 v4, v[52:55] offset:12288
    ds_write_b128 v4, v[16:19] offset:16384
    ds_write_b128 v4, v[20:23] offset:20480
    ds_write_b128 v4, v[24:27] offset:24576
    ds_write_b128 v4, v[28:31] offset:28672
    ds_write_b128 v4, v[56:59] offset:32768
    ds_write_b128 v4, v[60:63] offset:36864
    ds_write_b128 v4, v[64:67] offset:40960
    ds_write_b128 v4, v[68:71] offset:45056
    s_waitcnt vmcnt(5)
    s_barrier
    ds_read_b64_tr_b16 v[40:41], v38 offset:0
    ds_read_b64_tr_b16 v[42:43], v38 offset:512
    ds_read_b64_tr_b16 v[44:45], v38 offset:8192
    ds_read_b64_tr_b16 v[46:47], v38 offset:8704
    ds_read_b64_tr_b16 v[48:49], v39 offset:0
    ds_read_b64_tr_b16 v[50:51], v39 offset:512
    ds_read_b64_tr_b16 v[52:53], v39 offset:8192
    ds_read_b64_tr_b16 v[54:55], v39 offset:8704
    ds_read_b64_tr_b16 v[16:17], v38 offset:16384
    ds_read_b64_tr_b16 v[18:19], v38 offset:16896
    ds_read_b64_tr_b16 v[20:21], v38 offset:24576
    ds_read_b64_tr_b16 v[22:23], v38 offset:25088
    ds_read_b64_tr_b16 v[24:25], v39 offset:16384
    ds_read_b64_tr_b16 v[26:27], v39 offset:16896
    ds_read_b64_tr_b16 v[28:29], v39 offset:24576
    ds_read_b64_tr_b16 v[30:31], v39 offset:25088
    ds_read_b64_tr_b16 v[56:57], v38 offset:32768
    ds_read_b64_tr_b16 v[58:59], v38 offset:33280
    ds_read_b64_tr_b16 v[60:61], v38 offset:40960
    ds_read_b64_tr_b16 v[62:63], v38 offset:41472
    ds_read_b64_tr_b16 v[64:65], v39 offset:32768
    ds_read_b64_tr_b16 v[66:67], v39 offset:33280
    ds_read_b64_tr_b16 v[68:69], v39 offset:40960
    ds_read_b64_tr_b16 v[70:71], v39 offset:41472
    s_waitcnt lgkmcnt(0)
    s_barrier
    ds_write_b128 v4, v[40:43] offset:49152
    ds_write_b128 v4, v[44:47] offset:53248
    ds_write_b128 v4, v[48:51] offset:57344
    ds_write_b128 v4, v[52:55] offset:61440
    ds_write_b128 v5, v[16:19] offset:0
    ds_write_b128 v5, v[20:23] offset:4096
    ds_write_b128 v5, v[24:27] offset:8192
    ds_write_b128 v5, v[28:31] offset:12288
    ds_write_b128 v5, v[56:59] offset:16384
    ds_write_b128 v5, v[60:63] offset:20480
    ds_write_b128 v5, v[64:67] offset:24576
    ds_write_b128 v5, v[68:71] offset:28672
R_ready:
    v_readfirstlane_b32 s7, v73
    s_nop 0
    s_and_b32 s70, s7, 0xffff
    s_cmp_ge_u32 s70, 32
    s_cbranch_scc1 R_readyok
    buffer_load_dwordx4 v[72:75], off, s[32:35], 0 sc1
    s_add_u32 s74, s74, 1
    s_cmp_gt_u32 s74, 0x400000
    s_cbranch_scc1 L_exit
    s_waitcnt vmcnt(0)
    s_branch R_ready
R_readyok:
    s_waitcnt lgkmcnt(0)
    v_mov_b64 v[40:41], 0
    v_mov_b64 v[42:43], 0
    v_mov_b64 v[44:45], 0
    v_mov_b64 v[46:47], 0
    v_mov_b64 v[48:49], 0
    v_mov_b64 v[50:51], 0
    v_mov_b64 v[52:53], 0
    v_mov_b64 v[54:55], 0
    ds_write_b128 v1, v[40:43] offset:12288
    ds_read_b128 v[56:59], v1 offset:16384
    ds_read_b128 v[60:63], v1 offset:20480
    ds_read_b128 v[64:67], v1 offset:24576
    ds_read_b128 v[68:71], v1 offset:28672
    ds_read_b128 v[28:31], v1 offset:32768
    ds_read_b128 v[32:35], v1 offset:36864
    v_mov_b64 v[36:37], v[76:77]
    v_mov_b64 v[38:39], v[78:79]
    s_waitcnt vmcnt(0)
    v_mov_b64 v[72:73], 0
    v_mov_b64 v[74:75], 0
    v_mov_b64 v[76:77], 0
    v_mov_b64 v[78:79], 0
    v_bfe_u32 v12, v2, 5, 3
    v_cmp_eq_u32 s[18:19], 3, v12
    s_add_u32 s39, s38, 1
    s_mov_b32 s101, 0
    s_and_b32 s15, s39, 1
    s_waitcnt lgkmcnt(0)
    s_cmp_gt_u32 s7, 65535
    s_cbranch_scc1 G_step
    .p2align 6
    s_nop 0
R_step:
    s_waitcnt vmcnt(1)
R_step0:
    v_max3_u32 v12, v36, v37, v38
    v_max_u32 v12, v12, v39
    ds_write_b128 v1, v[36:39]
    v_cmp_eq_u32 vcc, -1, v12
    s_cbranch_vccnz R_fix0
R_ok0:
    s_mov_b32 m0, s75
    s_nop 0
    buffer_load_dwordx4 v1, s[8:11], s63 offen sc1 lds
    s_waitcnt lgkmcnt(0)
    s_barrier
    ds_read_b128 v[12:15], v2 offset:0
    ds_read_b128 v[20:23], v2 offset:2048
    s_mov_b32 m0, s13
    s_nop 0
    buffer_load_dword v3, s[8:11], s16 offen sc1 lds
    ds_read_b128 v[16:19], v2 offset:1024
    ds_read_b128 v[24:27], v2 offset:3072
    v_mul_u32_u24 v10, 1, v1
    s_waitcnt lgkmcnt(3)
    v_smfmac_f32_16x16x64_bf16 v[40:43], v[12:15], v[56:63], v0
    ds_read_b128 v[56:59], v1 offset:40960
    v_smfmac_f32_16x16x64_bf16 v[44:47], v[12:15], v[64:71], v0
    ds_read_b128 v[60:63], v1 offset:45056
    v_smfmac_f32_16x16x64_bf16 v[48:51], v[12:15], v[28:35], v0
    ds_read_b128 v[64:67], v1 offset:49152
    s_waitcnt lgkmcnt(3)
    v_smfmac_f32_16x16x64_bf16 v[72:75], v[12:15], a[0:7], v0
    ds_read_b128 v[68:71], v1 offset:53248
    v_smfmac_f32_16x16x64_bf16 v[76:79], v[12:15], a[8:15], v0
    v_smfmac_f32_16x16x64_bf16 v[48:51], v[20:23], v[176:183], v0
    s_waitcnt lgkmcnt(2)
    v_smfmac_f32_16x16x64_bf16 v[52:55], v[12:15], v[56:63], v0
    ds_read_b128 v[56:59], v1 offset:57344
    v_smfmac_f32_16x16x64_bf16 v[52:55], v[20:23], v[184:191], v0
    ds_read_b128 v[60:63], v1 offset:61440
    s_waitcnt lgkmcnt(2)
    v_smfmac_f32_16x16x64_bf16 v[40:43], v[20:23], v[64:71], v0
    ds_read_b128 v[64:67], v4 offset:0
    v_smfmac_f32_16x16x64_bf16 v[72:75], v[20:23], a[32:39], v0
    buffer_load_dwordx4 v[12:15], v1, s[8:11], s55 offen sc1
    v_smfmac_f32_16x16x64_bf16 v[76:79], v[20:23], a[40:47], v0
    ds_read_b128 v[68:71], v4 offset:4096
    s_waitcnt lgkmcnt(2)
    v_smfmac_f32_16x16x64_bf16 v[44:47], v[20:23], v[56:63], v0
    ds_read_b128 v[56:59], v4 offset:8192
    v_smfmac_f32_16x16x64_bf16 v[40:43], v[16:19], v[80:87], v0
    ds_read_b128 v[60:63], v4 offset:12288
    v_smfmac_f32_16x16x64_bf16 v[44:47], v[16:19], v[88:95], v0
    buffer_load_dwordx4 v[20:23], v1, s[8:11], s54 offen sc1
    s_waitcnt lgkmcnt(2)
    v_smfmac_f32_16x16x64_bf16 v[48:51], v[16:19], v[64:71], v0
    s_waitcnt vmcnt(2)
    ds_read_b128 v[36:39], v1 offset:4096
    v_smfmac_f32_16x16x64_bf16 v[72:75], v[16:19], a[16:23], v0
    ds_read_b32 v32, v3 offset:8192
    ds_read_b128 v[64:67], v4 offset:16384
    s_waitcnt lgkmcnt(3)
    v_smfmac_f32_16x16x64_bf16 v[52:55], v[16:19], v[56:63], v0
    ds_read_b128 v[68:71], v4 offset:20480
    v_smfmac_f32_16x16x64_bf16 v[76:79], v[16:19], a[24:31], v0
    s_add_u32 s70, s54, 0x80000
    buffer_load_dword v10, v10, s[8:11], s70 offen
    ds_read_b128 v[56:59], v4 offset:24576
    v_smfmac_f32_16x16x64_bf16 v[40:43], v[24:27], v[96:103], v0
    ds_read_b128 v[60:63], v4 offset:28672
    s_waitcnt lgkmcnt(4)
    v_max3_u32 v36, v36, v37, v38
    v_max3_u32 v36, v36, v39, v32
    v_smfmac_f32_16x16x64_bf16 v[44:47], v[24:27], v[104:111], v0
    s_waitcnt lgkmcnt(2)
    v_cmp_eq_u32 vcc, -1, v36
    v_smfmac_f32_16x16x64_bf16 v[48:51], v[24:27], v[64:71], v0
    ds_read_b128 v[64:67], v4 offset:32768
    ds_read_b128 v[68:71], v4 offset:36864
    v_smfmac_f32_16x16x64_bf16 v[72:75], v[24:27], a[48:55], v0
    s_cbranch_vccnz R_fix1
R_ok1:
    s_barrier
    ds_read_b128 v[32:35], v2 offset:5120
    v_smfmac_f32_16x16x64_bf16 v[76:79], v[24:27], a[56:63], v0
    ds_read_b128 v[16:19], v2 offset:7168
    s_waitcnt lgkmcnt(4)
    v_smfmac_f32_16x16x64_bf16 v[52:55], v[24:27], v[56:63], v0
    ds_read_b128 v[28:31], v2 offset:4096
    ds_read_b128 v[36:39], v2 offset:6144
    ds_read_b128 v[24:27], v2 offset:8192
    s_mov_b64 vcc, s[40:41]
    s_waitcnt lgkmcnt(4)
    v_smfmac_f32_16x16x64_bf16 v[40:43], v[32:35], v[128:135], v0
    ds_read_b128 v[56:59], v4 offset:40960
    s_waitcnt lgkmcnt(4)
    v_smfmac_f32_16x16x64_bf16 v[40:43], v[16:19], v[64:71], v0
    ds_read_b128 v[60:63], v4 offset:45056
    s_waitcnt lgkmcnt(4)
    v_smfmac_f32_16x16x64_bf16 v[40:43], v[28:31], v[112:119], v0
    v_smfmac_f32_16x16x64_bf16 v[44:47], v[32:35], v[136:143], v0
    s_waitcnt lgkmcnt(2)
    v_smfmac_f32_16x16x64_bf16 v[40:43], v[24:27], v[160:167], v0
    v_smfmac_f32_16x16x64_bf16 v[40:43], v[36:39], v[144:151], v0
    ds_read_b128 v[64:67], v4 offset:49152
    v_smfmac_f32_16x16x64_bf16 v[44:47], v[28:31], v[120:127], v0
    ds_read_b128 v[68:71], v4 offset:53248
    v_smfmac_f32_16x16x64_bf16 v[44:47], v[24:27], v[168:175], v0
    s_waitcnt lgkmcnt(2)
    v_smfmac_f32_16x16x64_bf16 v[44:47], v[16:19], v[56:63], v0
    ds_read_b128 v[56:59], v4 offset:57344
    s_nop 0
    v_add_f32 v40, v40, v42
    v_smfmac_f32_16x16x64_bf16 v[44:47], v[36:39], v[152:159], v0
    ds_read_b128 v[60:63], v4 offset:61440
    v_add_f32 v41, v41, v43
    v_smfmac_f32_16x16x64_bf16 v[48:51], v[28:31], v[192:199], v0
    s_waitcnt lgkmcnt(2)
    v_cvt_pk_bf16_f32 v42, v40, v41
    v_smfmac_f32_16x16x64_bf16 v[48:51], v[32:35], v[64:71], v0
    ds_write_b32 v6, v42 offset:12292
    s_nop 0
    v_add_f32 v44, v44, v46
    v_add_f32 v45, v45, v47
    v_smfmac_f32_16x16x64_bf16 v[48:51], v[16:19], v[224:231], v0
    buffer_load_dwordx4 v[66:69], v1, s[8:11], s57 offen sc1
    v_cvt_pk_bf16_f32 v43, v44, v45
    s_waitcnt lgkmcnt(1)
    v_smfmac_f32_16x16x64_bf16 v[52:55], v[32:35], v[56:63], v0
    ds_write_b32 v6, v43 offset:12804
    ds_read_b64_tr_b16 v[40:41], v9 offset:12288
    v_smfmac_f32_16x16x64_bf16 v[48:51], v[24:27], v[240:247], v0
    ds_read_b64_tr_b16 v[42:43], v9 offset:12544
    v_mul_u32_u24 v64, 3, v1
    v_smfmac_f32_16x16x64_bf16 v[48:51], v[36:39], v[208:215], v0
    buffer_load_dwordx4 v[58:61], v1, s[8:11], s56 offen sc1
    v_smfmac_f32_16x16x64_bf16 v[52:55], v[28:31], v[200:207], v0
    s_add_u32 s70, s55, 0x80000
    s_sub_u32 s71, s4, s70
    v_writelane_b32 v64, s71, 0
    v_smfmac_f32_16x16x64_bf16 v[52:55], v[16:19], v[232:239], v0
    s_waitcnt vmcnt(3)
    s_waitcnt lgkmcnt(0)
    v_mfma_f32_16x16x32_bf16 v[44:47], v[20:23], v[40:43], 0
    v_add_f32 v48, v48, v50
    v_add_f32 v49, v49, v51
    v_mfma_f32_16x16x32_bf16 v[20:23], v[12:15], v[40:43], 0
    buffer_load_dword v10, v64, s[8:11], s70 offen sc1
    v_cvt_pk_bf16_f32 v50, v48, v49
    v_smfmac_f32_16x16x64_bf16 v[52:55], v[24:27], v[248:255], v0
    ds_write_b32 v7, v50 offset:12288
    v_mov_b32 v65, s101
    v_smfmac_f32_16x16x64_bf16 v[52:55], v[36:39], v[216:223], v0
    s_nop 1
    v_cndmask_b32_dpp v12, v44, v20, vcc quad_perm:[2,3,2,3] row_mask:0xf bank_mask:0xf
    v_cndmask_b32_dpp v13, v45, v21, vcc quad_perm:[2,3,2,3] row_mask:0xf bank_mask:0xf
    v_cndmask_b32_dpp v14, v46, v22, vcc quad_perm:[2,3,2,3] row_mask:0xf bank_mask:0xf
    v_cndmask_b32_dpp v15, v47, v23, vcc quad_perm:[2,3,2,3] row_mask:0xf bank_mask:0xf
    v_smfmac_f32_16x16x64_bf16 v[72:75], v[32:35], a[80:87], v0
    ds_write_b128 v1, v[12:15] offset:0
    v_add_f32 v52, v52, v54
    v_add_f32 v53, v53, v55
    v_cvt_pk_bf16_f32 v51, v52, v53
    v_smfmac_f32_16x16x64_bf16 v[76:79], v[32:35], a[88:95], v0
    ds_write_b32 v7, v51 offset:12800
    v_lshrrev_b32 v22, 1, v1
    v_smfmac_f32_16x16x64_bf16 v[72:75], v[28:31], a[64:71], v0
    ds_read_b64 v[22:23], v22 offset:10240
    v_mov_b64 v[20:21], v[50:51]
    v_smfmac_f32_16x16x64_bf16 v[76:79], v[28:31], a[72:79], v0
    buffer_store_dword v65, off, s[8:11], s12 sc1
    v_smfmac_f32_16x16x64_bf16 v[72:75], v[16:19], a[112:119], v0
    s_waitcnt lgkmcnt(1)
    s_barrier
    ds_read_b64_tr_b16 v[40:41], v8 offset:12288
    ds_read_b64_tr_b16 v[42:43], v8 offset:12544
    v_smfmac_f32_16x16x64_bf16 v[76:79], v[16:19], a[120:127], v0
    ds_read_b64_tr_b16 v[44:45], v8 offset:14336
    ds_read_b64_tr_b16 v[46:47], v8 offset:14592
    v_smfmac_f32_16x16x64_bf16 v[72:75], v[24:27], a[128:135], v0
    ds_read_b64_tr_b16 v[48:49], v8 offset:12800
    ds_read_b64_tr_b16 v[50:51], v8 offset:13056
    v_smfmac_f32_16x16x64_bf16 v[76:79], v[24:27], a[136:143], v0
    ds_read_b64_tr_b16 v[52:53], v8 offset:14848
    ds_read_b64_tr_b16 v[54:55], v8 offset:15104
    s_waitcnt lgkmcnt(6)
    v_mfma_f32_16x16x32_bf16 v[16:19], v[40:43], v[40:43], 0
    ds_read_b128 v[12:15], v2 offset:0
    s_waitcnt lgkmcnt(5)
    v_mfma_f32_16x16x32_bf16 v[16:19], v[44:47], v[44:47], v[16:19]
    ds_read_b128 v[32:35], v2 offset:1024
    s_waitcnt lgkmcnt(4)
    v_mfma_f32_16x16x32_bf16 v[16:19], v[48:51], v[48:51], v[16:19]
    ds_read_b128 v[28:31], v2 offset:2048
    s_waitcnt lgkmcnt(3)
    v_mfma_f32_16x16x32_bf16 v[16:19], v[52:55], v[52:55], v[16:19]
    ds_read_b128 v[24:27], v2 offset:3072
    v_smfmac_f32_16x16x64_bf16 v[72:75], v[36:39], a[96:103], v0
    buffer_store_dwordx4 v[20:23], v1, s[8:11], s58 offen sc1
    v_smfmac_f32_16x16x64_bf16 v[76:79], v[36:39], a[104:111], v0
    v_mov_b64 v[48:49], 0
    v_mov_b64 v[50:51], 0
    v_mov_b64 v[52:53], 0
    s_waitcnt lgkmcnt(0)
    v_pk_add_f32 v[12:13], v[12:13], v[32:33]
    v_pk_add_f32 v[14:15], v[14:15], v[34:35]
    v_pk_add_f32 v[12:13], v[12:13], v[28:29]
    v_pk_add_f32 v[14:15], v[14:15], v[30:31]
    v_pk_add_f32 v[12:13], v[12:13], v[24:25]
    v_pk_add_f32 v[14:15], v[14:15], v[26:27]
    v_cndmask_b32_dpp v17, v16, v17, vcc quad_perm:[2,3,2,3] row_mask:0xf bank_mask:0xf
    v_max3_f32 v19, v12, v13, v14
    v_max3_f32 v19, v19, v15, v17
    v_pk_add_f32 v[72:73], v[72:73], v[74:75]
    v_pk_add_f32 v[76:77], v[76:77], v[78:79]
    v_max_f32_dpp v19, v19, v19 quad_perm:[2,3,0,1] row_mask:0xf bank_mask:0xf
    v_mov_b32 v16, v19
    v_cvt_pk_bf16_f32 v56, v72, v73
    v_cvt_pk_bf16_f32 v62, v72, v73
    v_permlane16_swap_b32 v16, v19
    v_max_f32 v19, v16, v19
    v_mov_b32 v16, v19
    v_cvt_pk_bf16_f32 v64, v76, v77
    v_cvt_pk_bf16_f32 v70, v76, v77
    v_permlane32_swap_b32 v16, v19
    v_max_f32 v19, v16, v19
    v_mul_f32 v16, s68, v19
    v_pk_fma_f32 v[12:13], v[12:13], s[68:69], v[16:17] op_sel_hi:[1,1,0] neg_lo:[0,0,1] neg_hi:[0,0,1]
    v_pk_fma_f32 v[14:15], v[14:15], s[68:69], v[16:17] op_sel_hi:[1,1,0] neg_lo:[0,0,1] neg_hi:[0,0,1]
    v_fma_f32 v17, v17, s68, -v16
    v_exp_f32 v12, v12
    v_exp_f32 v13, v13
    v_exp_f32 v14, v14
    v_exp_f32 v15, v15
    v_exp_f32 v17, v17
    v_cvt_pk_bf16_f32 v12, v12, v13
    v_cvt_pk_bf16_f32 v14, v14, v15
    v_cvt_pk_bf16_f32 v17, v17, 0
    v_cndmask_b32 v41, 0, v12, s[96:97]
    v_cndmask_b32 v42, v14, 0, s[96:97]
    v_cndmask_b32 v40, v12, v17, s[96:97]
    v_cndmask_b32 v43, v17, v14, s[96:97]
    v_mov_b64 v[44:45], s[98:99]
    v_mov_b64 v[46:47], s[98:99]
    v_mov_b64 v[54:55], 0
    v_mov_b32 v63, v64
    v_mfma_f32_16x16x32_bf16 v[12:15], v[40:43], v[44:47], 0
    s_waitcnt vmcnt(3)
    v_lshrrev_b32 v36, 1, v1
    v_smfmac_f32_16x16x64_bf16 v[48:51], v[40:43], v[56:63], v0 abid:1
    ds_write_b64 v36, v[62:63] offset:10240
    v_smfmac_f32_16x16x64_bf16 v[52:55], v[40:43], v[64:71], v0 abid:1
    s_cmp_eq_u32 s38, 63
    s_cbranch_scc1 R_done
    s_nop 0
    v_add_f32 v12, v12, v14
    v_add_f32 v13, v13, v15
    v_rcp_f32 v12, v12
    v_rcp_f32 v13, v13
    v_pk_add_f32 v[48:49], v[48:49], v[50:51]
    v_pk_mul_f32 v[48:49], v[48:49], v[12:13]
    v_cvt_pk_bf16_f32 v50, v48, v49
    v_cvt_pk_bf16_f32 v51, v48, v49
    v_pk_add_f32 v[52:53], v[52:53], v[54:55]
    ds_write_b64 v6, v[50:51] offset:6144
    v_pk_mul_f32 v[52:53], v[52:53], v[12:13]
    v_cvt_pk_bf16_f32 v54, v52, v53
    v_cvt_pk_bf16_f32 v55, v52, v53
    ds_write_b64 v6, v[54:55] offset:6656
    v_mov_b64 v[16:17], 0
    v_mov_b64 v[18:19], 0
    v_mov_b64 v[20:21], 0
    v_mov_b64 v[22:23], 0
    v_mov_b64 v[72:73], 0
    v_mov_b64 v[74:75], 0
    v_mov_b64 v[76:77], 0
    v_mov_b64 v[78:79], 0
    v_mov_b64 v[28:29], 0
    v_mov_b64 v[30:31], 0
    s_waitcnt lgkmcnt(0)
    s_barrier
    ds_read_b64_tr_b16 v[24:25], v8 offset:6144
    ds_read_b64_tr_b16 v[26:27], v8 offset:6400
    ds_read_b64_tr_b16 v[32:33], v8 offset:8192
    ds_read_b64_tr_b16 v[34:35], v8 offset:8448
    ds_read_b64_tr_b16 v[40:41], v8 offset:6656
    ds_read_b64_tr_b16 v[42:43], v8 offset:6912
    s_waitcnt lgkmcnt(4)
    v_smfmac_f32_16x16x64_bf16 v[16:19], v[24:27], a[144:151], v0
    ds_read_b64_tr_b16 v[44:45], v8 offset:8704
    v_smfmac_f32_16x16x64_bf16 v[20:23], v[24:27], a[176:183], v0
    ds_read_b64_tr_b16 v[46:47], v8 offset:8960
    s_waitcnt lgkmcnt(4)
    v_smfmac_f32_16x16x64_bf16 v[16:19], v[32:35], a[160:167], v0
    ds_read_b128 v[56:59], v5 offset:0
    v_smfmac_f32_16x16x64_bf16 v[20:23], v[32:35], a[192:199], v0
    ds_read_b128 v[60:63], v5 offset:4096
    s_waitcnt lgkmcnt(4)
    v_smfmac_f32_16x16x64_bf16 v[16:19], v[40:43], a[152:159], v0
    ds_read_b128 v[64:67], v5 offset:8192
    s_waitcnt lgkmcnt(3)
    v_smfmac_f32_16x16x64_bf16 v[16:19], v[44:47], a[168:175], v0
    ds_read_b128 v[68:71], v5 offset:12288
    v_mov_b32 v53, s39
    v_smfmac_f32_16x16x64_bf16 v[20:23], v[40:43], a[184:191], v0
    s_nop 0
    v_mov_b32 v12, 0xeeee4444
    v_smfmac_f32_16x16x64_bf16 v[20:23], v[44:47], a[200:207], v0
    s_nop 1
    v_smfmac_f32_16x16x64_bf16 v[72:75], v[32:35], a[208:215], v0
    s_waitcnt lgkmcnt(2)
    v_cvt_pk_bf16_f32 v36, v16, v17
    v_cvt_pk_bf16_f32 v37, v18, v19
    v_smfmac_f32_16x16x64_bf16 v[72:75], v[24:27], v[56:63], v0
    ds_read_b128 v[56:59], v5 offset:16384
    v_and_or_b32 v36, v36, -2, s15
    v_cvt_pk_bf16_f32 v38, v20, v21
    v_cvt_pk_bf16_f32 v39, v22, v23
    s_waitcnt lgkmcnt(1)
    v_smfmac_f32_16x16x64_bf16 v[72:75], v[40:43], v[64:71], v0
    buffer_store_dwordx4 v[36:39], v11, s[8:11], s59 offen
    v_smfmac_f32_16x16x64_bf16 v[72:75], v[44:47], a[216:223], v0
    ds_read_b128 v[60:63], v5 offset:20480
    ds_read_b128 v[64:67], v5 offset:24576
    v_smfmac_f32_16x16x64_bf16 v[76:79], v[24:27], a[224:231], v0
    ds_read_b128 v[68:71], v5 offset:28672
    v_lshrrev_b32 v54, 1, v11
    v_smfmac_f32_16x16x64_bf16 v[76:79], v[32:35], a[240:247], v0
    s_nop 1
    v_smfmac_f32_16x16x64_bf16 v[76:79], v[40:43], a[232:239], v0
    v_cvt_pk_bf16_f32 v48, v72, v73
    v_smfmac_f32_16x16x64_bf16 v[76:79], v[44:47], a[248:255], v0
    v_cvt_pk_bf16_f32 v49, v74, v75
    v_and_or_b32 v48, v48, -2, s15
    s_waitcnt lgkmcnt(2)
    v_smfmac_f32_16x16x64_bf16 v[28:31], v[24:27], v[56:63], v12
    s_nop 1
    v_smfmac_f32_16x16x64_bf16 v[28:31], v[32:35], v[56:63], v12 abid:1
    s_waitcnt lgkmcnt(0)
    v_cvt_pk_bf16_f32 v50, v76, v77
    v_cvt_pk_bf16_f32 v51, v78, v79
    v_smfmac_f32_16x16x64_bf16 v[28:31], v[40:43], v[64:71], v12
    buffer_store_dwordx4 v[48:51], v11, s[8:11], s65 offen
    v_smfmac_f32_16x16x64_bf16 v[28:31], v[44:47], v[64:71], v12 abid:1
    s_nop 7
    v_cvt_pk_bf16_f32 v52, v28, v29
    buffer_store_dwordx2 v[52:53], v54, s[8:11], s66 offen
    s_and_b32 s70, s39, 3
    s_lshl_b32 s70, s70, 14
    s_add_u32 s61, s100, s70
    s_add_u32 s62, s70, 0x3880000
    s_add_u32 s63, s70, 0x3881000
    s_add_u32 s16, s70, 0x3882000
    s_add_u32 s70, s70, 0x4000
    s_and_b32 s70, s70, 0xc000
    s_add_u32 s64, s67, s70
    ds_read_b128 v[56:59], v1 offset:16384
    ds_read_b128 v[60:63], v1 offset:20480
    ds_read_b128 v[64:67], v1 offset:24576
    ds_read_b128 v[68:71], v1 offset:28672
    ds_read_b128 v[28:31], v1 offset:32768
    ds_read_b128 v[32:35], v1 offset:36864
    s_add_u32 s54, s54, 0x80000
    s_add_u32 s55, s55, 0x80000
    s_add_u32 s56, s56, 0x80000
    s_add_u32 s57, s57, 0x80000
    s_add_u32 s58, s58, 0x20000
    s_mov_b32 s101, s38
    s_add_u32 s38, s38, 1
    s_add_u32 s39, s39, 1
    s_xor_b32 s15, s15, 1
    s_add_u32 s73, s38, s14
    s_min_u32 s73, s73, 64
    v_mov_b64 v[72:73], 0
    v_mov_b64 v[74:75], 0
    v_mov_b64 v[76:77], 0
    v_mov_b64 v[78:79], 0
    s_cmp_eq_u32 s36, 3
    s_cbranch_scc1 R_w3
    s_add_u32 s72, s74, 1
    v_mov_b32 v16, 0x3f80
    v_mov_b32 v17, 0x3f800000
    v_cndmask_b32 v16, v16, v17, s[52:53]
    v_cndmask_b32 v20, 0, v16, s[46:47]
    v_cndmask_b32 v21, 0, v16, s[48:49]
    v_cndmask_b32 v22, 0, v16, s[50:51]
    v_cndmask_b32 v23, 0, v16, s[18:19]
    v_and_b32 v12, 0x10, v2
    v_and_b32 v13, 0xe0, v2
    v_lshl_or_b32 v12, v13, 5, v12
    v_bfe_u32 v13, v2, 8, 1
    v_lshl_or_b32 v12, v13, 3, v12
    v_bfe_u32 v13, v2, 9, 1
    v_lshl_or_b32 v12, v13, 2, v12
    s_cmp_eq_u32 s36, 0
    s_cbranch_scc1 R_p1
    v_mov_b32 v15, 0
    s_nop 2
    v_mov_b32 v15, 0
    s_nop 2
    v_mov_b32 v15, 0
    s_nop 2
    v_mov_b32 v15, 0
    s_nop 2
    v_mov_b32 v15, 0
    s_nop 2
    v_mov_b32 v15, 0
    s_nop 2
    v_mov_b32 v15, 0
    s_nop 2
    v_mov_b32 v15, 0
    s_nop 2
    s_cmp_eq_u32 s36, 1
    s_cbranch_scc1 R_p1
    v_lshrrev_b32 v14, 1, v2
    v_mov_b32 v15, 0
    s_nop 2
    v_mov_b32 v15, 0
    s_nop 2
R_p1c:
    buffer_load_dwordx2 v[40:41], v14, s[8:11], s60 offen offset:0 sc1
    buffer_load_dwordx2 v[42:43], v14, s[8:11], s60 offen offset:512 sc1
    buffer_load_dwordx2 v[44:45], v14, s[8:11], s60 offen offset:1024 sc1
    buffer_load_dwordx2 v[46:47], v14, s[8:11], s60 offen offset:1536 sc1
    s_add_u32 s74, s74, 1
    s_cmp_gt_u32 s74, 0x400000
    s_cbranch_scc1 L_exit
    s_waitcnt vmcnt(3)
    v_cmp_ne_u32 vcc, s38, v41
    v_mfma_f32_16x16x16_bf16 v[16:19], v[40:41], v[20:21], 0
    s_cbranch_vccnz R_p1c
    s_waitcnt vmcnt(2)
    v_cmp_ne_u32 vcc, s38, v43
    v_mfma_f32_16x16x16_bf16 v[16:19], v[42:43], v[20:21], v[16:19]
    s_cbranch_vccnz R_p1c
    s_waitcnt vmcnt(1)
    v_cmp_ne_u32 vcc, s38, v45
    v_mfma_f32_16x16x16_bf16 v[16:19], v[44:45], v[20:21], v[16:19]
    s_cbranch_vccnz R_p1c
    s_waitcnt vmcnt(0)
    v_cmp_ne_u32 vcc, s38, v47
    v_mfma_f32_16x16x16_bf16 v[16:19], v[46:47], v[20:21], v[16:19]
    s_cbranch_vccnz R_p1c
    s_branch R_p1ok
R_p1:
    buffer_load_dwordx4 v[40:43], v2, s[8:11], s60 offen offset:0 sc1
    buffer_load_dwordx4 v[44:47], v2, s[8:11], s60 offen offset:1024 sc1
    buffer_load_dwordx4 v[48:51], v2, s[8:11], s60 offen offset:2048 sc1
    buffer_load_dwordx4 v[52:55], v2, s[8:11], s60 offen offset:3072 sc1
    s_add_u32 s74, s74, 1
    s_cmp_gt_u32 s74, 0x400000
    s_cbranch_scc1 L_exit
    s_waitcnt vmcnt(3)
    v_and_b32 v13, 1, v40
    v_cmp_eq_u32 vcc, s15, v13
    v_mfma_f32_16x16x32_bf16 v[16:19], v[40:43], v[20:23], 0
    s_cbranch_vccnz R_p1
    s_waitcnt vmcnt(2)
    v_and_b32 v13, 1, v44
    v_cmp_eq_u32 vcc, s15, v13
    v_mfma_f32_16x16x32_bf16 v[16:19], v[44:47], v[20:23], v[16:19]
    s_cbranch_vccnz R_p1
    s_waitcnt vmcnt(1)
    v_and_b32 v13, 1, v48
    v_cmp_eq_u32 vcc, s15, v13
    v_mfma_f32_16x16x32_bf16 v[16:19], v[48:51], v[20:23], v[16:19]
    s_cbranch_vccnz R_p1
    s_waitcnt vmcnt(0)
    v_and_b32 v13, 1, v52
    v_cmp_eq_u32 vcc, s15, v13
    v_mfma_f32_16x16x32_bf16 v[16:19], v[52:55], v[20:23], v[16:19]
    s_cbranch_vccnz R_p1
R_p1ok:
    s_nop 6
    v_permlane32_swap_b32 v16, v18
    v_permlane32_swap_b32 v17, v19
    v_pk_add_f32 v[16:17], v[16:17], v[18:19]
    v_cvt_pk_bf16_f32 v16, v16, v17
    s_mov_b64 exec, s[42:43]
    v_min_u32 v16, -2, v16
    buffer_store_dword v16, v12, s[8:11], s61 offen
    s_mov_b64 exec, -1
R_h2:
    s_barrier
    buffer_load_dwordx4 v[36:39], v1, s[8:11], s62 offen sc1
    v_mov_b64 v[40:41], 0
    v_mov_b64 v[42:43], 0
    v_mov_b64 v[44:45], 0
    v_mov_b64 v[46:47], 0
    v_mov_b64 v[48:49], 0
    v_mov_b64 v[50:51], 0
    v_mov_b64 v[52:53], 0
    v_mov_b64 v[54:55], 0
    v_mov_b32 v15, 0
    s_nop 2
    v_mov_b32 v15, 0
    s_nop 2
    v_mov_b32 v15, 0
    s_nop 2
    v_mov_b32 v15, 0
    s_nop 2
    buffer_load_dwordx4 v[36:39], v1, s[8:11], s62 offen sc1
    v_readfirstlane_b32 s5, v10
    s_nop 0
    s_lshr_b32 s71, s5, 16
    s_and_b32 s5, s5, 0xffff
    s_min_u32 s5, s5, s71
    s_cmp_ge_u32 s5, s73
    s_cbranch_scc1 R_step
R_kv1:
    buffer_load_dword v10, off, s[8:11], s4 sc1
    s_add_u32 s74, s74, 1
    s_cmp_gt_u32 s74, 0x400000
    s_cbranch_scc1 L_exit
    s_waitcnt vmcnt(0)
    v_readfirstlane_b32 s5, v10
    s_nop 0
    s_lshr_b32 s71, s5, 16
    s_and_b32 s5, s5, 0xffff
    s_min_u32 s5, s5, s71
    s_cmp_lt_u32 s5, s73
    s_cbranch_scc1 R_kv1
    s_branch R_step
R_w3:
    v_mov_b64 v[20:21], -1
    v_mov_b64 v[22:23], -1
    s_mov_b64 exec, s[44:45]
    buffer_store_dwordx4 v[20:23], v2, s[8:11], s64 offen
    s_mov_b64 exec, -1
    s_waitcnt vmcnt(1)
    s_branch R_h2
R_fix0:
    buffer_load_dwordx4 v[36:39], v1, s[8:11], s62 offen sc1
    s_add_u32 s74, s74, 1
    s_cmp_gt_u32 s74, 0x400000
    s_cbranch_scc1 L_exit
    s_waitcnt vmcnt(1)
    s_branch R_step0
R_fix1:
    s_mov_b32 m0, s75
    s_nop 0
    buffer_load_dwordx4 v1, s[8:11], s63 offen sc1 lds
    s_mov_b32 m0, s13
    s_nop 0
    buffer_load_dword v3, s[8:11], s16 offen sc1 lds
    s_add_u32 s74, s74, 1
    s_cmp_gt_u32 s74, 0x400000
    s_cbranch_scc1 L_exit
    s_waitcnt vmcnt(0)
    ds_read_b128 v[36:39], v1 offset:4096
    ds_read_b32 v32, v3 offset:8192
    s_waitcnt lgkmcnt(0)
    v_max3_u32 v36, v36, v37, v38
    v_max3_u32 v36, v36, v39, v32
    v_cmp_eq_u32 vcc, -1, v36
    s_cbranch_vccnz R_fix1
    s_branch R_ok1
R_done:
    v_mov_b32 v63, v64
    s_add_u32 s58, s58, 0x20000
    buffer_store_dwordx4 v[60:63], v1, s[8:11], s58 offen sc1
    s_waitcnt vmcnt(0)
    s_barrier
    s_cmp_lg_u32 s36, 3
    s_cbranch_scc1 L_exit
    v_mov_b32 v76, 64
    s_mov_b64 exec, 1
    buffer_store_dword v76, off, s[8:11], s6 sc1
    s_mov_b64 exec, -1
    s_waitcnt vmcnt(0)
    s_branch L_exit
    .p2align 6
    s_nop 0
G_step:
    s_waitcnt vmcnt(1)
G_step0:
    v_max3_u32 v12, v36, v37, v38
    v_max_u32 v12, v12, v39
    ds_write_b128 v1, v[36:39]
    v_cmp_eq_u32 vcc, -1, v12
    s_cbranch_vccnz G_fix0
G_ok0:
    s_mov_b32 m0, s75
    s_nop 0
    buffer_load_dwordx4 v1, s[8:11], s63 offen sc1 lds
    s_waitcnt lgkmcnt(0)
    s_barrier
    ds_read_b128 v[12:15], v2 offset:0
    ds_read_b128 v[20:23], v2 offset:2048
    s_mov_b32 m0, s13
    s_nop 0
    buffer_load_dword v3, s[8:11], s16 offen sc1 lds
    ds_read_b128 v[16:19], v2 offset:1024
    ds_read_b128 v[24:27], v2 offset:3072
    v_mul_u32_u24 v10, 1, v1
    s_waitcnt lgkmcnt(3)
    v_smfmac_f32_16x16x64_bf16 v[40:43], v[12:15], v[56:63], v0
    ds_read_b128 v[56:59], v1 offset:40960
    v_smfmac_f32_16x16x64_bf16 v[44:47], v[12:15], v[64:71], v0
    ds_read_b128 v[60:63], v1 offset:45056
    v_smfmac_f32_16x16x64_bf16 v[48:51], v[12:15], v[28:35], v0
    ds_read_b128 v[64:67], v1 offset:49152
    s_waitcnt lgkmcnt(3)
    v_smfmac_f32_16x16x64_bf16 v[72:75], v[12:15], a[0:7], v0
    ds_read_b128 v[68:71], v1 offset:53248
    v_smfmac_f32_16x16x64_bf16 v[76:79], v[12:15], a[8:15], v0
    v_smfmac_f32_16x16x64_bf16 v[48:51], v[20:23], v[176:183], v0
    s_waitcnt lgkmcnt(2)
    v_smfmac_f32_16x16x64_bf16 v[52:55], v[12:15], v[56:63], v0
    ds_read_b128 v[56:59], v1 offset:57344
    v_smfmac_f32_16x16x64_bf16 v[52:55], v[20:23], v[184:191], v0
    ds_read_b128 v[60:63], v1 offset:61440
    s_waitcnt lgkmcnt(2)
    v_smfmac_f32_16x16x64_bf16 v[40:43], v[20:23], v[64:71], v0
    ds_read_b128 v[64:67], v4 offset:0
    v_smfmac_f32_16x16x64_bf16 v[72:75], v[20:23], a[32:39], v0
    buffer_load_dwordx4 v[12:15], v1, s[8:11], s55 offen sc1
    v_smfmac_f32_16x16x64_bf16 v[76:79], v[20:23], a[40:47], v0
    ds_read_b128 v[68:71], v4 offset:4096
    s_waitcnt lgkmcnt(2)
    v_smfmac_f32_16x16x64_bf16 v[44:47], v[20:23], v[56:63], v0
    ds_read_b128 v[56:59], v4 offset:8192
    v_smfmac_f32_16x16x64_bf16 v[40:43], v[16:19], v[80:87], v0
    ds_read_b128 v[60:63], v4 offset:12288
    v_smfmac_f32_16x16x64_bf16 v[44:47], v[16:19], v[88:95], v0
    buffer_load_dwordx4 v[20:23], v1, s[8:11], s54 offen sc1
    s_waitcnt lgkmcnt(2)
    v_smfmac_f32_16x16x64_bf16 v[48:51], v[16:19], v[64:71], v0
    s_waitcnt vmcnt(2)
    ds_read_b128 v[36:39], v1 offset:4096
    v_smfmac_f32_16x16x64_bf16 v[72:75], v[16:19], a[16:23], v0
    ds_read_b32 v32, v3 offset:8192
    ds_read_b128 v[64:67], v4 offset:16384
    s_waitcnt lgkmcnt(3)
    v_smfmac_f32_16x16x64_bf16 v[52:55], v[16:19], v[56:63], v0
    ds_read_b128 v[68:71], v4 offset:20480
    v_smfmac_f32_16x16x64_bf16 v[76:79], v[16:19], a[24:31], v0
    s_add_u32 s70, s54, 0x80000
    buffer_load_dword v10, v10, s[8:11], s70 offen
    ds_read_b128 v[56:59], v4 offset:24576
    v_smfmac_f32_16x16x64_bf16 v[40:43], v[24:27], v[96:103], v0
    ds_read_b128 v[60:63], v4 offset:28672
    s_waitcnt lgkmcnt(4)
    v_max3_u32 v36, v36, v37, v38
    v_max3_u32 v36, v36, v39, v32
    v_smfmac_f32_16x16x64_bf16 v[44:47], v[24:27], v[104:111], v0
    s_waitcnt lgkmcnt(2)
    v_cmp_eq_u32 vcc, -1, v36
    v_smfmac_f32_16x16x64_bf16 v[48:51], v[24:27], v[64:71], v0
    ds_read_b128 v[64:67], v4 offset:32768
    ds_read_b128 v[68:71], v4 offset:36864
    v_smfmac_f32_16x16x64_bf16 v[72:75], v[24:27], a[48:55], v0
    s_cbranch_vccnz G_fix1
G_ok1:
    s_barrier
    ds_read_b128 v[32:35], v2 offset:5120
    v_smfmac_f32_16x16x64_bf16 v[76:79], v[24:27], a[56:63], v0
    ds_read_b128 v[16:19], v2 offset:7168
    s_waitcnt lgkmcnt(4)
    v_smfmac_f32_16x16x64_bf16 v[52:55], v[24:27], v[56:63], v0
    ds_read_b128 v[28:31], v2 offset:4096
    ds_read_b128 v[36:39], v2 offset:6144
    ds_read_b128 v[24:27], v2 offset:8192
    s_mov_b64 vcc, s[40:41]
    s_waitcnt lgkmcnt(4)
    v_smfmac_f32_16x16x64_bf16 v[40:43], v[32:35], v[128:135], v0
    ds_read_b128 v[56:59], v4 offset:40960
    s_waitcnt lgkmcnt(4)
    v_smfmac_f32_16x16x64_bf16 v[40:43], v[16:19], v[64:71], v0
    ds_read_b128 v[60:63], v4 offset:45056
    s_waitcnt lgkmcnt(4)
    v_smfmac_f32_16x16x64_bf16 v[40:43], v[28:31], v[112:119], v0
    v_smfmac_f32_16x16x64_bf16 v[44:47], v[32:35], v[136:143], v0
    s_waitcnt lgkmcnt(2)
    v_smfmac_f32_16x16x64_bf16 v[40:43], v[24:27], v[160:167], v0
    v_smfmac_f32_16x16x64_bf16 v[40:43], v[36:39], v[144:151], v0
    ds_read_b128 v[64:67], v4 offset:49152
    v_smfmac_f32_16x16x64_bf16 v[44:47], v[28:31], v[120:127], v0
    ds_read_b128 v[68:71], v4 offset:53248
    v_smfmac_f32_16x16x64_bf16 v[44:47], v[24:27], v[168:175], v0
    s_waitcnt lgkmcnt(2)
    v_smfmac_f32_16x16x64_bf16 v[44:47], v[16:19], v[56:63], v0
    ds_read_b128 v[56:59], v4 offset:57344
    s_nop 0
    v_add_f32 v40, v40, v42
    v_smfmac_f32_16x16x64_bf16 v[44:47], v[36:39], v[152:159], v0
    ds_read_b128 v[60:63], v4 offset:61440
    v_add_f32 v41, v41, v43
    v_smfmac_f32_16x16x64_bf16 v[48:51], v[28:31], v[192:199], v0
    s_waitcnt lgkmcnt(2)
    v_cvt_pk_bf16_f32 v42, v40, v41
    v_smfmac_f32_16x16x64_bf16 v[48:51], v[32:35], v[64:71], v0
    ds_write_b32 v6, v42 offset:12292
    s_nop 0
    v_add_f32 v44, v44, v46
    v_add_f32 v45, v45, v47
    v_smfmac_f32_16x16x64_bf16 v[48:51], v[16:19], v[224:231], v0
    buffer_load_dwordx4 v[66:69], v1, s[8:11], s57 offen sc1
    v_cvt_pk_bf16_f32 v43, v44, v45
    s_waitcnt lgkmcnt(1)
    v_smfmac_f32_16x16x64_bf16 v[52:55], v[32:35], v[56:63], v0
    ds_write_b32 v6, v43 offset:12804
    ds_read_b64_tr_b16 v[40:41], v9 offset:12288
    v_smfmac_f32_16x16x64_bf16 v[48:51], v[24:27], v[240:247], v0
    ds_read_b64_tr_b16 v[42:43], v9 offset:12544
    v_mul_u32_u24 v64, 3, v1
    v_smfmac_f32_16x16x64_bf16 v[48:51], v[36:39], v[208:215], v0
    buffer_load_dwordx4 v[58:61], v1, s[8:11], s56 offen sc1
    v_smfmac_f32_16x16x64_bf16 v[52:55], v[28:31], v[200:207], v0
    s_add_u32 s70, s55, 0x80000
    s_sub_u32 s71, s4, s70
    v_writelane_b32 v64, s71, 0
    v_smfmac_f32_16x16x64_bf16 v[52:55], v[16:19], v[232:239], v0
    s_waitcnt vmcnt(3)
    s_waitcnt lgkmcnt(0)
    v_mfma_f32_16x16x32_bf16 v[44:47], v[20:23], v[40:43], 0
    v_add_f32 v48, v48, v50
    v_add_f32 v49, v49, v51
    v_mfma_f32_16x16x32_bf16 v[20:23], v[12:15], v[40:43], 0
    buffer_load_dword v10, v64, s[8:11], s70 offen sc1
    v_cvt_pk_bf16_f32 v50, v48, v49
    v_smfmac_f32_16x16x64_bf16 v[52:55], v[24:27], v[248:255], v0
    ds_write_b32 v7, v50 offset:12288
    v_mov_b32 v65, s101
    v_smfmac_f32_16x16x64_bf16 v[52:55], v[36:39], v[216:223], v0
    s_nop 1
    v_cndmask_b32_dpp v12, v44, v20, vcc quad_perm:[2,3,2,3] row_mask:0xf bank_mask:0xf
    v_cndmask_b32_dpp v13, v45, v21, vcc quad_perm:[2,3,2,3] row_mask:0xf bank_mask:0xf
    v_cndmask_b32_dpp v14, v46, v22, vcc quad_perm:[2,3,2,3] row_mask:0xf bank_mask:0xf
    v_cndmask_b32_dpp v15, v47, v23, vcc quad_perm:[2,3,2,3] row_mask:0xf bank_mask:0xf
    v_smfmac_f32_16x16x64_bf16 v[72:75], v[32:35], a[80:87], v0
    ds_write_b128 v1, v[12:15] offset:0
    v_add_f32 v52, v52, v54
    v_add_f32 v53, v53, v55
    v_cvt_pk_bf16_f32 v51, v52, v53
    v_smfmac_f32_16x16x64_bf16 v[76:79], v[32:35], a[88:95], v0
    ds_write_b32 v7, v51 offset:12800
    v_lshrrev_b32 v22, 1, v1
    v_smfmac_f32_16x16x64_bf16 v[72:75], v[28:31], a[64:71], v0
    ds_read_b64 v[22:23], v22 offset:10240
    v_mov_b64 v[20:21], v[50:51]
    v_smfmac_f32_16x16x64_bf16 v[76:79], v[28:31], a[72:79], v0
    buffer_store_dword v65, off, s[8:11], s12 sc1
    v_smfmac_f32_16x16x64_bf16 v[72:75], v[16:19], a[112:119], v0
    s_waitcnt lgkmcnt(1)
    s_barrier
    ds_read_b64_tr_b16 v[40:41], v8 offset:12288
    ds_read_b64_tr_b16 v[42:43], v8 offset:12544
    v_smfmac_f32_16x16x64_bf16 v[76:79], v[16:19], a[120:127], v0
    ds_read_b64_tr_b16 v[44:45], v8 offset:14336
    ds_read_b64_tr_b16 v[46:47], v8 offset:14592
    v_smfmac_f32_16x16x64_bf16 v[72:75], v[24:27], a[128:135], v0
    ds_read_b64_tr_b16 v[48:49], v8 offset:12800
    ds_read_b64_tr_b16 v[50:51], v8 offset:13056
    v_smfmac_f32_16x16x64_bf16 v[76:79], v[24:27], a[136:143], v0
    ds_read_b64_tr_b16 v[52:53], v8 offset:14848
    ds_read_b64_tr_b16 v[54:55], v8 offset:15104
    s_waitcnt lgkmcnt(6)
    v_mfma_f32_16x16x32_bf16 v[16:19], v[40:43], v[40:43], 0
    ds_read_b128 v[12:15], v2 offset:0
    s_waitcnt lgkmcnt(5)
    v_mfma_f32_16x16x32_bf16 v[16:19], v[44:47], v[44:47], v[16:19]
    ds_read_b128 v[32:35], v2 offset:1024
    s_waitcnt lgkmcnt(4)
    v_mfma_f32_16x16x32_bf16 v[16:19], v[48:51], v[48:51], v[16:19]
    ds_read_b128 v[28:31], v2 offset:2048
    s_waitcnt lgkmcnt(3)
    v_mfma_f32_16x16x32_bf16 v[16:19], v[52:55], v[52:55], v[16:19]
    ds_read_b128 v[24:27], v2 offset:3072
    v_smfmac_f32_16x16x64_bf16 v[72:75], v[36:39], a[96:103], v0
    buffer_store_dwordx4 v[20:23], v1, s[8:11], s58 offen sc1
    v_smfmac_f32_16x16x64_bf16 v[76:79], v[36:39], a[104:111], v0
    v_mov_b64 v[48:49], 0
    v_mov_b64 v[50:51], 0
    v_mov_b64 v[52:53], 0
    s_waitcnt lgkmcnt(0)
    v_pk_add_f32 v[12:13], v[12:13], v[32:33]
    v_pk_add_f32 v[14:15], v[14:15], v[34:35]
    v_pk_add_f32 v[12:13], v[12:13], v[28:29]
    v_pk_add_f32 v[14:15], v[14:15], v[30:31]
    v_pk_add_f32 v[12:13], v[12:13], v[24:25]
    v_pk_add_f32 v[14:15], v[14:15], v[26:27]
    v_cndmask_b32_dpp v17, v16, v17, vcc quad_perm:[2,3,2,3] row_mask:0xf bank_mask:0xf
    v_max3_f32 v19, v12, v13, v14
    v_max3_f32 v19, v19, v15, v17
    v_pk_add_f32 v[72:73], v[72:73], v[74:75]
    v_pk_add_f32 v[76:77], v[76:77], v[78:79]
    v_max_f32_dpp v19, v19, v19 quad_perm:[2,3,0,1] row_mask:0xf bank_mask:0xf
    v_mov_b32 v16, v19
    v_cvt_pk_bf16_f32 v56, v72, v73
    v_cvt_pk_bf16_f32 v62, v72, v73
    v_permlane16_swap_b32 v16, v19
    v_max_f32 v19, v16, v19
    v_mov_b32 v16, v19
    v_cvt_pk_bf16_f32 v64, v76, v77
    v_cvt_pk_bf16_f32 v70, v76, v77
    v_permlane32_swap_b32 v16, v19
    v_max_f32 v19, v16, v19
    v_mul_f32 v16, s68, v19
    v_pk_fma_f32 v[12:13], v[12:13], s[68:69], v[16:17] op_sel_hi:[1,1,0] neg_lo:[0,0,1] neg_hi:[0,0,1]
    v_pk_fma_f32 v[14:15], v[14:15], s[68:69], v[16:17] op_sel_hi:[1,1,0] neg_lo:[0,0,1] neg_hi:[0,0,1]
    v_fma_f32 v17, v17, s68, -v16
    v_exp_f32 v12, v12
    v_exp_f32 v13, v13
    v_exp_f32 v14, v14
    v_exp_f32 v15, v15
    v_exp_f32 v17, v17
    v_cvt_pk_bf16_f32 v12, v12, v13
    v_cvt_pk_bf16_f32 v14, v14, v15
    v_cvt_pk_bf16_f32 v17, v17, 0
    v_cndmask_b32 v41, 0, v12, s[96:97]
    v_cndmask_b32 v42, v14, 0, s[96:97]
    v_cndmask_b32 v40, v12, v17, s[96:97]
    v_cndmask_b32 v43, v17, v14, s[96:97]
    v_mov_b64 v[44:45], s[98:99]
    v_mov_b64 v[46:47], s[98:99]
    v_mov_b64 v[54:55], 0
    v_mov_b32 v63, v64
    v_mfma_f32_16x16x32_bf16 v[12:15], v[40:43], v[44:47], 0
    s_waitcnt vmcnt(3)
    v_lshrrev_b32 v36, 1, v1
    v_smfmac_f32_16x16x64_bf16 v[48:51], v[40:43], v[56:63], v0 abid:1
    ds_write_b64 v36, v[62:63] offset:10240
    v_smfmac_f32_16x16x64_bf16 v[52:55], v[40:43], v[64:71], v0 abid:1
    s_cmp_eq_u32 s38, 63
    s_cbranch_scc1 G_done
    s_nop 0
    v_add_f32 v12, v12, v14
    v_add_f32 v13, v13, v15
    v_rcp_f32 v12, v12
    v_rcp_f32 v13, v13
    v_pk_add_f32 v[48:49], v[48:49], v[50:51]
    v_pk_mul_f32 v[48:49], v[48:49], v[12:13]
    v_cvt_pk_bf16_f32 v50, v48, v49
    v_cvt_pk_bf16_f32 v51, v48, v49
    v_pk_add_f32 v[52:53], v[52:53], v[54:55]
    ds_write_b64 v6, v[50:51] offset:6144
    v_pk_mul_f32 v[52:53], v[52:53], v[12:13]
    v_cvt_pk_bf16_f32 v54, v52, v53
    v_cvt_pk_bf16_f32 v55, v52, v53
    ds_write_b64 v6, v[54:55] offset:6656
    v_mov_b64 v[16:17], 0
    v_mov_b64 v[18:19], 0
    v_mov_b64 v[20:21], 0
    v_mov_b64 v[22:23], 0
    v_mov_b64 v[72:73], 0
    v_mov_b64 v[74:75], 0
    v_mov_b64 v[76:77], 0
    v_mov_b64 v[78:79], 0
    v_mov_b64 v[28:29], 0
    v_mov_b64 v[30:31], 0
    s_waitcnt lgkmcnt(0)
    s_barrier
    ds_read_b64_tr_b16 v[24:25], v8 offset:6144
    ds_read_b64_tr_b16 v[26:27], v8 offset:6400
    ds_read_b64_tr_b16 v[32:33], v8 offset:8192
    ds_read_b64_tr_b16 v[34:35], v8 offset:8448
    ds_read_b64_tr_b16 v[40:41], v8 offset:6656
    ds_read_b64_tr_b16 v[42:43], v8 offset:6912
    s_waitcnt lgkmcnt(4)
    v_smfmac_f32_16x16x64_bf16 v[16:19], v[24:27], a[144:151], v0
    ds_read_b64_tr_b16 v[44:45], v8 offset:8704
    v_smfmac_f32_16x16x64_bf16 v[20:23], v[24:27], a[176:183], v0
    ds_read_b64_tr_b16 v[46:47], v8 offset:8960
    s_waitcnt lgkmcnt(4)
    v_smfmac_f32_16x16x64_bf16 v[16:19], v[32:35], a[160:167], v0
    ds_read_b128 v[56:59], v5 offset:0
    v_smfmac_f32_16x16x64_bf16 v[20:23], v[32:35], a[192:199], v0
    ds_read_b128 v[60:63], v5 offset:4096
    s_waitcnt lgkmcnt(4)
    v_smfmac_f32_16x16x64_bf16 v[16:19], v[40:43], a[152:159], v0
    ds_read_b128 v[64:67], v5 offset:8192
    s_waitcnt lgkmcnt(3)
    v_smfmac_f32_16x16x64_bf16 v[16:19], v[44:47], a[168:175], v0
    ds_read_b128 v[68:71], v5 offset:12288
    v_mov_b32 v53, s39
    v_smfmac_f32_16x16x64_bf16 v[20:23], v[40:43], a[184:191], v0
    s_nop 0
    v_mov_b32 v12, 0xeeee4444
    v_smfmac_f32_16x16x64_bf16 v[20:23], v[44:47], a[200:207], v0
    s_nop 1
    v_smfmac_f32_16x16x64_bf16 v[72:75], v[32:35], a[208:215], v0
    s_waitcnt lgkmcnt(2)
    v_cvt_pk_bf16_f32 v36, v16, v17
    v_cvt_pk_bf16_f32 v37, v18, v19
    v_smfmac_f32_16x16x64_bf16 v[72:75], v[24:27], v[56:63], v0
    ds_read_b128 v[56:59], v5 offset:16384
    v_and_or_b32 v36, v36, -2, s15
    v_cvt_pk_bf16_f32 v38, v20, v21
    v_cvt_pk_bf16_f32 v39, v22, v23
    s_waitcnt lgkmcnt(1)
    v_smfmac_f32_16x16x64_bf16 v[72:75], v[40:43], v[64:71], v0
    buffer_store_dwordx4 v[36:39], v11, s[8:11], s59 offen sc1
    v_smfmac_f32_16x16x64_bf16 v[72:75], v[44:47], a[216:223], v0
    ds_read_b128 v[60:63], v5 offset:20480
    ds_read_b128 v[64:67], v5 offset:24576
    v_smfmac_f32_16x16x64_bf16 v[76:79], v[24:27], a[224:231], v0
    ds_read_b128 v[68:71], v5 offset:28672
    v_lshrrev_b32 v54, 1, v11
    v_smfmac_f32_16x16x64_bf16 v[76:79], v[32:35], a[240:247], v0
    s_nop 1
    v_smfmac_f32_16x16x64_bf16 v[76:79], v[40:43], a[232:239], v0
    v_cvt_pk_bf16_f32 v48, v72, v73
    v_smfmac_f32_16x16x64_bf16 v[76:79], v[44:47], a[248:255], v0
    v_cvt_pk_bf16_f32 v49, v74, v75
    v_and_or_b32 v48, v48, -2, s15
    s_waitcnt lgkmcnt(2)
    v_smfmac_f32_16x16x64_bf16 v[28:31], v[24:27], v[56:63], v12
    s_nop 1
    v_smfmac_f32_16x16x64_bf16 v[28:31], v[32:35], v[56:63], v12 abid:1
    s_waitcnt lgkmcnt(0)
    v_cvt_pk_bf16_f32 v50, v76, v77
    v_cvt_pk_bf16_f32 v51, v78, v79
    v_smfmac_f32_16x16x64_bf16 v[28:31], v[40:43], v[64:71], v12
    buffer_store_dwordx4 v[48:51], v11, s[8:11], s65 offen sc1
    v_smfmac_f32_16x16x64_bf16 v[28:31], v[44:47], v[64:71], v12 abid:1
    s_nop 7
    v_cvt_pk_bf16_f32 v52, v28, v29
    buffer_store_dwordx2 v[52:53], v54, s[8:11], s66 offen sc1
    s_and_b32 s70, s39, 3
    s_lshl_b32 s70, s70, 14
    s_add_u32 s61, s100, s70
    s_add_u32 s62, s70, 0x3880000
    s_add_u32 s63, s70, 0x3881000
    s_add_u32 s16, s70, 0x3882000
    s_add_u32 s70, s70, 0x4000
    s_and_b32 s70, s70, 0xc000
    s_add_u32 s64, s67, s70
    ds_read_b128 v[56:59], v1 offset:16384
    ds_read_b128 v[60:63], v1 offset:20480
    ds_read_b128 v[64:67], v1 offset:24576
    ds_read_b128 v[68:71], v1 offset:28672
    ds_read_b128 v[28:31], v1 offset:32768
    ds_read_b128 v[32:35], v1 offset:36864
    s_add_u32 s54, s54, 0x80000
    s_add_u32 s55, s55, 0x80000
    s_add_u32 s56, s56, 0x80000
    s_add_u32 s57, s57, 0x80000
    s_add_u32 s58, s58, 0x20000
    s_mov_b32 s101, s38
    s_add_u32 s38, s38, 1
    s_add_u32 s39, s39, 1
    s_xor_b32 s15, s15, 1
    s_add_u32 s73, s38, s14
    s_min_u32 s73, s73, 64
    v_mov_b64 v[72:73], 0
    v_mov_b64 v[74:75], 0
    v_mov_b64 v[76:77], 0
    v_mov_b64 v[78:79], 0
    s_cmp_eq_u32 s36, 3
    s_cbranch_scc1 G_w3
    s_add_u32 s72, s74, 1
    v_mov_b32 v16, 0x3f80
    v_mov_b32 v17, 0x3f800000
    v_cndmask_b32 v16, v16, v17, s[52:53]
    v_cndmask_b32 v20, 0, v16, s[46:47]
    v_cndmask_b32 v21, 0, v16, s[48:49]
    v_cndmask_b32 v22, 0, v16, s[50:51]
    v_cndmask_b32 v23, 0, v16, s[18:19]
    v_and_b32 v12, 0x10, v2
    v_and_b32 v13, 0xe0, v2
    v_lshl_or_b32 v12, v13, 5, v12
    v_bfe_u32 v13, v2, 8, 1
    v_lshl_or_b32 v12, v13, 3, v12
    v_bfe_u32 v13, v2, 9, 1
    v_lshl_or_b32 v12, v13, 2, v12
    s_cmp_eq_u32 s36, 0
    s_cbranch_scc1 G_p1
    v_mov_b32 v15, 0
    s_nop 2
    v_mov_b32 v15, 0
    s_nop 2
    v_mov_b32 v15, 0
    s_nop 2
    v_mov_b32 v15, 0
    s_nop 2
    v_mov_b32 v15, 0
    s_nop 2
    v_mov_b32 v15, 0
    s_nop 2
    v_mov_b32 v15, 0
    s_nop 2
    v_mov_b32 v15, 0
    s_nop 2
    s_cmp_eq_u32 s36, 1
    s_cbranch_scc1 G_p1
    v_lshrrev_b32 v14, 1, v2
    v_mov_b32 v15, 0
    s_nop 2
    v_mov_b32 v15, 0
    s_nop 2
G_p1c:
    buffer_load_dwordx2 v[40:41], v14, s[8:11], s60 offen offset:0 sc1
    buffer_load_dwordx2 v[42:43], v14, s[8:11], s60 offen offset:512 sc1
    buffer_load_dwordx2 v[44:45], v14, s[8:11], s60 offen offset:1024 sc1
    buffer_load_dwordx2 v[46:47], v14, s[8:11], s60 offen offset:1536 sc1
    s_add_u32 s74, s74, 1
    s_cmp_gt_u32 s74, 0x400000
    s_cbranch_scc1 L_exit
    s_waitcnt vmcnt(3)
    v_cmp_ne_u32 vcc, s38, v41
    v_mfma_f32_16x16x16_bf16 v[16:19], v[40:41], v[20:21], 0
    s_cbranch_vccnz G_p1c
    s_waitcnt vmcnt(2)
    v_cmp_ne_u32 vcc, s38, v43
    v_mfma_f32_16x16x16_bf16 v[16:19], v[42:43], v[20:21], v[16:19]
    s_cbranch_vccnz G_p1c
    s_waitcnt vmcnt(1)
    v_cmp_ne_u32 vcc, s38, v45
    v_mfma_f32_16x16x16_bf16 v[16:19], v[44:45], v[20:21], v[16:19]
    s_cbranch_vccnz G_p1c
    s_waitcnt vmcnt(0)
    v_cmp_ne_u32 vcc, s38, v47
    v_mfma_f32_16x16x16_bf16 v[16:19], v[46:47], v[20:21], v[16:19]
    s_cbranch_vccnz G_p1c
    s_branch G_p1ok
G_p1:
    buffer_load_dwordx4 v[40:43], v2, s[8:11], s60 offen offset:0 sc1
    buffer_load_dwordx4 v[44:47], v2, s[8:11], s60 offen offset:1024 sc1
    buffer_load_dwordx4 v[48:51], v2, s[8:11], s60 offen offset:2048 sc1
    buffer_load_dwordx4 v[52:55], v2, s[8:11], s60 offen offset:3072 sc1
    s_add_u32 s74, s74, 1
    s_cmp_gt_u32 s74, 0x400000
    s_cbranch_scc1 L_exit
    s_waitcnt vmcnt(3)
    v_and_b32 v13, 1, v40
    v_cmp_eq_u32 vcc, s15, v13
    v_mfma_f32_16x16x32_bf16 v[16:19], v[40:43], v[20:23], 0
    s_cbranch_vccnz G_p1
    s_waitcnt vmcnt(2)
    v_and_b32 v13, 1, v44
    v_cmp_eq_u32 vcc, s15, v13
    v_mfma_f32_16x16x32_bf16 v[16:19], v[44:47], v[20:23], v[16:19]
    s_cbranch_vccnz G_p1
    s_waitcnt vmcnt(1)
    v_and_b32 v13, 1, v48
    v_cmp_eq_u32 vcc, s15, v13
    v_mfma_f32_16x16x32_bf16 v[16:19], v[48:51], v[20:23], v[16:19]
    s_cbranch_vccnz G_p1
    s_waitcnt vmcnt(0)
    v_and_b32 v13, 1, v52
    v_cmp_eq_u32 vcc, s15, v13
    v_mfma_f32_16x16x32_bf16 v[16:19], v[52:55], v[20:23], v[16:19]
    s_cbranch_vccnz G_p1
G_p1ok:
    s_nop 6
    v_permlane32_swap_b32 v16, v18
    v_permlane32_swap_b32 v17, v19
    v_pk_add_f32 v[16:17], v[16:17], v[18:19]
    v_cvt_pk_bf16_f32 v16, v16, v17
    s_mov_b64 exec, s[42:43]
    v_min_u32 v16, -2, v16
    buffer_store_dword v16, v12, s[8:11], s61 offen sc1
    s_mov_b64 exec, -1
G_h2:
    s_barrier
    buffer_load_dwordx4 v[36:39], v1, s[8:11], s62 offen sc1
    v_mov_b64 v[40:41], 0
    v_mov_b64 v[42:43], 0
    v_mov_b64 v[44:45], 0
    v_mov_b64 v[46:47], 0
    v_mov_b64 v[48:49], 0
    v_mov_b64 v[50:51], 0
    v_mov_b64 v[52:53], 0
    v_mov_b64 v[54:55], 0
    v_mov_b32 v15, 0
    s_nop 2
    v_mov_b32 v15, 0
    s_nop 2
    v_mov_b32 v15, 0
    s_nop 2
    v_mov_b32 v15, 0
    s_nop 2
    buffer_load_dwordx4 v[36:39], v1, s[8:11], s62 offen sc1
    v_readfirstlane_b32 s5, v10
    s_nop 0
    s_lshr_b32 s71, s5, 16
    s_and_b32 s5, s5, 0xffff
    s_min_u32 s5, s5, s71
    s_cmp_ge_u32 s5, s73
    s_cbranch_scc1 G_step
G_kv1:
    buffer_load_dword v10, off, s[8:11], s4 sc1
    s_add_u32 s74, s74, 1
    s_cmp_gt_u32 s74, 0x400000
    s_cbranch_scc1 L_exit
    s_waitcnt vmcnt(0)
    v_readfirstlane_b32 s5, v10
    s_nop 0
    s_lshr_b32 s71, s5, 16
    s_and_b32 s5, s5, 0xffff
    s_min_u32 s5, s5, s71
    s_cmp_lt_u32 s5, s73
    s_cbranch_scc1 G_kv1
    s_branch G_step
G_w3:
    v_mov_b64 v[20:21], -1
    v_mov_b64 v[22:23], -1
    s_mov_b64 exec, s[44:45]
    buffer_store_dwordx4 v[20:23], v2, s[8:11], s64 offen sc1
    s_mov_b64 exec, -1
    s_waitcnt vmcnt(1)
    s_branch G_h2
G_fix0:
    buffer_load_dwordx4 v[36:39], v1, s[8:11], s62 offen sc1
    s_add_u32 s74, s74, 1
    s_cmp_gt_u32 s74, 0x400000
    s_cbranch_scc1 L_exit
    s_waitcnt vmcnt(1)
    s_branch G_step0
G_fix1:
    s_mov_b32 m0, s75
    s_nop 0
    buffer_load_dwordx4 v1, s[8:11], s63 offen sc1 lds
    s_mov_b32 m0, s13
    s_nop 0
    buffer_load_dword v3, s[8:11], s16 offen sc1 lds
    s_add_u32 s74, s74, 1
    s_cmp_gt_u32 s74, 0x400000
    s_cbranch_scc1 L_exit
    s_waitcnt vmcnt(0)
    ds_read_b128 v[36:39], v1 offset:4096
    ds_read_b32 v32, v3 offset:8192
    s_waitcnt lgkmcnt(0)
    v_max3_u32 v36, v36, v37, v38
    v_max3_u32 v36, v36, v39, v32
    v_cmp_eq_u32 vcc, -1, v36
    s_cbranch_vccnz G_fix1
    s_branch G_ok1
G_done:
    v_mov_b32 v63, v64
    s_add_u32 s58, s58, 0x20000
    buffer_store_dwordx4 v[60:63], v1, s[8:11], s58 offen sc1
    s_waitcnt vmcnt(0)
    s_barrier
    s_cmp_lg_u32 s36, 3
    s_cbranch_scc1 L_exit
    v_mov_b32 v76, 64
    s_mov_b64 exec, 1
    buffer_store_dword v76, off, s[8:11], s6 sc1
    s_mov_b64 exec, -1
    s_waitcnt vmcnt(0)
    s_branch L_exit
L_worker:
    s_sub_u32 s3, s37, 33
    s_mov_b32 s38, 0
    s_mov_b32 s39, 1
    s_and_b32 s37, s3, 31
    s_cmp_lt_u32 s3, 32
    s_cbranch_scc1 W_K
    s_cmp_lt_u32 s3, 64
    s_cbranch_scc1 W_V
    s_cmp_lt_u32 s3, 118
    s_cbranch_scc1 W_B
    s_cmp_lt_u32 s3, 214
    s_cbranch_scc1 W_QA
    s_cmp_lt_u32 s3, 218
    s_cbranch_scc1 W_X2
    s_cmp_eq_u32 s3, -1
    s_cbranch_scc0 L_exit
    s_mov_b32 s3, 300
    s_load_dwordx2 s[28:29], s[0:1], 120
    v_lshrrev_b32 v1, 6, v0
    s_nop 0
    v_readfirstlane_b32 s36, v1
    v_and_b32 v1, 63, v0
    v_and_b32 v2, 15, v0
    v_bfe_u32 v3, v0, 4, 2
    v_lshlrev_b32 v4, 4, v0
    v_mov_b64 v[8:9], 0
    v_mov_b64 v[10:11], 0
    s_waitcnt lgkmcnt(0)
    s_mov_b32 s8, s28
    s_and_b32 s9, s29, 0xffff
    s_mov_b32 s10, 0x10000000
    s_mov_b32 s11, 0x20000
    s_mov_b32 s40, 61931520
    buffer_store_dwordx4 v[8:11], v4, s[8:11], s40 offen sc1
    s_mov_b32 s40, 61935616
    buffer_store_dwordx4 v[8:11], v4, s[8:11], s40 offen sc1
    s_mov_b32 s40, 61939712
    buffer_store_dwordx4 v[8:11], v4, s[8:11], s40 offen sc1
    s_mov_b32 s40, 61943808
    buffer_store_dwordx4 v[8:11], v4, s[8:11], s40 offen sc1
    s_waitcnt vmcnt(0)
    s_barrier
    s_cmp_lg_u32 s36, 0
    s_cbranch_scc1 OL_1
    s_mov_b64 exec, 1
    v_mov_b32 v8, 1
    buffer_atomic_add v8, off, s[32:35], 0 offset:8
    s_mov_b64 exec, -1
OL_1:
    s_waitcnt vmcnt(0)
    s_branch L_exit
W_K:
    s_load_dwordx2 s[4:5], s[0:1], 0
    s_load_dwordx2 s[6:7], s[0:1], 24
    s_load_dwordx2 s[28:29], s[0:1], 120
    v_lshrrev_b32 v1, 6, v0
    s_nop 0
    v_readfirstlane_b32 s36, v1
    v_and_b32 v1, 63, v0
    v_and_b32 v2, 15, v0
    v_bfe_u32 v3, v0, 4, 2
    v_lshlrev_b32 v4, 4, v0
    s_waitcnt lgkmcnt(0)
    s_mov_b32 s12, s4
    s_and_b32 s13, s5, 0xffff
    s_mov_b32 s14, 0x240000
    s_mov_b32 s15, 0x20000
    s_mov_b32 s16, s6
    s_and_b32 s17, s7, 0xffff
    s_mov_b32 s18, 0x480000
    s_mov_b32 s19, 0x20000
    s_mov_b32 s8, s28
    s_and_b32 s9, s29, 0xffff
    s_mov_b32 s10, 0x10000000
    s_mov_b32 s11, 0x20000
    s_lshl_b32 s43, s37, 8
    v_lshlrev_b32 v8, 2, v3
    v_xor_b32 v8, v8, v2
    v_lshlrev_b32 v8, 4, v8
    s_lshl_b32 s40, s36, 2
    v_add_u32 v9, s40, v3
    s_mov_b32 s41, 8192
    v_mul_lo_u32 v9, v9, s41
    v_add_u32 v8, v8, v9
    s_lshl_b32 s42, s36, 10
    s_add_u32 m0, s42, 0
    s_add_u32 s40, s43, 0
    buffer_load_dwordx4 v8, s[16:19], s40 offen lds
    s_add_u32 m0, s42, 4096
    s_add_u32 s40, s43, 131072
    buffer_load_dwordx4 v8, s[16:19], s40 offen lds
    s_add_u32 m0, s42, 8192
    s_add_u32 s40, s43, 262144
    buffer_load_dwordx4 v8, s[16:19], s40 offen lds
    s_add_u32 m0, s42, 12288
    s_add_u32 s40, s43, 393216
    buffer_load_dwordx4 v8, s[16:19], s40 offen lds
    s_add_u32 m0, s42, 16384
    s_add_u32 s40, s43, 524288
    buffer_load_dwordx4 v8, s[16:19], s40 offen lds
    s_add_u32 m0, s42, 20480
    s_add_u32 s40, s43, 655360
    buffer_load_dwordx4 v8, s[16:19], s40 offen lds
    s_add_u32 m0, s42, 24576
    s_add_u32 s40, s43, 786432
    buffer_load_dwordx4 v8, s[16:19], s40 offen lds
    s_add_u32 m0, s42, 28672
    s_add_u32 s40, s43, 917504
    buffer_load_dwordx4 v8, s[16:19], s40 offen lds
    s_add_u32 m0, s42, 32768
    s_add_u32 s40, s43, 1048576
    buffer_load_dwordx4 v8, s[16:19], s40 offen lds
    s_add_u32 m0, s42, 36864
    s_add_u32 s40, s43, 1179648
    buffer_load_dwordx4 v8, s[16:19], s40 offen lds
    s_add_u32 m0, s42, 40960
    s_add_u32 s40, s43, 1310720
    buffer_load_dwordx4 v8, s[16:19], s40 offen lds
    s_add_u32 m0, s42, 45056
    s_add_u32 s40, s43, 1441792
    buffer_load_dwordx4 v8, s[16:19], s40 offen lds
    s_add_u32 m0, s42, 49152
    s_add_u32 s40, s43, 1572864
    buffer_load_dwordx4 v8, s[16:19], s40 offen lds
    s_add_u32 m0, s42, 53248
    s_add_u32 s40, s43, 1703936
    buffer_load_dwordx4 v8, s[16:19], s40 offen lds
    s_add_u32 m0, s42, 57344
    s_add_u32 s40, s43, 1835008
    buffer_load_dwordx4 v8, s[16:19], s40 offen lds
    s_add_u32 m0, s42, 61440
    s_add_u32 s40, s43, 1966080
    buffer_load_dwordx4 v8, s[16:19], s40 offen lds
    s_add_u32 m0, s42, 65536
    s_add_u32 s40, s43, 2097152
    buffer_load_dwordx4 v8, s[16:19], s40 offen lds
    s_add_u32 m0, s42, 69632
    s_add_u32 s40, s43, 2228224
    buffer_load_dwordx4 v8, s[16:19], s40 offen lds
    s_add_u32 m0, s42, 73728
    s_add_u32 s40, s43, 2359296
    buffer_load_dwordx4 v8, s[16:19], s40 offen lds
    s_add_u32 m0, s42, 77824
    s_add_u32 s40, s43, 2490368
    buffer_load_dwordx4 v8, s[16:19], s40 offen lds
    s_add_u32 m0, s42, 81920
    s_add_u32 s40, s43, 2621440
    buffer_load_dwordx4 v8, s[16:19], s40 offen lds
    s_add_u32 m0, s42, 86016
    s_add_u32 s40, s43, 2752512
    buffer_load_dwordx4 v8, s[16:19], s40 offen lds
    s_add_u32 m0, s42, 90112
    s_add_u32 s40, s43, 2883584
    buffer_load_dwordx4 v8, s[16:19], s40 offen lds
    s_add_u32 m0, s42, 94208
    s_add_u32 s40, s43, 3014656
    buffer_load_dwordx4 v8, s[16:19], s40 offen lds
    s_add_u32 m0, s42, 98304
    s_add_u32 s40, s43, 3145728
    buffer_load_dwordx4 v8, s[16:19], s40 offen lds
    s_add_u32 m0, s42, 102400
    s_add_u32 s40, s43, 3276800
    buffer_load_dwordx4 v8, s[16:19], s40 offen lds
    s_add_u32 m0, s42, 106496
    s_add_u32 s40, s43, 3407872
    buffer_load_dwordx4 v8, s[16:19], s40 offen lds
    s_add_u32 m0, s42, 110592
    s_add_u32 s40, s43, 3538944
    buffer_load_dwordx4 v8, s[16:19], s40 offen lds
    s_add_u32 m0, s42, 114688
    s_add_u32 s40, s43, 3670016
    buffer_load_dwordx4 v8, s[16:19], s40 offen lds
    s_add_u32 m0, s42, 118784
    s_add_u32 s40, s43, 3801088
    buffer_load_dwordx4 v8, s[16:19], s40 offen lds
    s_add_u32 m0, s42, 122880
    s_add_u32 s40, s43, 3932160
    buffer_load_dwordx4 v8, s[16:19], s40 offen lds
    s_add_u32 m0, s42, 126976
    s_add_u32 s40, s43, 4063232
    buffer_load_dwordx4 v8, s[16:19], s40 offen lds
    s_add_u32 m0, s42, 131072
    s_add_u32 s40, s43, 4194304
    buffer_load_dwordx4 v8, s[16:19], s40 offen lds
    s_add_u32 m0, s42, 135168
    s_add_u32 s40, s43, 4325376
    buffer_load_dwordx4 v8, s[16:19], s40 offen lds
    s_add_u32 m0, s42, 139264
    s_add_u32 s40, s43, 4456448
    buffer_load_dwordx4 v8, s[16:19], s40 offen lds
    s_add_u32 m0, s42, 143360
    s_add_u32 s40, s43, 4587520
    buffer_load_dwordx4 v8, s[16:19], s40 offen lds
    v_lshrrev_b32 v9, 2, v2
    v_lshl_add_u32 v10, v3, 3, v9
    v_lshlrev_b32 v10, 8, v10
    v_xor_b32 v9, s36, v9
    v_lshl_or_b32 v10, v9, 6, v10
    v_and_b32 v9, 3, v2
    v_lshl_or_b32 v10, v9, 4, v10
    v_add_u32 v11, 0xc000, v10
    v_add_u32 v12, 0x18000, v10
    s_waitcnt vmcnt(0)
    s_barrier
    ds_read_b64_tr_b16 v[64:65], v10 offset:0
    ds_read_b64_tr_b16 v[66:67], v10 offset:1024
    ds_read_b64_tr_b16 v[68:69], v10 offset:8
    ds_read_b64_tr_b16 v[70:71], v10 offset:1032
    ds_read_b64_tr_b16 v[72:73], v10 offset:8192
    ds_read_b64_tr_b16 v[74:75], v10 offset:9216
    ds_read_b64_tr_b16 v[76:77], v10 offset:8200
    ds_read_b64_tr_b16 v[78:79], v10 offset:9224
    ds_read_b64_tr_b16 v[80:81], v10 offset:16384
    ds_read_b64_tr_b16 v[82:83], v10 offset:17408
    ds_read_b64_tr_b16 v[84:85], v10 offset:16392
    ds_read_b64_tr_b16 v[86:87], v10 offset:17416
    ds_read_b64_tr_b16 v[88:89], v10 offset:24576
    ds_read_b64_tr_b16 v[90:91], v10 offset:25600
    ds_read_b64_tr_b16 v[92:93], v10 offset:24584
    ds_read_b64_tr_b16 v[94:95], v10 offset:25608
    ds_read_b64_tr_b16 v[96:97], v10 offset:32768
    ds_read_b64_tr_b16 v[98:99], v10 offset:33792
    ds_read_b64_tr_b16 v[100:101], v10 offset:32776
    ds_read_b64_tr_b16 v[102:103], v10 offset:33800
    ds_read_b64_tr_b16 v[104:105], v10 offset:40960
    ds_read_b64_tr_b16 v[106:107], v10 offset:41984
    ds_read_b64_tr_b16 v[108:109], v10 offset:40968
    ds_read_b64_tr_b16 v[110:111], v10 offset:41992
    ds_read_b64_tr_b16 v[112:113], v11 offset:0
    ds_read_b64_tr_b16 v[114:115], v11 offset:1024
    ds_read_b64_tr_b16 v[116:117], v11 offset:8
    ds_read_b64_tr_b16 v[118:119], v11 offset:1032
    ds_read_b64_tr_b16 v[120:121], v11 offset:8192
    ds_read_b64_tr_b16 v[122:123], v11 offset:9216
    ds_read_b64_tr_b16 v[124:125], v11 offset:8200
    ds_read_b64_tr_b16 v[126:127], v11 offset:9224
    ds_read_b64_tr_b16 v[128:129], v11 offset:16384
    ds_read_b64_tr_b16 v[130:131], v11 offset:17408
    ds_read_b64_tr_b16 v[132:133], v11 offset:16392
    ds_read_b64_tr_b16 v[134:135], v11 offset:17416
    ds_read_b64_tr_b16 v[136:137], v11 offset:24576
    ds_read_b64_tr_b16 v[138:139], v11 offset:25600
    ds_read_b64_tr_b16 v[140:141], v11 offset:24584
    ds_read_b64_tr_b16 v[142:143], v11 offset:25608
    ds_read_b64_tr_b16 v[144:145], v11 offset:32768
    ds_read_b64_tr_b16 v[146:147], v11 offset:33792
    ds_read_b64_tr_b16 v[148:149], v11 offset:32776
    ds_read_b64_tr_b16 v[150:151], v11 offset:33800
    ds_read_b64_tr_b16 v[152:153], v11 offset:40960
    ds_read_b64_tr_b16 v[154:155], v11 offset:41984
    ds_read_b64_tr_b16 v[156:157], v11 offset:40968
    ds_read_b64_tr_b16 v[158:159], v11 offset:41992
    ds_read_b64_tr_b16 v[160:161], v12 offset:0
    ds_read_b64_tr_b16 v[162:163], v12 offset:1024
    ds_read_b64_tr_b16 v[164:165], v12 offset:8
    ds_read_b64_tr_b16 v[166:167], v12 offset:1032
    ds_read_b64_tr_b16 v[168:169], v12 offset:8192
    ds_read_b64_tr_b16 v[170:171], v12 offset:9216
    ds_read_b64_tr_b16 v[172:173], v12 offset:8200
    ds_read_b64_tr_b16 v[174:175], v12 offset:9224
    ds_read_b64_tr_b16 v[176:177], v12 offset:16384
    ds_read_b64_tr_b16 v[178:179], v12 offset:17408
    ds_read_b64_tr_b16 v[180:181], v12 offset:16392
    ds_read_b64_tr_b16 v[182:183], v12 offset:17416
    ds_read_b64_tr_b16 v[184:185], v12 offset:24576
    ds_read_b64_tr_b16 v[186:187], v12 offset:25600
    ds_read_b64_tr_b16 v[188:189], v12 offset:24584
    ds_read_b64_tr_b16 v[190:191], v12 offset:25608
    ds_read_b64_tr_b16 v[192:193], v12 offset:32768
    ds_read_b64_tr_b16 v[194:195], v12 offset:33792
    ds_read_b64_tr_b16 v[196:197], v12 offset:32776
    ds_read_b64_tr_b16 v[198:199], v12 offset:33800
    ds_read_b64_tr_b16 v[200:201], v12 offset:40960
    ds_read_b64_tr_b16 v[202:203], v12 offset:41984
    ds_read_b64_tr_b16 v[204:205], v12 offset:40968
    ds_read_b64_tr_b16 v[206:207], v12 offset:41992
    s_waitcnt lgkmcnt(0)
    s_barrier
    s_mov_b32 s68, 0
WT_2:
    buffer_load_dword v8, off, s[32:35], 0 offset:8 sc1
    s_waitcnt vmcnt(0)
    v_readfirstlane_b32 s70, v8
    s_nop 0
    s_cmp_ge_u32 s70, 1
    s_cbranch_scc1 WTX_3
    s_sleep 2
    s_add_u32 s68, s68, 1
    s_cmp_lt_u32 s68, 0x80000
    s_cbranch_scc1 WT_2
    s_branch L_exit
WTX_3:
    s_lshl_b32 s46, s37, 7
    s_add_u32 s46, s46, 61931520
    s_mov_b32 s69, 0
    v_lshrrev_b32 v8, 2, v1
    v_and_b32 v9, 3, v1
    v_lshrrev_b32 v10, 5, v1
    v_lshlrev_b32 v11, 1, v10
    v_xor_b32 v9, v9, v11
    v_bfe_u32 v11, v8, 1, 2
    v_lshlrev_b32 v11, 2, v11
    v_lshl_or_b32 v11, v10, 4, v11
    v_and_b32 v8, 1, v8
    v_or_b32 v8, v8, v11
    v_mul_u32_u24 v8, 1152, v8
    v_lshl_add_u32 v5, v9, 4, v8
    v_add_u32 v6, 2304, v5
    v_lshrrev_b32 v8, 3, v2
    v_lshlrev_b32 v8, 1, v8
    v_xor_b32 v8, v8, v3
    v_lshlrev_b32 v8, 4, v8
    v_lshl_or_b32 v7, v2, 6, v8
    s_cmp_ge_u32 s36, 2
    s_cselect_b64 vcc, -1, 0
    v_cndmask_b32 v5, v5, v6, vcc
    s_and_b32 s45, s36, 1
    s_mul_i32 s45, s45, 576
    s_mov_b32 s44, 0
    s_mov_b32 s42, 0
    s_mul_i32 s78, s38, 36864
    s_add_u32 s78, s78, s45
    s_mul_i32 s79, s36, 9216
    s_add_u32 s79, s79, s42
    s_add_u32 m0, s79, 0
    s_nop 0
    buffer_load_dwordx4 v5, s[12:15], s78 offen lds
    s_add_u32 m0, s79, 1024
    s_add_u32 s78, s78, 64
    buffer_load_dwordx4 v5, s[12:15], s78 offen lds
    s_add_u32 m0, s79, 2048
    s_add_u32 s78, s78, 64
    buffer_load_dwordx4 v5, s[12:15], s78 offen lds
    s_add_u32 m0, s79, 3072
    s_add_u32 s78, s78, 64
    buffer_load_dwordx4 v5, s[12:15], s78 offen lds
    s_add_u32 m0, s79, 4096
    s_add_u32 s78, s78, 64
    buffer_load_dwordx4 v5, s[12:15], s78 offen lds
    s_add_u32 m0, s79, 5120
    s_add_u32 s78, s78, 64
    buffer_load_dwordx4 v5, s[12:15], s78 offen lds
    s_add_u32 m0, s79, 6144
    s_add_u32 s78, s78, 64
    buffer_load_dwordx4 v5, s[12:15], s78 offen lds
    s_add_u32 m0, s79, 7168
    s_add_u32 s78, s78, 64
    buffer_load_dwordx4 v5, s[12:15], s78 offen lds
    s_add_u32 m0, s79, 8192
    s_add_u32 s78, s78, 64
    buffer_load_dwordx4 v5, s[12:15], s78 offen lds
    s_add_u32 s43, s38, s39
    s_mov_b32 s42, 36864
    s_mul_i32 s78, s43, 36864
    s_add_u32 s78, s78, s45
    s_mul_i32 s79, s36, 9216
    s_add_u32 s79, s79, s42
    s_add_u32 m0, s79, 0
    s_nop 0
    buffer_load_dwordx4 v5, s[12:15], s78 offen lds
    s_add_u32 m0, s79, 1024
    s_add_u32 s78, s78, 64
    buffer_load_dwordx4 v5, s[12:15], s78 offen lds
    s_add_u32 m0, s79, 2048
    s_add_u32 s78, s78, 64
    buffer_load_dwordx4 v5, s[12:15], s78 offen lds
    s_add_u32 m0, s79, 3072
    s_add_u32 s78, s78, 64
    buffer_load_dwordx4 v5, s[12:15], s78 offen lds
    s_add_u32 m0, s79, 4096
    s_add_u32 s78, s78, 64
    buffer_load_dwordx4 v5, s[12:15], s78 offen lds
    s_add_u32 m0, s79, 5120
    s_add_u32 s78, s78, 64
    buffer_load_dwordx4 v5, s[12:15], s78 offen lds
    s_add_u32 m0, s79, 6144
    s_add_u32 s78, s78, 64
    buffer_load_dwordx4 v5, s[12:15], s78 offen lds
    s_add_u32 m0, s79, 7168
    s_add_u32 s78, s78, 64
    buffer_load_dwordx4 v5, s[12:15], s78 offen lds
    s_add_u32 m0, s79, 8192
    s_add_u32 s78, s78, 64
    buffer_load_dwordx4 v5, s[12:15], s78 offen lds
    s_waitcnt vmcnt(9)
PK_loop:
    s_barrier
    s_max_u32 s47, s38, 1
    s_sub_u32 s47, s47, 1
    s_cmp_lg_u32 s36, 0
    s_cbranch_scc1 OL_4
    s_mov_b64 exec, 1
    v_mov_b32 v8, s47
    buffer_store_short v8, off, s[8:11], s46 offset:0 sc1
    s_mov_b64 exec, -1
OL_4:
    v_add_u32 v6, s44, v7
    s_add_u32 s42, s44, 73728
    s_cmp_ge_u32 s42, 110592
    s_cselect_b32 s43, 110592, 0
    s_sub_u32 s42, s42, s43
    s_lshl_b32 s43, s39, 1
    s_add_u32 s43, s43, s38
    s_mul_i32 s78, s43, 36864
    s_add_u32 s78, s78, s45
    s_mul_i32 s79, s36, 9216
    s_add_u32 s79, s79, s42
    s_add_u32 s44, s44, 36864
    s_cmp_ge_u32 s44, 110592
    s_cselect_b32 s44, 0, s44
    ds_read_b128 v[32:35], v6 offset:0
    ds_read_b128 v[36:39], v6 offset:18432
    ds_read_b128 v[40:43], v6 offset:1024
    ds_read_b128 v[44:47], v6 offset:19456
    ds_read_b128 v[48:51], v6 offset:2048
    ds_read_b128 v[52:55], v6 offset:20480
    s_waitcnt lgkmcnt(5)
    v_mfma_f32_16x16x32_bf16 v[16:19], v[64:67], v[32:35], 0
    ds_read_b128 v[56:59], v6 offset:3072
    v_mfma_f32_16x16x32_bf16 v[20:23], v[68:71], v[32:35], 0
    s_waitcnt lgkmcnt(5)
    v_mfma_f32_16x16x32_bf16 v[24:27], v[64:67], v[36:39], 0
    ds_read_b128 v[60:63], v6 offset:21504
    v_mfma_f32_16x16x32_bf16 v[28:31], v[68:71], v[36:39], 0
    s_add_u32 m0, s79, 0
    s_nop 0
    buffer_load_dwordx4 v5, s[12:15], s78 offen lds
    s_waitcnt lgkmcnt(5)
    v_mfma_f32_16x16x32_bf16 v[16:19], v[72:75], v[40:43], v[16:19]
    ds_read_b128 v[32:35], v6 offset:4096
    v_mfma_f32_16x16x32_bf16 v[20:23], v[76:79], v[40:43], v[20:23]
    s_waitcnt lgkmcnt(5)
    v_mfma_f32_16x16x32_bf16 v[24:27], v[72:75], v[44:47], v[24:27]
    ds_read_b128 v[36:39], v6 offset:22528
    v_mfma_f32_16x16x32_bf16 v[28:31], v[76:79], v[44:47], v[28:31]
    s_waitcnt lgkmcnt(5)
    v_mfma_f32_16x16x32_bf16 v[16:19], v[80:83], v[48:51], v[16:19]
    ds_read_b128 v[40:43], v6 offset:5120
    v_mfma_f32_16x16x32_bf16 v[20:23], v[84:87], v[48:51], v[20:23]
    s_add_u32 m0, s79, 1024
    s_add_u32 s78, s78, 64
    buffer_load_dwordx4 v5, s[12:15], s78 offen lds
    s_waitcnt lgkmcnt(5)
    v_mfma_f32_16x16x32_bf16 v[24:27], v[80:83], v[52:55], v[24:27]
    ds_read_b128 v[44:47], v6 offset:23552
    v_mfma_f32_16x16x32_bf16 v[28:31], v[84:87], v[52:55], v[28:31]
    s_waitcnt lgkmcnt(5)
    v_mfma_f32_16x16x32_bf16 v[16:19], v[88:91], v[56:59], v[16:19]
    ds_read_b128 v[48:51], v6 offset:6144
    v_mfma_f32_16x16x32_bf16 v[20:23], v[92:95], v[56:59], v[20:23]
    s_waitcnt lgkmcnt(5)
    v_mfma_f32_16x16x32_bf16 v[24:27], v[88:91], v[60:63], v[24:27]
    ds_read_b128 v[52:55], v6 offset:24576
    v_mfma_f32_16x16x32_bf16 v[28:31], v[92:95], v[60:63], v[28:31]
    s_add_u32 m0, s79, 2048
    s_add_u32 s78, s78, 64
    buffer_load_dwordx4 v5, s[12:15], s78 offen lds
    s_waitcnt lgkmcnt(5)
    v_mfma_f32_16x16x32_bf16 v[16:19], v[96:99], v[32:35], v[16:19]
    ds_read_b128 v[56:59], v6 offset:7168
    v_mfma_f32_16x16x32_bf16 v[20:23], v[100:103], v[32:35], v[20:23]
    s_waitcnt lgkmcnt(5)
    v_mfma_f32_16x16x32_bf16 v[24:27], v[96:99], v[36:39], v[24:27]
    ds_read_b128 v[60:63], v6 offset:25600
    v_mfma_f32_16x16x32_bf16 v[28:31], v[100:103], v[36:39], v[28:31]
    s_waitcnt lgkmcnt(5)
    v_mfma_f32_16x16x32_bf16 v[16:19], v[104:107], v[40:43], v[16:19]
    ds_read_b128 v[32:35], v6 offset:8192
    v_mfma_f32_16x16x32_bf16 v[20:23], v[108:111], v[40:43], v[20:23]
    s_add_u32 m0, s79, 3072
    s_add_u32 s78, s78, 64
    buffer_load_dwordx4 v5, s[12:15], s78 offen lds
    s_waitcnt lgkmcnt(5)
    v_mfma_f32_16x16x32_bf16 v[24:27], v[104:107], v[44:47], v[24:27]
    ds_read_b128 v[36:39], v6 offset:26624
    v_mfma_f32_16x16x32_bf16 v[28:31], v[108:111], v[44:47], v[28:31]
    s_waitcnt lgkmcnt(5)
    v_mfma_f32_16x16x32_bf16 v[16:19], v[112:115], v[48:51], v[16:19]
    ds_read_b128 v[40:43], v6 offset:9216
    v_mfma_f32_16x16x32_bf16 v[20:23], v[116:119], v[48:51], v[20:23]
    s_waitcnt lgkmcnt(5)
    v_mfma_f32_16x16x32_bf16 v[24:27], v[112:115], v[52:55], v[24:27]
    ds_read_b128 v[44:47], v6 offset:27648
    v_mfma_f32_16x16x32_bf16 v[28:31], v[116:119], v[52:55], v[28:31]
    s_add_u32 m0, s79, 4096
    s_add_u32 s78, s78, 64
    buffer_load_dwordx4 v5, s[12:15], s78 offen lds
    s_waitcnt lgkmcnt(5)
    v_mfma_f32_16x16x32_bf16 v[16:19], v[120:123], v[56:59], v[16:19]
    ds_read_b128 v[48:51], v6 offset:10240
    v_mfma_f32_16x16x32_bf16 v[20:23], v[124:127], v[56:59], v[20:23]
    s_waitcnt lgkmcnt(5)
    v_mfma_f32_16x16x32_bf16 v[24:27], v[120:123], v[60:63], v[24:27]
    ds_read_b128 v[52:55], v6 offset:28672
    v_mfma_f32_16x16x32_bf16 v[28:31], v[124:127], v[60:63], v[28:31]
    s_waitcnt lgkmcnt(5)
    v_mfma_f32_16x16x32_bf16 v[16:19], v[128:131], v[32:35], v[16:19]
    ds_read_b128 v[56:59], v6 offset:11264
    v_mfma_f32_16x16x32_bf16 v[20:23], v[132:135], v[32:35], v[20:23]
    s_add_u32 m0, s79, 5120
    s_add_u32 s78, s78, 64
    buffer_load_dwordx4 v5, s[12:15], s78 offen lds
    s_waitcnt lgkmcnt(5)
    v_mfma_f32_16x16x32_bf16 v[24:27], v[128:131], v[36:39], v[24:27]
    ds_read_b128 v[60:63], v6 offset:29696
    v_mfma_f32_16x16x32_bf16 v[28:31], v[132:135], v[36:39], v[28:31]
    s_waitcnt lgkmcnt(5)
    v_mfma_f32_16x16x32_bf16 v[16:19], v[136:139], v[40:43], v[16:19]
    ds_read_b128 v[32:35], v6 offset:12288
    v_mfma_f32_16x16x32_bf16 v[20:23], v[140:143], v[40:43], v[20:23]
    s_waitcnt lgkmcnt(5)
    v_mfma_f32_16x16x32_bf16 v[24:27], v[136:139], v[44:47], v[24:27]
    ds_read_b128 v[36:39], v6 offset:30720
    v_mfma_f32_16x16x32_bf16 v[28:31], v[140:143], v[44:47], v[28:31]
    s_add_u32 m0, s79, 6144
    s_add_u32 s78, s78, 64
    buffer_load_dwordx4 v5, s[12:15], s78 offen lds
    s_waitcnt lgkmcnt(5)
    v_mfma_f32_16x16x32_bf16 v[16:19], v[144:147], v[48:51], v[16:19]
    ds_read_b128 v[40:43], v6 offset:13312
    v_mfma_f32_16x16x32_bf16 v[20:23], v[148:151], v[48:51], v[20:23]
    s_waitcnt lgkmcnt(5)
    v_mfma_f32_16x16x32_bf16 v[24:27], v[144:147], v[52:55], v[24:27]
    ds_read_b128 v[44:47], v6 offset:31744
    v_mfma_f32_16x16x32_bf16 v[28:31], v[148:151], v[52:55], v[28:31]
    s_waitcnt lgkmcnt(5)
    v_mfma_f32_16x16x32_bf16 v[16:19], v[152:155], v[56:59], v[16:19]
    ds_read_b128 v[48:51], v6 offset:14336
    v_mfma_f32_16x16x32_bf16 v[20:23], v[156:159], v[56:59], v[20:23]
    s_add_u32 m0, s79, 7168
    s_add_u32 s78, s78, 64
    buffer_load_dwordx4 v5, s[12:15], s78 offen lds
    s_waitcnt lgkmcnt(5)
    v_mfma_f32_16x16x32_bf16 v[24:27], v[152:155], v[60:63], v[24:27]
    ds_read_b128 v[52:55], v6 offset:32768
    v_mfma_f32_16x16x32_bf16 v[28:31], v[156:159], v[60:63], v[28:31]
    s_waitcnt lgkmcnt(5)
    v_mfma_f32_16x16x32_bf16 v[16:19], v[160:163], v[32:35], v[16:19]
    ds_read_b128 v[56:59], v6 offset:15360
    v_mfma_f32_16x16x32_bf16 v[20:23], v[164:167], v[32:35], v[20:23]
    s_waitcnt lgkmcnt(5)
    v_mfma_f32_16x16x32_bf16 v[24:27], v[160:163], v[36:39], v[24:27]
    ds_read_b128 v[60:63], v6 offset:33792
    v_mfma_f32_16x16x32_bf16 v[28:31], v[164:167], v[36:39], v[28:31]
    s_add_u32 m0, s79, 8192
    s_add_u32 s78, s78, 64
    buffer_load_dwordx4 v5, s[12:15], s78 offen lds
    s_waitcnt lgkmcnt(5)
    v_mfma_f32_16x16x32_bf16 v[16:19], v[168:171], v[40:43], v[16:19]
    ds_read_b128 v[32:35], v6 offset:16384
    v_mfma_f32_16x16x32_bf16 v[20:23], v[172:175], v[40:43], v[20:23]
    s_waitcnt lgkmcnt(5)
    v_mfma_f32_16x16x32_bf16 v[24:27], v[168:171], v[44:47], v[24:27]
    ds_read_b128 v[36:39], v6 offset:34816
    v_mfma_f32_16x16x32_bf16 v[28:31], v[172:175], v[44:47], v[28:31]
    s_waitcnt lgkmcnt(5)
    v_mfma_f32_16x16x32_bf16 v[16:19], v[176:179], v[48:51], v[16:19]
    ds_read_b128 v[40:43], v6 offset:17408
    v_mfma_f32_16x16x32_bf16 v[20:23], v[180:183], v[48:51], v[20:23]
    s_waitcnt lgkmcnt(5)
    v_mfma_f32_16x16x32_bf16 v[24:27], v[176:179], v[52:55], v[24:27]
    ds_read_b128 v[44:47], v6 offset:35840
    v_mfma_f32_16x16x32_bf16 v[28:31], v[180:183], v[52:55], v[28:31]
    s_waitcnt lgkmcnt(5)
    v_mfma_f32_16x16x32_bf16 v[16:19], v[184:187], v[56:59], v[16:19]
    v_mfma_f32_16x16x32_bf16 v[20:23], v[188:191], v[56:59], v[20:23]
    s_waitcnt lgkmcnt(4)
    v_mfma_f32_16x16x32_bf16 v[24:27], v[184:187], v[60:63], v[24:27]
    v_mfma_f32_16x16x32_bf16 v[28:31], v[188:191], v[60:63], v[28:31]
    s_waitcnt lgkmcnt(3)
    v_mfma_f32_16x16x32_bf16 v[16:19], v[192:195], v[32:35], v[16:19]
    v_mfma_f32_16x16x32_bf16 v[20:23], v[196:199], v[32:35], v[20:23]
    s_waitcnt lgkmcnt(2)
    v_mfma_f32_16x16x32_bf16 v[24:27], v[192:195], v[36:39], v[24:27]
    v_mfma_f32_16x16x32_bf16 v[28:31], v[196:199], v[36:39], v[28:31]
    s_waitcnt lgkmcnt(1)
    v_mfma_f32_16x16x32_bf16 v[16:19], v[200:203], v[40:43], v[16:19]
    v_mfma_f32_16x16x32_bf16 v[20:23], v[204:207], v[40:43], v[20:23]
    s_waitcnt lgkmcnt(0)
    v_mfma_f32_16x16x32_bf16 v[24:27], v[200:203], v[44:47], v[24:27]
    v_mfma_f32_16x16x32_bf16 v[28:31], v[204:207], v[44:47], v[28:31]
    s_lshl_b32 s40, s38, 5
    s_add_u32 s40, s40, s37
    s_lshl_b32 s40, s40, 14
    s_add_u32 s40, s40, 0
    s_add_u32 s41, s40, 4096
    v_cvt_pk_bf16_f32 v8, v16, v17
    v_cvt_pk_bf16_f32 v9, v18, v19
    v_cvt_pk_bf16_f32 v10, v20, v21
    v_cvt_pk_bf16_f32 v11, v22, v23
    buffer_store_dwordx4 v[8:11], v4, s[8:11], s40 offen sc1
    v_cvt_pk_bf16_f32 v12, v24, v25
    v_cvt_pk_bf16_f32 v13, v26, v27
    v_cvt_pk_bf16_f32 v14, v28, v29
    v_cvt_pk_bf16_f32 v15, v30, v31
    buffer_store_dwordx4 v[12:15], v4, s[8:11], s41 offen sc1
    s_add_u32 s38, s38, s39
    s_waitcnt vmcnt(11)
    s_cmp_lt_u32 s38, 64
    s_cbranch_scc1 PK_loop
    s_waitcnt vmcnt(0)
    s_barrier
    s_cmp_lg_u32 s36, 0
    s_cbranch_scc1 OL_5
    s_mov_b64 exec, 1
    v_mov_b32 v8, 64
    buffer_store_short v8, off, s[8:11], s46 offset:0 sc1
    s_mov_b64 exec, -1
OL_5:
    s_waitcnt vmcnt(0)
    s_branch W_X0
W_V:
    s_load_dwordx2 s[4:5], s[0:1], 0
    s_load_dwordx2 s[6:7], s[0:1], 32
    s_load_dwordx2 s[28:29], s[0:1], 120
    v_lshrrev_b32 v1, 6, v0
    s_nop 0
    v_readfirstlane_b32 s36, v1
    v_and_b32 v1, 63, v0
    v_and_b32 v2, 15, v0
    v_bfe_u32 v3, v0, 4, 2
    v_lshlrev_b32 v4, 4, v0
    s_waitcnt lgkmcnt(0)
    s_mov_b32 s12, s4
    s_and_b32 s13, s5, 0xffff
    s_mov_b32 s14, 0x240000
    s_mov_b32 s15, 0x20000
    s_mov_b32 s16, s6
    s_and_b32 s17, s7, 0xffff
    s_mov_b32 s18, 0x480000
    s_mov_b32 s19, 0x20000
    s_mov_b32 s8, s28
    s_and_b32 s9, s29, 0xffff
    s_mov_b32 s10, 0x10000000
    s_mov_b32 s11, 0x20000
    s_lshl_b32 s43, s37, 8
    v_lshlrev_b32 v8, 2, v3
    v_xor_b32 v8, v8, v2
    v_lshlrev_b32 v8, 4, v8
    s_lshl_b32 s40, s36, 2
    v_add_u32 v9, s40, v3
    s_mov_b32 s41, 8192
    v_mul_lo_u32 v9, v9, s41
    v_add_u32 v8, v8, v9
    s_lshl_b32 s42, s36, 10
    s_add_u32 m0, s42, 0
    s_add_u32 s40, s43, 0
    buffer_load_dwordx4 v8, s[16:19], s40 offen lds
    s_add_u32 m0, s42, 4096
    s_add_u32 s40, s43, 131072
    buffer_load_dwordx4 v8, s[16:19], s40 offen lds
    s_add_u32 m0, s42, 8192
    s_add_u32 s40, s43, 262144
    buffer_load_dwordx4 v8, s[16:19], s40 offen lds
    s_add_u32 m0, s42, 12288
    s_add_u32 s40, s43, 393216
    buffer_load_dwordx4 v8, s[16:19], s40 offen lds
    s_add_u32 m0, s42, 16384
    s_add_u32 s40, s43, 524288
    buffer_load_dwordx4 v8, s[16:19], s40 offen lds
    s_add_u32 m0, s42, 20480
    s_add_u32 s40, s43, 655360
    buffer_load_dwordx4 v8, s[16:19], s40 offen lds
    s_add_u32 m0, s42, 24576
    s_add_u32 s40, s43, 786432
    buffer_load_dwordx4 v8, s[16:19], s40 offen lds
    s_add_u32 m0, s42, 28672
    s_add_u32 s40, s43, 917504
    buffer_load_dwordx4 v8, s[16:19], s40 offen lds
    s_add_u32 m0, s42, 32768
    s_add_u32 s40, s43, 1048576
    buffer_load_dwordx4 v8, s[16:19], s40 offen lds
    s_add_u32 m0, s42, 36864
    s_add_u32 s40, s43, 1179648
    buffer_load_dwordx4 v8, s[16:19], s40 offen lds
    s_add_u32 m0, s42, 40960
    s_add_u32 s40, s43, 1310720
    buffer_load_dwordx4 v8, s[16:19], s40 offen lds
    s_add_u32 m0, s42, 45056
    s_add_u32 s40, s43, 1441792
    buffer_load_dwordx4 v8, s[16:19], s40 offen lds
    s_add_u32 m0, s42, 49152
    s_add_u32 s40, s43, 1572864
    buffer_load_dwordx4 v8, s[16:19], s40 offen lds
    s_add_u32 m0, s42, 53248
    s_add_u32 s40, s43, 1703936
    buffer_load_dwordx4 v8, s[16:19], s40 offen lds
    s_add_u32 m0, s42, 57344
    s_add_u32 s40, s43, 1835008
    buffer_load_dwordx4 v8, s[16:19], s40 offen lds
    s_add_u32 m0, s42, 61440
    s_add_u32 s40, s43, 1966080
    buffer_load_dwordx4 v8, s[16:19], s40 offen lds
    s_add_u32 m0, s42, 65536
    s_add_u32 s40, s43, 2097152
    buffer_load_dwordx4 v8, s[16:19], s40 offen lds
    s_add_u32 m0, s42, 69632
    s_add_u32 s40, s43, 2228224
    buffer_load_dwordx4 v8, s[16:19], s40 offen lds
    s_add_u32 m0, s42, 73728
    s_add_u32 s40, s43, 2359296
    buffer_load_dwordx4 v8, s[16:19], s40 offen lds
    s_add_u32 m0, s42, 77824
    s_add_u32 s40, s43, 2490368
    buffer_load_dwordx4 v8, s[16:19], s40 offen lds
    s_add_u32 m0, s42, 81920
    s_add_u32 s40, s43, 2621440
    buffer_load_dwordx4 v8, s[16:19], s40 offen lds
    s_add_u32 m0, s42, 86016
    s_add_u32 s40, s43, 2752512
    buffer_load_dwordx4 v8, s[16:19], s40 offen lds
    s_add_u32 m0, s42, 90112
    s_add_u32 s40, s43, 2883584
    buffer_load_dwordx4 v8, s[16:19], s40 offen lds
    s_add_u32 m0, s42, 94208
    s_add_u32 s40, s43, 3014656
    buffer_load_dwordx4 v8, s[16:19], s40 offen lds
    s_add_u32 m0, s42, 98304
    s_add_u32 s40, s43, 3145728
    buffer_load_dwordx4 v8, s[16:19], s40 offen lds
    s_add_u32 m0, s42, 102400
    s_add_u32 s40, s43, 3276800
    buffer_load_dwordx4 v8, s[16:19], s40 offen lds
    s_add_u32 m0, s42, 106496
    s_add_u32 s40, s43, 3407872
    buffer_load_dwordx4 v8, s[16:19], s40 offen lds
    s_add_u32 m0, s42, 110592
    s_add_u32 s40, s43, 3538944
    buffer_load_dwordx4 v8, s[16:19], s40 offen lds
    s_add_u32 m0, s42, 114688
    s_add_u32 s40, s43, 3670016
    buffer_load_dwordx4 v8, s[16:19], s40 offen lds
    s_add_u32 m0, s42, 118784
    s_add_u32 s40, s43, 3801088
    buffer_load_dwordx4 v8, s[16:19], s40 offen lds
    s_add_u32 m0, s42, 122880
    s_add_u32 s40, s43, 3932160
    buffer_load_dwordx4 v8, s[16:19], s40 offen lds
    s_add_u32 m0, s42, 126976
    s_add_u32 s40, s43, 4063232
    buffer_load_dwordx4 v8, s[16:19], s40 offen lds
    s_add_u32 m0, s42, 131072
    s_add_u32 s40, s43, 4194304
    buffer_load_dwordx4 v8, s[16:19], s40 offen lds
    s_add_u32 m0, s42, 135168
    s_add_u32 s40, s43, 4325376
    buffer_load_dwordx4 v8, s[16:19], s40 offen lds
    s_add_u32 m0, s42, 139264
    s_add_u32 s40, s43, 4456448
    buffer_load_dwordx4 v8, s[16:19], s40 offen lds
    s_add_u32 m0, s42, 143360
    s_add_u32 s40, s43, 4587520
    buffer_load_dwordx4 v8, s[16:19], s40 offen lds
    v_lshrrev_b32 v9, 2, v2
    v_lshl_add_u32 v10, v3, 3, v9
    v_lshlrev_b32 v10, 8, v10
    v_xor_b32 v9, s36, v9
    v_lshl_or_b32 v10, v9, 6, v10
    v_and_b32 v9, 3, v2
    v_lshl_or_b32 v10, v9, 3, v10
    v_add_u32 v11, 0xc000, v10
    v_add_u32 v12, 0x18000, v10
    s_waitcnt vmcnt(0)
    s_barrier
    ds_read_b64_tr_b16 v[64:65], v10 offset:0
    ds_read_b64_tr_b16 v[66:67], v10 offset:1024
    ds_read_b64_tr_b16 v[68:69], v10 offset:32
    ds_read_b64_tr_b16 v[70:71], v10 offset:1056
    ds_read_b64_tr_b16 v[72:73], v10 offset:8192
    ds_read_b64_tr_b16 v[74:75], v10 offset:9216
    ds_read_b64_tr_b16 v[76:77], v10 offset:8224
    ds_read_b64_tr_b16 v[78:79], v10 offset:9248
    ds_read_b64_tr_b16 v[80:81], v10 offset:16384
    ds_read_b64_tr_b16 v[82:83], v10 offset:17408
    ds_read_b64_tr_b16 v[84:85], v10 offset:16416
    ds_read_b64_tr_b16 v[86:87], v10 offset:17440
    ds_read_b64_tr_b16 v[88:89], v10 offset:24576
    ds_read_b64_tr_b16 v[90:91], v10 offset:25600
    ds_read_b64_tr_b16 v[92:93], v10 offset:24608
    ds_read_b64_tr_b16 v[94:95], v10 offset:25632
    ds_read_b64_tr_b16 v[96:97], v10 offset:32768
    ds_read_b64_tr_b16 v[98:99], v10 offset:33792
    ds_read_b64_tr_b16 v[100:101], v10 offset:32800
    ds_read_b64_tr_b16 v[102:103], v10 offset:33824
    ds_read_b64_tr_b16 v[104:105], v10 offset:40960
    ds_read_b64_tr_b16 v[106:107], v10 offset:41984
    ds_read_b64_tr_b16 v[108:109], v10 offset:40992
    ds_read_b64_tr_b16 v[110:111], v10 offset:42016
    ds_read_b64_tr_b16 v[112:113], v11 offset:0
    ds_read_b64_tr_b16 v[114:115], v11 offset:1024
    ds_read_b64_tr_b16 v[116:117], v11 offset:32
    ds_read_b64_tr_b16 v[118:119], v11 offset:1056
    ds_read_b64_tr_b16 v[120:121], v11 offset:8192
    ds_read_b64_tr_b16 v[122:123], v11 offset:9216
    ds_read_b64_tr_b16 v[124:125], v11 offset:8224
    ds_read_b64_tr_b16 v[126:127], v11 offset:9248
    ds_read_b64_tr_b16 v[128:129], v11 offset:16384
    ds_read_b64_tr_b16 v[130:131], v11 offset:17408
    ds_read_b64_tr_b16 v[132:133], v11 offset:16416
    ds_read_b64_tr_b16 v[134:135], v11 offset:17440
    ds_read_b64_tr_b16 v[136:137], v11 offset:24576
    ds_read_b64_tr_b16 v[138:139], v11 offset:25600
    ds_read_b64_tr_b16 v[140:141], v11 offset:24608
    ds_read_b64_tr_b16 v[142:143], v11 offset:25632
    ds_read_b64_tr_b16 v[144:145], v11 offset:32768
    ds_read_b64_tr_b16 v[146:147], v11 offset:33792
    ds_read_b64_tr_b16 v[148:149], v11 offset:32800
    ds_read_b64_tr_b16 v[150:151], v11 offset:33824
    ds_read_b64_tr_b16 v[152:153], v11 offset:40960
    ds_read_b64_tr_b16 v[154:155], v11 offset:41984
    ds_read_b64_tr_b16 v[156:157], v11 offset:40992
    ds_read_b64_tr_b16 v[158:159], v11 offset:42016
    ds_read_b64_tr_b16 v[160:161], v12 offset:0
    ds_read_b64_tr_b16 v[162:163], v12 offset:1024
    ds_read_b64_tr_b16 v[164:165], v12 offset:32
    ds_read_b64_tr_b16 v[166:167], v12 offset:1056
    ds_read_b64_tr_b16 v[168:169], v12 offset:8192
    ds_read_b64_tr_b16 v[170:171], v12 offset:9216
    ds_read_b64_tr_b16 v[172:173], v12 offset:8224
    ds_read_b64_tr_b16 v[174:175], v12 offset:9248
    ds_read_b64_tr_b16 v[176:177], v12 offset:16384
    ds_read_b64_tr_b16 v[178:179], v12 offset:17408
    ds_read_b64_tr_b16 v[180:181], v12 offset:16416
    ds_read_b64_tr_b16 v[182:183], v12 offset:17440
    ds_read_b64_tr_b16 v[184:185], v12 offset:24576
    ds_read_b64_tr_b16 v[186:187], v12 offset:25600
    ds_read_b64_tr_b16 v[188:189], v12 offset:24608
    ds_read_b64_tr_b16 v[190:191], v12 offset:25632
    ds_read_b64_tr_b16 v[192:193], v12 offset:32768
    ds_read_b64_tr_b16 v[194:195], v12 offset:33792
    ds_read_b64_tr_b16 v[196:197], v12 offset:32800
    ds_read_b64_tr_b16 v[198:199], v12 offset:33824
    ds_read_b64_tr_b16 v[200:201], v12 offset:40960
    ds_read_b64_tr_b16 v[202:203], v12 offset:41984
    ds_read_b64_tr_b16 v[204:205], v12 offset:40992
    ds_read_b64_tr_b16 v[206:207], v12 offset:42016
    s_waitcnt lgkmcnt(0)
    s_barrier
    s_mov_b32 s68, 0
WT_6:
    buffer_load_dword v8, off, s[32:35], 0 offset:8 sc1
    s_waitcnt vmcnt(0)
    v_readfirstlane_b32 s70, v8
    s_nop 0
    s_cmp_ge_u32 s70, 1
    s_cbranch_scc1 WTX_7
    s_sleep 2
    s_add_u32 s68, s68, 1
    s_cmp_lt_u32 s68, 0x80000
    s_cbranch_scc1 WT_6
    s_branch L_exit
WTX_7:
    s_lshl_b32 s46, s37, 7
    s_add_u32 s46, s46, 61931520
    s_mov_b32 s69, 0
    v_lshrrev_b32 v8, 2, v1
    v_and_b32 v9, 3, v1
    v_lshrrev_b32 v10, 5, v1
    v_lshlrev_b32 v11, 1, v10
    v_xor_b32 v9, v9, v11
    v_mul_u32_u24 v8, 1152, v8
    v_lshl_add_u32 v5, v9, 4, v8
    v_add_u32 v6, 18432, v5
    v_lshrrev_b32 v8, 3, v2
    v_lshlrev_b32 v8, 1, v8
    v_xor_b32 v8, v8, v3
    v_lshlrev_b32 v8, 4, v8
    v_lshl_or_b32 v7, v2, 6, v8
    s_cmp_ge_u32 s36, 2
    s_cselect_b64 vcc, -1, 0
    v_cndmask_b32 v5, v5, v6, vcc
    s_and_b32 s45, s36, 1
    s_mul_i32 s45, s45, 576
    s_mov_b32 s44, 0
    s_mov_b32 s42, 0
    s_mul_i32 s78, s38, 36864
    s_add_u32 s78, s78, s45
    s_mul_i32 s79, s36, 9216
    s_add_u32 s79, s79, s42
    s_add_u32 m0, s79, 0
    s_nop 0
    buffer_load_dwordx4 v5, s[12:15], s78 offen lds
    s_add_u32 m0, s79, 1024
    s_add_u32 s78, s78, 64
    buffer_load_dwordx4 v5, s[12:15], s78 offen lds
    s_add_u32 m0, s79, 2048
    s_add_u32 s78, s78, 64
    buffer_load_dwordx4 v5, s[12:15], s78 offen lds
    s_add_u32 m0, s79, 3072
    s_add_u32 s78, s78, 64
    buffer_load_dwordx4 v5, s[12:15], s78 offen lds
    s_add_u32 m0, s79, 4096
    s_add_u32 s78, s78, 64
    buffer_load_dwordx4 v5, s[12:15], s78 offen lds
    s_add_u32 m0, s79, 5120
    s_add_u32 s78, s78, 64
    buffer_load_dwordx4 v5, s[12:15], s78 offen lds
    s_add_u32 m0, s79, 6144
    s_add_u32 s78, s78, 64
    buffer_load_dwordx4 v5, s[12:15], s78 offen lds
    s_add_u32 m0, s79, 7168
    s_add_u32 s78, s78, 64
    buffer_load_dwordx4 v5, s[12:15], s78 offen lds
    s_add_u32 m0, s79, 8192
    s_add_u32 s78, s78, 64
    buffer_load_dwordx4 v5, s[12:15], s78 offen lds
    s_add_u32 s43, s38, s39
    s_mov_b32 s42, 36864
    s_mul_i32 s78, s43, 36864
    s_add_u32 s78, s78, s45
    s_mul_i32 s79, s36, 9216
    s_add_u32 s79, s79, s42
    s_add_u32 m0, s79, 0
    s_nop 0
    buffer_load_dwordx4 v5, s[12:15], s78 offen lds
    s_add_u32 m0, s79, 1024
    s_add_u32 s78, s78, 64
    buffer_load_dwordx4 v5, s[12:15], s78 offen lds
    s_add_u32 m0, s79, 2048
    s_add_u32 s78, s78, 64
    buffer_load_dwordx4 v5, s[12:15], s78 offen lds
    s_add_u32 m0, s79, 3072
    s_add_u32 s78, s78, 64
    buffer_load_dwordx4 v5, s[12:15], s78 offen lds
    s_add_u32 m0, s79, 4096
    s_add_u32 s78, s78, 64
    buffer_load_dwordx4 v5, s[12:15], s78 offen lds
    s_add_u32 m0, s79, 5120
    s_add_u32 s78, s78, 64
    buffer_load_dwordx4 v5, s[12:15], s78 offen lds
    s_add_u32 m0, s79, 6144
    s_add_u32 s78, s78, 64
    buffer_load_dwordx4 v5, s[12:15], s78 offen lds
    s_add_u32 m0, s79, 7168
    s_add_u32 s78, s78, 64
    buffer_load_dwordx4 v5, s[12:15], s78 offen lds
    s_add_u32 m0, s79, 8192
    s_add_u32 s78, s78, 64
    buffer_load_dwordx4 v5, s[12:15], s78 offen lds
    s_waitcnt vmcnt(9)
PV_loop:
    s_barrier
    s_max_u32 s47, s38, 1
    s_sub_u32 s47, s47, 1
    s_cmp_lg_u32 s36, 0
    s_cbranch_scc1 OL_8
    s_mov_b64 exec, 1
    v_mov_b32 v8, s47
    buffer_store_short v8, off, s[8:11], s46 offset:2 sc1
    s_mov_b64 exec, -1
OL_8:
    v_add_u32 v6, s44, v7
    s_add_u32 s42, s44, 73728
    s_cmp_ge_u32 s42, 110592
    s_cselect_b32 s43, 110592, 0
    s_sub_u32 s42, s42, s43
    s_lshl_b32 s43, s39, 1
    s_add_u32 s43, s43, s38
    s_mul_i32 s78, s43, 36864
    s_add_u32 s78, s78, s45
    s_mul_i32 s79, s36, 9216
    s_add_u32 s79, s79, s42
    s_add_u32 s44, s44, 36864
    s_cmp_ge_u32 s44, 110592
    s_cselect_b32 s44, 0, s44
    ds_read_b128 v[32:35], v6 offset:0
    ds_read_b128 v[36:39], v6 offset:18432
    ds_read_b128 v[40:43], v6 offset:1024
    ds_read_b128 v[44:47], v6 offset:19456
    ds_read_b128 v[48:51], v6 offset:2048
    ds_read_b128 v[52:55], v6 offset:20480
    s_waitcnt lgkmcnt(5)
    v_mfma_f32_16x16x32_bf16 v[16:19], v[32:35], v[64:67], 0
    ds_read_b128 v[56:59], v6 offset:3072
    v_mfma_f32_16x16x32_bf16 v[20:23], v[32:35], v[68:71], 0
    s_waitcnt lgkmcnt(5)
    v_mfma_f32_16x16x32_bf16 v[24:27], v[36:39], v[64:67], 0
    ds_read_b128 v[60:63], v6 offset:21504
    v_mfma_f32_16x16x32_bf16 v[28:31], v[36:39], v[68:71], 0
    s_add_u32 m0, s79, 0
    s_nop 0
    buffer_load_dwordx4 v5, s[12:15], s78 offen lds
    s_waitcnt lgkmcnt(5)
    v_mfma_f32_16x16x32_bf16 v[16:19], v[40:43], v[72:75], v[16:19]
    ds_read_b128 v[32:35], v6 offset:4096
    v_mfma_f32_16x16x32_bf16 v[20:23], v[40:43], v[76:79], v[20:23]
    s_waitcnt lgkmcnt(5)
    v_mfma_f32_16x16x32_bf16 v[24:27], v[44:47], v[72:75], v[24:27]
    ds_read_b128 v[36:39], v6 offset:22528
    v_mfma_f32_16x16x32_bf16 v[28:31], v[44:47], v[76:79], v[28:31]
    s_waitcnt lgkmcnt(5)
    v_mfma_f32_16x16x32_bf16 v[16:19], v[48:51], v[80:83], v[16:19]
    ds_read_b128 v[40:43], v6 offset:5120
    v_mfma_f32_16x16x32_bf16 v[20:23], v[48:51], v[84:87], v[20:23]
    s_add_u32 m0, s79, 1024
    s_add_u32 s78, s78, 64
    buffer_load_dwordx4 v5, s[12:15], s78 offen lds
    s_waitcnt lgkmcnt(5)
    v_mfma_f32_16x16x32_bf16 v[24:27], v[52:55], v[80:83], v[24:27]
    ds_read_b128 v[44:47], v6 offset:23552
    v_mfma_f32_16x16x32_bf16 v[28:31], v[52:55], v[84:87], v[28:31]
    s_waitcnt lgkmcnt(5)
    v_mfma_f32_16x16x32_bf16 v[16:19], v[56:59], v[88:91], v[16:19]
    ds_read_b128 v[48:51], v6 offset:6144
    v_mfma_f32_16x16x32_bf16 v[20:23], v[56:59], v[92:95], v[20:23]
    s_waitcnt lgkmcnt(5)
    v_mfma_f32_16x16x32_bf16 v[24:27], v[60:63], v[88:91], v[24:27]
    ds_read_b128 v[52:55], v6 offset:24576
    v_mfma_f32_16x16x32_bf16 v[28:31], v[60:63], v[92:95], v[28:31]
    s_add_u32 m0, s79, 2048
    s_add_u32 s78, s78, 64
    buffer_load_dwordx4 v5, s[12:15], s78 offen lds
    s_waitcnt lgkmcnt(5)
    v_mfma_f32_16x16x32_bf16 v[16:19], v[32:35], v[96:99], v[16:19]
    ds_read_b128 v[56:59], v6 offset:7168
    v_mfma_f32_16x16x32_bf16 v[20:23], v[32:35], v[100:103], v[20:23]
    s_waitcnt lgkmcnt(5)
    v_mfma_f32_16x16x32_bf16 v[24:27], v[36:39], v[96:99], v[24:27]
    ds_read_b128 v[60:63], v6 offset:25600
    v_mfma_f32_16x16x32_bf16 v[28:31], v[36:39], v[100:103], v[28:31]
    s_waitcnt lgkmcnt(5)
    v_mfma_f32_16x16x32_bf16 v[16:19], v[40:43], v[104:107], v[16:19]
    ds_read_b128 v[32:35], v6 offset:8192
    v_mfma_f32_16x16x32_bf16 v[20:23], v[40:43], v[108:111], v[20:23]
    s_add_u32 m0, s79, 3072
    s_add_u32 s78, s78, 64
    buffer_load_dwordx4 v5, s[12:15], s78 offen lds
    s_waitcnt lgkmcnt(5)
    v_mfma_f32_16x16x32_bf16 v[24:27], v[44:47], v[104:107], v[24:27]
    ds_read_b128 v[36:39], v6 offset:26624
    v_mfma_f32_16x16x32_bf16 v[28:31], v[44:47], v[108:111], v[28:31]
    s_waitcnt lgkmcnt(5)
    v_mfma_f32_16x16x32_bf16 v[16:19], v[48:51], v[112:115], v[16:19]
    ds_read_b128 v[40:43], v6 offset:9216
    v_mfma_f32_16x16x32_bf16 v[20:23], v[48:51], v[116:119], v[20:23]
    s_waitcnt lgkmcnt(5)
    v_mfma_f32_16x16x32_bf16 v[24:27], v[52:55], v[112:115], v[24:27]
    ds_read_b128 v[44:47], v6 offset:27648
    v_mfma_f32_16x16x32_bf16 v[28:31], v[52:55], v[116:119], v[28:31]
    s_add_u32 m0, s79, 4096
    s_add_u32 s78, s78, 64
    buffer_load_dwordx4 v5, s[12:15], s78 offen lds
    s_waitcnt lgkmcnt(5)
    v_mfma_f32_16x16x32_bf16 v[16:19], v[56:59], v[120:123], v[16:19]
    ds_read_b128 v[48:51], v6 offset:10240
    v_mfma_f32_16x16x32_bf16 v[20:23], v[56:59], v[124:127], v[20:23]
    s_waitcnt lgkmcnt(5)
    v_mfma_f32_16x16x32_bf16 v[24:27], v[60:63], v[120:123], v[24:27]
    ds_read_b128 v[52:55], v6 offset:28672
    v_mfma_f32_16x16x32_bf16 v[28:31], v[60:63], v[124:127], v[28:31]
    s_waitcnt lgkmcnt(5)
    v_mfma_f32_16x16x32_bf16 v[16:19], v[32:35], v[128:131], v[16:19]
    ds_read_b128 v[56:59], v6 offset:11264
    v_mfma_f32_16x16x32_bf16 v[20:23], v[32:35], v[132:135], v[20:23]
    s_add_u32 m0, s79, 5120
    s_add_u32 s78, s78, 64
    buffer_load_dwordx4 v5, s[12:15], s78 offen lds
    s_waitcnt lgkmcnt(5)
    v_mfma_f32_16x16x32_bf16 v[24:27], v[36:39], v[128:131], v[24:27]
    ds_read_b128 v[60:63], v6 offset:29696
    v_mfma_f32_16x16x32_bf16 v[28:31], v[36:39], v[132:135], v[28:31]
    s_waitcnt lgkmcnt(5)
    v_mfma_f32_16x16x32_bf16 v[16:19], v[40:43], v[136:139], v[16:19]
    ds_read_b128 v[32:35], v6 offset:12288
    v_mfma_f32_16x16x32_bf16 v[20:23], v[40:43], v[140:143], v[20:23]
    s_waitcnt lgkmcnt(5)
    v_mfma_f32_16x16x32_bf16 v[24:27], v[44:47], v[136:139], v[24:27]
    ds_read_b128 v[36:39], v6 offset:30720
    v_mfma_f32_16x16x32_bf16 v[28:31], v[44:47], v[140:143], v[28:31]
    s_add_u32 m0, s79, 6144
    s_add_u32 s78, s78, 64
    buffer_load_dwordx4 v5, s[12:15], s78 offen lds
    s_waitcnt lgkmcnt(5)
    v_mfma_f32_16x16x32_bf16 v[16:19], v[48:51], v[144:147], v[16:19]
    ds_read_b128 v[40:43], v6 offset:13312
    v_mfma_f32_16x16x32_bf16 v[20:23], v[48:51], v[148:151], v[20:23]
    s_waitcnt lgkmcnt(5)
    v_mfma_f32_16x16x32_bf16 v[24:27], v[52:55], v[144:147], v[24:27]
    ds_read_b128 v[44:47], v6 offset:31744
    v_mfma_f32_16x16x32_bf16 v[28:31], v[52:55], v[148:151], v[28:31]
    s_waitcnt lgkmcnt(5)
    v_mfma_f32_16x16x32_bf16 v[16:19], v[56:59], v[152:155], v[16:19]
    ds_read_b128 v[48:51], v6 offset:14336
    v_mfma_f32_16x16x32_bf16 v[20:23], v[56:59], v[156:159], v[20:23]
    s_add_u32 m0, s79, 7168
    s_add_u32 s78, s78, 64
    buffer_load_dwordx4 v5, s[12:15], s78 offen lds
    s_waitcnt lgkmcnt(5)
    v_mfma_f32_16x16x32_bf16 v[24:27], v[60:63], v[152:155], v[24:27]
    ds_read_b128 v[52:55], v6 offset:32768
    v_mfma_f32_16x16x32_bf16 v[28:31], v[60:63], v[156:159], v[28:31]
    s_waitcnt lgkmcnt(5)
    v_mfma_f32_16x16x32_bf16 v[16:19], v[32:35], v[160:163], v[16:19]
    ds_read_b128 v[56:59], v6 offset:15360
    v_mfma_f32_16x16x32_bf16 v[20:23], v[32:35], v[164:167], v[20:23]
    s_waitcnt lgkmcnt(5)
    v_mfma_f32_16x16x32_bf16 v[24:27], v[36:39], v[160:163], v[24:27]
    ds_read_b128 v[60:63], v6 offset:33792
    v_mfma_f32_16x16x32_bf16 v[28:31], v[36:39], v[164:167], v[28:31]
    s_add_u32 m0, s79, 8192
    s_add_u32 s78, s78, 64
    buffer_load_dwordx4 v5, s[12:15], s78 offen lds
    s_waitcnt lgkmcnt(5)
    v_mfma_f32_16x16x32_bf16 v[16:19], v[40:43], v[168:171], v[16:19]
    ds_read_b128 v[32:35], v6 offset:16384
    v_mfma_f32_16x16x32_bf16 v[20:23], v[40:43], v[172:175], v[20:23]
    s_waitcnt lgkmcnt(5)
    v_mfma_f32_16x16x32_bf16 v[24:27], v[44:47], v[168:171], v[24:27]
    ds_read_b128 v[36:39], v6 offset:34816
    v_mfma_f32_16x16x32_bf16 v[28:31], v[44:47], v[172:175], v[28:31]
    s_waitcnt lgkmcnt(5)
    v_mfma_f32_16x16x32_bf16 v[16:19], v[48:51], v[176:179], v[16:19]
    ds_read_b128 v[40:43], v6 offset:17408
    v_mfma_f32_16x16x32_bf16 v[20:23], v[48:51], v[180:183], v[20:23]
    s_waitcnt lgkmcnt(5)
    v_mfma_f32_16x16x32_bf16 v[24:27], v[52:55], v[176:179], v[24:27]
    ds_read_b128 v[44:47], v6 offset:35840
    v_mfma_f32_16x16x32_bf16 v[28:31], v[52:55], v[180:183], v[28:31]
    s_waitcnt lgkmcnt(5)
    v_mfma_f32_16x16x32_bf16 v[16:19], v[56:59], v[184:187], v[16:19]
    v_mfma_f32_16x16x32_bf16 v[20:23], v[56:59], v[188:191], v[20:23]
    s_waitcnt lgkmcnt(4)
    v_mfma_f32_16x16x32_bf16 v[24:27], v[60:63], v[184:187], v[24:27]
    v_mfma_f32_16x16x32_bf16 v[28:31], v[60:63], v[188:191], v[28:31]
    s_waitcnt lgkmcnt(3)
    v_mfma_f32_16x16x32_bf16 v[16:19], v[32:35], v[192:195], v[16:19]
    v_mfma_f32_16x16x32_bf16 v[20:23], v[32:35], v[196:199], v[20:23]
    s_waitcnt lgkmcnt(2)
    v_mfma_f32_16x16x32_bf16 v[24:27], v[36:39], v[192:195], v[24:27]
    v_mfma_f32_16x16x32_bf16 v[28:31], v[36:39], v[196:199], v[28:31]
    s_waitcnt lgkmcnt(1)
    v_mfma_f32_16x16x32_bf16 v[16:19], v[40:43], v[200:203], v[16:19]
    v_mfma_f32_16x16x32_bf16 v[20:23], v[40:43], v[204:207], v[20:23]
    s_waitcnt lgkmcnt(0)
    v_mfma_f32_16x16x32_bf16 v[24:27], v[44:47], v[200:203], v[24:27]
    v_mfma_f32_16x16x32_bf16 v[28:31], v[44:47], v[204:207], v[28:31]
    s_lshl_b32 s40, s38, 5
    s_add_u32 s40, s40, s37
    s_lshl_b32 s40, s40, 14
    s_add_u32 s40, s40, 8192
    s_add_u32 s41, s40, 4096
    v_cvt_pk_bf16_f32 v8, v16, v17
    v_cvt_pk_bf16_f32 v9, v18, v19
    v_cvt_pk_bf16_f32 v10, v24, v25
    v_cvt_pk_bf16_f32 v11, v26, v27
    buffer_store_dwordx4 v[8:11], v4, s[8:11], s40 offen sc1
    v_cvt_pk_bf16_f32 v12, v20, v21
    v_cvt_pk_bf16_f32 v13, v22, v23
    v_cvt_pk_bf16_f32 v14, v28, v29
    v_cvt_pk_bf16_f32 v15, v30, v31
    buffer_store_dwordx4 v[12:15], v4, s[8:11], s41 offen sc1
    s_add_u32 s38, s38, s39
    s_waitcnt vmcnt(11)
    s_cmp_lt_u32 s38, 64
    s_cbranch_scc1 PV_loop
    s_waitcnt vmcnt(0)
    s_barrier
    s_cmp_lg_u32 s36, 0
    s_cbranch_scc1 OL_9
    s_mov_b64 exec, 1
    v_mov_b32 v8, 64
    buffer_store_short v8, off, s[8:11], s46 offset:2 sc1
    s_mov_b64 exec, -1
OL_9:
    s_waitcnt vmcnt(0)
    s_branch W_X1
W_X2:
    s_sub_u32 s37, s3, 182
W_X1:
    s_mov_b32 s38, 33
    s_mov_b32 s39, 5
    s_mov_b32 s77, 64
    s_cmp_lt_u32 s37, 18
    s_cbranch_scc1 W_WO2
    s_sub_u32 s37, s37, 18
    s_mov_b32 s38, 32
    s_branch W_WO2
W_X0:
    s_mov_b32 s38, 63
    s_mov_b32 s39, 64
    s_mov_b32 s77, 64
    s_branch W_QA2
W_QA:
    s_sub_u32 s4, s3, 118
    s_and_b32 s37, s4, 31
    s_lshr_b32 s38, s4, 5
    s_mov_b32 s39, 3
    s_mov_b32 s77, 63
W_QA2:
    s_load_dwordx2 s[4:5], s[0:1], 0
    s_load_dwordx2 s[6:7], s[0:1], 16
    s_load_dwordx2 s[28:29], s[0:1], 120
    v_lshrrev_b32 v1, 6, v0
    s_nop 0
    v_readfirstlane_b32 s36, v1
    v_and_b32 v1, 63, v0
    v_and_b32 v2, 15, v0
    v_bfe_u32 v3, v0, 4, 2
    v_lshlrev_b32 v4, 4, v0
    s_waitcnt lgkmcnt(0)
    s_mov_b32 s12, s4
    s_and_b32 s13, s5, 0xffff
    s_mov_b32 s14, 0x240000
    s_mov_b32 s15, 0x20000
    s_mov_b32 s16, s6
    s_and_b32 s17, s7, 0xffff
    s_mov_b32 s18, 0x480000
    s_mov_b32 s19, 0x20000
    s_mov_b32 s8, s28
    s_and_b32 s9, s29, 0xffff
    s_mov_b32 s10, 0x10000000
    s_mov_b32 s11, 0x20000
    s_mov_b32 s68, 0
WT_10:
    buffer_load_dword v8, off, s[32:35], 0 offset:8 sc1
    s_waitcnt vmcnt(0)
    v_readfirstlane_b32 s70, v8
    s_nop 0
    s_cmp_ge_u32 s70, 1
    s_cbranch_scc1 WTX_11
    s_sleep 8
    s_add_u32 s68, s68, 1
    s_cmp_lt_u32 s68, 0x80000
    s_cbranch_scc1 WT_10
    s_branch L_exit
WTX_11:
    s_lshl_b32 s72, s37, 7
    s_add_u32 s72, s72, 61931520
    s_mov_b32 s68, 0
WT_12:
    buffer_load_dword v8, off, s[8:11], s72 offset:0 sc1
    s_waitcnt vmcnt(0)
    v_readfirstlane_b32 s70, v8
    s_nop 0
    s_lshr_b32 s71, s70, 16
    s_and_b32 s70, s70, 0xffff
    s_min_u32 s70, s70, s71
    s_cmp_ge_u32 s70, 3
    s_cbranch_scc1 WTX_13
    s_sleep 16
    s_add_u32 s68, s68, 1
    s_cmp_lt_u32 s68, 0x80000
    s_cbranch_scc1 WT_12
    s_branch L_exit
WTX_13:
    s_lshl_b32 s43, s37, 8
    v_lshlrev_b32 v8, 2, v3
    v_xor_b32 v8, v8, v2
    v_lshlrev_b32 v8, 4, v8
    s_lshl_b32 s40, s36, 2
    v_add_u32 v9, s40, v3
    s_mov_b32 s41, 8192
    v_mul_lo_u32 v9, v9, s41
    v_add_u32 v8, v8, v9
    s_lshl_b32 s42, s36, 10
    s_add_u32 m0, s42, 0
    s_add_u32 s40, s43, 0
    buffer_load_dwordx4 v8, s[16:19], s40 offen lds
    s_add_u32 m0, s42, 4096
    s_add_u32 s40, s43, 131072
    buffer_load_dwordx4 v8, s[16:19], s40 offen lds
    s_add_u32 m0, s42, 8192
    s_add_u32 s40, s43, 262144
    buffer_load_dwordx4 v8, s[16:19], s40 offen lds
    s_add_u32 m0, s42, 12288
    s_add_u32 s40, s43, 393216
    buffer_load_dwordx4 v8, s[16:19], s40 offen lds
    s_add_u32 m0, s42, 16384
    s_add_u32 s40, s43, 524288
    buffer_load_dwordx4 v8, s[16:19], s40 offen lds
    s_add_u32 m0, s42, 20480
    s_add_u32 s40, s43, 655360
    buffer_load_dwordx4 v8, s[16:19], s40 offen lds
    s_add_u32 m0, s42, 24576
    s_add_u32 s40, s43, 786432
    buffer_load_dwordx4 v8, s[16:19], s40 offen lds
    s_add_u32 m0, s42, 28672
    s_add_u32 s40, s43, 917504
    buffer_load_dwordx4 v8, s[16:19], s40 offen lds
    s_add_u32 m0, s42, 32768
    s_add_u32 s40, s43, 1048576
    buffer_load_dwordx4 v8, s[16:19], s40 offen lds
    s_add_u32 m0, s42, 36864
    s_add_u32 s40, s43, 1179648
    buffer_load_dwordx4 v8, s[16:19], s40 offen lds
    s_add_u32 m0, s42, 40960
    s_add_u32 s40, s43, 1310720
    buffer_load_dwordx4 v8, s[16:19], s40 offen lds
    s_add_u32 m0, s42, 45056
    s_add_u32 s40, s43, 1441792
    buffer_load_dwordx4 v8, s[16:19], s40 offen lds
    s_add_u32 m0, s42, 49152
    s_add_u32 s40, s43, 1572864
    buffer_load_dwordx4 v8, s[16:19], s40 offen lds
    s_add_u32 m0, s42, 53248
    s_add_u32 s40, s43, 1703936
    buffer_load_dwordx4 v8, s[16:19], s40 offen lds
    s_add_u32 m0, s42, 57344
    s_add_u32 s40, s43, 1835008
    buffer_load_dwordx4 v8, s[16:19], s40 offen lds
    s_add_u32 m0, s42, 61440
    s_add_u32 s40, s43, 1966080
    buffer_load_dwordx4 v8, s[16:19], s40 offen lds
    s_add_u32 m0, s42, 65536
    s_add_u32 s40, s43, 2097152
    buffer_load_dwordx4 v8, s[16:19], s40 offen lds
    s_add_u32 m0, s42, 69632
    s_add_u32 s40, s43, 2228224
    buffer_load_dwordx4 v8, s[16:19], s40 offen lds
    s_add_u32 m0, s42, 73728
    s_add_u32 s40, s43, 2359296
    buffer_load_dwordx4 v8, s[16:19], s40 offen lds
    s_add_u32 m0, s42, 77824
    s_add_u32 s40, s43, 2490368
    buffer_load_dwordx4 v8, s[16:19], s40 offen lds
    s_add_u32 m0, s42, 81920
    s_add_u32 s40, s43, 2621440
    buffer_load_dwordx4 v8, s[16:19], s40 offen lds
    s_add_u32 m0, s42, 86016
    s_add_u32 s40, s43, 2752512
    buffer_load_dwordx4 v8, s[16:19], s40 offen lds
    s_add_u32 m0, s42, 90112
    s_add_u32 s40, s43, 2883584
    buffer_load_dwordx4 v8, s[16:19], s40 offen lds
    s_add_u32 m0, s42, 94208
    s_add_u32 s40, s43, 3014656
    buffer_load_dwordx4 v8, s[16:19], s40 offen lds
    s_add_u32 m0, s42, 98304
    s_add_u32 s40, s43, 3145728
    buffer_load_dwordx4 v8, s[16:19], s40 offen lds
    s_add_u32 m0, s42, 102400
    s_add_u32 s40, s43, 3276800
    buffer_load_dwordx4 v8, s[16:19], s40 offen lds
    s_add_u32 m0, s42, 106496
    s_add_u32 s40, s43, 3407872
    buffer_load_dwordx4 v8, s[16:19], s40 offen lds
    s_add_u32 m0, s42, 110592
    s_add_u32 s40, s43, 3538944
    buffer_load_dwordx4 v8, s[16:19], s40 offen lds
    s_add_u32 m0, s42, 114688
    s_add_u32 s40, s43, 3670016
    buffer_load_dwordx4 v8, s[16:19], s40 offen lds
    s_add_u32 m0, s42, 118784
    s_add_u32 s40, s43, 3801088
    buffer_load_dwordx4 v8, s[16:19], s40 offen lds
    s_add_u32 m0, s42, 122880
    s_add_u32 s40, s43, 3932160
    buffer_load_dwordx4 v8, s[16:19], s40 offen lds
    s_add_u32 m0, s42, 126976
    s_add_u32 s40, s43, 4063232
    buffer_load_dwordx4 v8, s[16:19], s40 offen lds
    s_add_u32 m0, s42, 131072
    s_add_u32 s40, s43, 4194304
    buffer_load_dwordx4 v8, s[16:19], s40 offen lds
    s_add_u32 m0, s42, 135168
    s_add_u32 s40, s43, 4325376
    buffer_load_dwordx4 v8, s[16:19], s40 offen lds
    s_add_u32 m0, s42, 139264
    s_add_u32 s40, s43, 4456448
    buffer_load_dwordx4 v8, s[16:19], s40 offen lds
    s_add_u32 m0, s42, 143360
    s_add_u32 s40, s43, 4587520
    buffer_load_dwordx4 v8, s[16:19], s40 offen lds
    v_lshrrev_b32 v9, 2, v2
    v_lshl_add_u32 v10, v3, 3, v9
    v_lshlrev_b32 v10, 8, v10
    v_xor_b32 v9, s36, v9
    v_lshl_or_b32 v10, v9, 6, v10
    v_and_b32 v9, 3, v2
    v_lshl_or_b32 v10, v9, 4, v10
    v_add_u32 v11, 0xc000, v10
    v_add_u32 v12, 0x18000, v10
    s_waitcnt vmcnt(0)
    s_barrier
    ds_read_b64_tr_b16 v[64:65], v10 offset:0
    ds_read_b64_tr_b16 v[66:67], v10 offset:1024
    ds_read_b64_tr_b16 v[68:69], v10 offset:8
    ds_read_b64_tr_b16 v[70:71], v10 offset:1032
    ds_read_b64_tr_b16 v[72:73], v10 offset:8192
    ds_read_b64_tr_b16 v[74:75], v10 offset:9216
    ds_read_b64_tr_b16 v[76:77], v10 offset:8200
    ds_read_b64_tr_b16 v[78:79], v10 offset:9224
    ds_read_b64_tr_b16 v[80:81], v10 offset:16384
    ds_read_b64_tr_b16 v[82:83], v10 offset:17408
    ds_read_b64_tr_b16 v[84:85], v10 offset:16392
    ds_read_b64_tr_b16 v[86:87], v10 offset:17416
    ds_read_b64_tr_b16 v[88:89], v10 offset:24576
    ds_read_b64_tr_b16 v[90:91], v10 offset:25600
    ds_read_b64_tr_b16 v[92:93], v10 offset:24584
    ds_read_b64_tr_b16 v[94:95], v10 offset:25608
    ds_read_b64_tr_b16 v[96:97], v10 offset:32768
    ds_read_b64_tr_b16 v[98:99], v10 offset:33792
    ds_read_b64_tr_b16 v[100:101], v10 offset:32776
    ds_read_b64_tr_b16 v[102:103], v10 offset:33800
    ds_read_b64_tr_b16 v[104:105], v10 offset:40960
    ds_read_b64_tr_b16 v[106:107], v10 offset:41984
    ds_read_b64_tr_b16 v[108:109], v10 offset:40968
    ds_read_b64_tr_b16 v[110:111], v10 offset:41992
    ds_read_b64_tr_b16 v[112:113], v11 offset:0
    ds_read_b64_tr_b16 v[114:115], v11 offset:1024
    ds_read_b64_tr_b16 v[116:117], v11 offset:8
    ds_read_b64_tr_b16 v[118:119], v11 offset:1032
    ds_read_b64_tr_b16 v[120:121], v11 offset:8192
    ds_read_b64_tr_b16 v[122:123], v11 offset:9216
    ds_read_b64_tr_b16 v[124:125], v11 offset:8200
    ds_read_b64_tr_b16 v[126:127], v11 offset:9224
    ds_read_b64_tr_b16 v[128:129], v11 offset:16384
    ds_read_b64_tr_b16 v[130:131], v11 offset:17408
    ds_read_b64_tr_b16 v[132:133], v11 offset:16392
    ds_read_b64_tr_b16 v[134:135], v11 offset:17416
    ds_read_b64_tr_b16 v[136:137], v11 offset:24576
    ds_read_b64_tr_b16 v[138:139], v11 offset:25600
    ds_read_b64_tr_b16 v[140:141], v11 offset:24584
    ds_read_b64_tr_b16 v[142:143], v11 offset:25608
    ds_read_b64_tr_b16 v[144:145], v11 offset:32768
    ds_read_b64_tr_b16 v[146:147], v11 offset:33792
    ds_read_b64_tr_b16 v[148:149], v11 offset:32776
    ds_read_b64_tr_b16 v[150:151], v11 offset:33800
    ds_read_b64_tr_b16 v[152:153], v11 offset:40960
    ds_read_b64_tr_b16 v[154:155], v11 offset:41984
    ds_read_b64_tr_b16 v[156:157], v11 offset:40968
    ds_read_b64_tr_b16 v[158:159], v11 offset:41992
    ds_read_b64_tr_b16 v[160:161], v12 offset:0
    ds_read_b64_tr_b16 v[162:163], v12 offset:1024
    ds_read_b64_tr_b16 v[164:165], v12 offset:8
    ds_read_b64_tr_b16 v[166:167], v12 offset:1032
    ds_read_b64_tr_b16 v[168:169], v12 offset:8192
    ds_read_b64_tr_b16 v[170:171], v12 offset:9216
    ds_read_b64_tr_b16 v[172:173], v12 offset:8200
    ds_read_b64_tr_b16 v[174:175], v12 offset:9224
    ds_read_b64_tr_b16 v[176:177], v12 offset:16384
    ds_read_b64_tr_b16 v[178:179], v12 offset:17408
    ds_read_b64_tr_b16 v[180:181], v12 offset:16392
    ds_read_b64_tr_b16 v[182:183], v12 offset:17416
    ds_read_b64_tr_b16 v[184:185], v12 offset:24576
    ds_read_b64_tr_b16 v[186:187], v12 offset:25600
    ds_read_b64_tr_b16 v[188:189], v12 offset:24584
    ds_read_b64_tr_b16 v[190:191], v12 offset:25608
    ds_read_b64_tr_b16 v[192:193], v12 offset:32768
    ds_read_b64_tr_b16 v[194:195], v12 offset:33792
    ds_read_b64_tr_b16 v[196:197], v12 offset:32776
    ds_read_b64_tr_b16 v[198:199], v12 offset:33800
    ds_read_b64_tr_b16 v[200:201], v12 offset:40960
    ds_read_b64_tr_b16 v[202:203], v12 offset:41984
    ds_read_b64_tr_b16 v[204:205], v12 offset:40968
    ds_read_b64_tr_b16 v[206:207], v12 offset:41992
    s_waitcnt lgkmcnt(0)
    s_barrier
    v_lshrrev_b32 v8, 2, v1
    v_and_b32 v9, 3, v1
    v_lshrrev_b32 v10, 5, v1
    v_lshlrev_b32 v11, 1, v10
    v_xor_b32 v9, v9, v11
    v_mul_u32_u24 v8, 1152, v8
    v_lshl_add_u32 v5, v9, 4, v8
    v_add_u32 v6, 18432, v5
    v_lshrrev_b32 v8, 3, v2
    v_lshlrev_b32 v8, 1, v8
    v_xor_b32 v8, v8, v3
    v_lshlrev_b32 v8, 4, v8
    v_lshl_or_b32 v7, v2, 6, v8
    s_cmp_ge_u32 s36, 2
    s_cselect_b64 vcc, -1, 0
    v_cndmask_b32 v5, v5, v6, vcc
    s_and_b32 s45, s36, 1
    s_mul_i32 s45, s45, 576
    s_mov_b32 s44, 0
    s_mov_b32 s42, 0
    s_mul_i32 s78, s38, 36864
    s_add_u32 s78, s78, s45
    s_mul_i32 s79, s36, 9216
    s_add_u32 s79, s79, s42
    s_add_u32 m0, s79, 0
    s_nop 0
    buffer_load_dwordx4 v5, s[12:15], s78 offen lds
    s_add_u32 m0, s79, 1024
    s_add_u32 s78, s78, 64
    buffer_load_dwordx4 v5, s[12:15], s78 offen lds
    s_add_u32 m0, s79, 2048
    s_add_u32 s78, s78, 64
    buffer_load_dwordx4 v5, s[12:15], s78 offen lds
    s_add_u32 m0, s79, 3072
    s_add_u32 s78, s78, 64
    buffer_load_dwordx4 v5, s[12:15], s78 offen lds
    s_add_u32 m0, s79, 4096
    s_add_u32 s78, s78, 64
    buffer_load_dwordx4 v5, s[12:15], s78 offen lds
    s_add_u32 m0, s79, 5120
    s_add_u32 s78, s78, 64
    buffer_load_dwordx4 v5, s[12:15], s78 offen lds
    s_add_u32 m0, s79, 6144
    s_add_u32 s78, s78, 64
    buffer_load_dwordx4 v5, s[12:15], s78 offen lds
    s_add_u32 m0, s79, 7168
    s_add_u32 s78, s78, 64
    buffer_load_dwordx4 v5, s[12:15], s78 offen lds
    s_add_u32 m0, s79, 8192
    s_add_u32 s78, s78, 64
    buffer_load_dwordx4 v5, s[12:15], s78 offen lds
    s_add_u32 s43, s38, s39
    s_mov_b32 s42, 36864
    s_mul_i32 s78, s43, 36864
    s_add_u32 s78, s78, s45
    s_mul_i32 s79, s36, 9216
    s_add_u32 s79, s79, s42
    s_add_u32 m0, s79, 0
    s_nop 0
    buffer_load_dwordx4 v5, s[12:15], s78 offen lds
    s_add_u32 m0, s79, 1024
    s_add_u32 s78, s78, 64
    buffer_load_dwordx4 v5, s[12:15], s78 offen lds
    s_add_u32 m0, s79, 2048
    s_add_u32 s78, s78, 64
    buffer_load_dwordx4 v5, s[12:15], s78 offen lds
    s_add_u32 m0, s79, 3072
    s_add_u32 s78, s78, 64
    buffer_load_dwordx4 v5, s[12:15], s78 offen lds
    s_add_u32 m0, s79, 4096
    s_add_u32 s78, s78, 64
    buffer_load_dwordx4 v5, s[12:15], s78 offen lds
    s_add_u32 m0, s79, 5120
    s_add_u32 s78, s78, 64
    buffer_load_dwordx4 v5, s[12:15], s78 offen lds
    s_add_u32 m0, s79, 6144
    s_add_u32 s78, s78, 64
    buffer_load_dwordx4 v5, s[12:15], s78 offen lds
    s_add_u32 m0, s79, 7168
    s_add_u32 s78, s78, 64
    buffer_load_dwordx4 v5, s[12:15], s78 offen lds
    s_add_u32 m0, s79, 8192
    s_add_u32 s78, s78, 64
    buffer_load_dwordx4 v5, s[12:15], s78 offen lds
    s_and_b32 s40, s36, 1
    s_lshr_b32 s41, s36, 1
    v_lshlrev_b32 v250, 4, v1
    v_add_u32 v249, 110592, v4
    s_lshl_b32 s42, s40, 12
    s_add_u32 s42, s42, 110592
    v_add_u32 v244, s42, v250
    s_lshl_b32 s42, s36, 9
    s_add_u32 s42, s42, 118784
    v_lshlrev_b32 v8, 4, v2
    v_lshl_or_b32 v8, v3, 2, v8
    v_add_u32 v245, s42, v8
    v_lshrrev_b32 v8, 2, v2
    v_lshl_add_u32 v8, v3, 3, v8
    v_lshlrev_b32 v8, 4, v8
    v_and_b32 v9, 1, v2
    v_lshl_or_b32 v8, v9, 3, v8
    v_add_u32 v246, 118784, v8
    v_lshrrev_b32 v8, 2, v2
    v_and_b32 v9, 3, v2
    v_lshl_or_b32 v10, v8, 3, v9
    v_and_b32 v11, 1, v3
    v_lshlrev_b32 v12, 4, v10
    v_lshl_or_b32 v12, v11, 3, v12
    s_lshl_b32 s42, s41, 10
    s_add_u32 s42, s42, 120832
    v_add_u32 v248, s42, v12
    v_and_b32 v12, 15, v10
    v_lshl_or_b32 v12, v11, 5, v12
    v_lshlrev_b32 v12, 4, v12
    v_lshrrev_b32 v11, 1, v3
    v_lshl_or_b32 v12, v11, 3, v12
    v_lshrrev_b32 v11, 3, v2
    v_lshl_or_b32 v12, v11, 12, v12
    s_lshl_b32 s42, s41, 11
    v_add_u32 v247, s42, v12
    s_lshl_b32 s42, s40, 4
    v_add_u32 v8, s42, v2
    v_lshlrev_b32 v9, 3, v3
    v_sub_u32 v8, v8, v9
    v_cmp_le_i32 s[48:49], 0, v8
    v_cmp_le_i32 s[50:51], 1, v8
    v_cmp_le_i32 s[52:53], 4, v8
    v_cmp_le_i32 s[54:55], 5, v8
    v_cmp_le_i32 s[56:57], 2, v8
    v_cmp_le_i32 s[58:59], 3, v8
    v_cmp_le_i32 s[60:61], 6, v8
    v_cmp_le_i32 s[62:63], 7, v8
    v_cmp_gt_u32 s[64:65], 2, v3
    s_mov_b32 s66, 0x3e0293ee
    s_mov_b32 s67, 0xff800000
    s_lshl_b32 s46, s40, 12
    s_lshl_b32 s42, s41, 11
    s_add_u32 s46, s46, s42
    s_mov_b32 s68, 0
WT_14:
    buffer_load_dword v8, off, s[32:35], 0 offset:8 sc1
    s_waitcnt vmcnt(0)
    v_readfirstlane_b32 s70, v8
    s_nop 0
    s_cmp_ge_u32 s70, 1
    s_cbranch_scc1 WTX_15
    s_sleep 2
    s_add_u32 s68, s68, 1
    s_cmp_lt_u32 s68, 0x80000
    s_cbranch_scc1 WT_14
    s_branch L_exit
WTX_15:
    s_lshl_b32 s72, s37, 7
    s_add_u32 s72, s72, 61931520
    s_add_u32 s73, s72, 4096
    s_mov_b32 s69, 0
    s_waitcnt vmcnt(9)
    s_barrier
QA_loop:
    s_add_u32 s74, s38, 1
    s_cmp_ge_u32 s69, s74
    s_cbranch_scc1 QA_kvok
    s_mov_b32 s68, 0
WT_16:
    buffer_load_dword v8, off, s[8:11], s72 offset:0 sc1
    s_waitcnt vmcnt(0)
    v_readfirstlane_b32 s70, v8
    s_nop 0
    s_lshr_b32 s71, s70, 16
    s_and_b32 s70, s70, 0xffff
    s_min_u32 s70, s70, s71
    s_cmp_ge_u32 s70, s74
    s_cbranch_scc1 WTX_17
    s_sleep 2
    s_add_u32 s68, s68, 1
    s_cmp_lt_u32 s68, 0x80000
    s_cbranch_scc1 WT_16
    s_branch L_exit
WTX_17:
    s_mov_b32 s69, s70
QA_kvok:
    s_lshl_b32 s40, s38, 5
    s_add_u32 s47, s40, s37
    s_lshl_b32 s40, s47, 14
    s_add_u32 s40, s40, 0
    s_add_u32 s41, s40, 4096
    s_add_u32 s42, s40, 8192
    s_lshl_b32 s75, s47, 12
    s_add_u32 s75, s75, 50593792
    buffer_load_dwordx4 v[208:211], v250, s[8:11], s40 offen offset:0 sc1
    buffer_load_dwordx4 v[212:215], v250, s[8:11], s40 offen offset:1024 sc1
    buffer_load_dwordx4 v[216:219], v250, s[8:11], s40 offen offset:2048 sc1
    buffer_load_dwordx4 v[220:223], v250, s[8:11], s40 offen offset:3072 sc1
    buffer_load_dwordx4 v[224:227], v250, s[8:11], s41 offen offset:0 sc1
    buffer_load_dwordx4 v[228:231], v250, s[8:11], s41 offen offset:1024 sc1
    buffer_load_dwordx4 v[232:235], v250, s[8:11], s41 offen offset:2048 sc1
    buffer_load_dwordx4 v[236:239], v250, s[8:11], s41 offen offset:3072 sc1
    buffer_load_dwordx2 a[0:1], v247, s[8:11], s42 offen offset:0 sc1
    buffer_load_dwordx2 a[2:3], v247, s[8:11], s42 offen offset:256 sc1
    buffer_load_dwordx2 a[4:5], v247, s[8:11], s42 offen offset:64 sc1
    buffer_load_dwordx2 a[6:7], v247, s[8:11], s42 offen offset:320 sc1
    buffer_load_dwordx2 a[8:9], v247, s[8:11], s42 offen offset:1024 sc1
    buffer_load_dwordx2 a[10:11], v247, s[8:11], s42 offen offset:1280 sc1
    buffer_load_dwordx2 a[12:13], v247, s[8:11], s42 offen offset:1088 sc1
    buffer_load_dwordx2 a[14:15], v247, s[8:11], s42 offen offset:1344 sc1
    v_add_u32 v6, s44, v7
    s_add_u32 s42, s44, 73728
    s_cmp_ge_u32 s42, 110592
    s_cselect_b32 s43, 110592, 0
    s_sub_u32 s42, s42, s43
    s_lshl_b32 s43, s39, 1
    s_add_u32 s43, s43, s38
    s_mul_i32 s78, s43, 36864
    s_add_u32 s78, s78, s45
    s_mul_i32 s79, s36, 9216
    s_add_u32 s79, s79, s42
    s_add_u32 s44, s44, 36864
    s_cmp_ge_u32 s44, 110592
    s_cselect_b32 s44, 0, s44
    ds_read_b128 v[32:35], v6 offset:0
    ds_read_b128 v[36:39], v6 offset:18432
    ds_read_b128 v[40:43], v6 offset:1024
    ds_read_b128 v[44:47], v6 offset:19456
    ds_read_b128 v[48:51], v6 offset:2048
    ds_read_b128 v[52:55], v6 offset:20480
    s_waitcnt lgkmcnt(5)
    v_mfma_f32_16x16x32_bf16 v[16:19], v[64:67], v[32:35], 0
    ds_read_b128 v[56:59], v6 offset:3072
    v_mfma_f32_16x16x32_bf16 v[20:23], v[68:71], v[32:35], 0
    s_waitcnt lgkmcnt(5)
    v_mfma_f32_16x16x32_bf16 v[24:27], v[64:67], v[36:39], 0
    ds_read_b128 v[60:63], v6 offset:21504
    v_mfma_f32_16x16x32_bf16 v[28:31], v[68:71], v[36:39], 0
    s_add_u32 m0, s79, 0
    s_nop 0
    buffer_load_dwordx4 v5, s[12:15], s78 offen lds
    s_waitcnt lgkmcnt(5)
    v_mfma_f32_16x16x32_bf16 v[16:19], v[72:75], v[40:43], v[16:19]
    ds_read_b128 v[32:35], v6 offset:4096
    v_mfma_f32_16x16x32_bf16 v[20:23], v[76:79], v[40:43], v[20:23]
    s_waitcnt lgkmcnt(5)
    v_mfma_f32_16x16x32_bf16 v[24:27], v[72:75], v[44:47], v[24:27]
    ds_read_b128 v[36:39], v6 offset:22528
    v_mfma_f32_16x16x32_bf16 v[28:31], v[76:79], v[44:47], v[28:31]
    s_waitcnt lgkmcnt(5)
    v_mfma_f32_16x16x32_bf16 v[16:19], v[80:83], v[48:51], v[16:19]
    ds_read_b128 v[40:43], v6 offset:5120
    v_mfma_f32_16x16x32_bf16 v[20:23], v[84:87], v[48:51], v[20:23]
    s_add_u32 m0, s79, 1024
    s_add_u32 s78, s78, 64
    buffer_load_dwordx4 v5, s[12:15], s78 offen lds
    s_waitcnt lgkmcnt(5)
    v_mfma_f32_16x16x32_bf16 v[24:27], v[80:83], v[52:55], v[24:27]
    ds_read_b128 v[44:47], v6 offset:23552
    v_mfma_f32_16x16x32_bf16 v[28:31], v[84:87], v[52:55], v[28:31]
    s_waitcnt lgkmcnt(5)
    v_mfma_f32_16x16x32_bf16 v[16:19], v[88:91], v[56:59], v[16:19]
    ds_read_b128 v[48:51], v6 offset:6144
    v_mfma_f32_16x16x32_bf16 v[20:23], v[92:95], v[56:59], v[20:23]
    s_waitcnt lgkmcnt(5)
    v_mfma_f32_16x16x32_bf16 v[24:27], v[88:91], v[60:63], v[24:27]
    ds_read_b128 v[52:55], v6 offset:24576
    v_mfma_f32_16x16x32_bf16 v[28:31], v[92:95], v[60:63], v[28:31]
    s_add_u32 m0, s79, 2048
    s_add_u32 s78, s78, 64
    buffer_load_dwordx4 v5, s[12:15], s78 offen lds
    s_waitcnt lgkmcnt(5)
    v_mfma_f32_16x16x32_bf16 v[16:19], v[96:99], v[32:35], v[16:19]
    ds_read_b128 v[56:59], v6 offset:7168
    v_mfma_f32_16x16x32_bf16 v[20:23], v[100:103], v[32:35], v[20:23]
    s_waitcnt lgkmcnt(5)
    v_mfma_f32_16x16x32_bf16 v[24:27], v[96:99], v[36:39], v[24:27]
    ds_read_b128 v[60:63], v6 offset:25600
    v_mfma_f32_16x16x32_bf16 v[28:31], v[100:103], v[36:39], v[28:31]
    s_waitcnt lgkmcnt(5)
    v_mfma_f32_16x16x32_bf16 v[16:19], v[104:107], v[40:43], v[16:19]
    ds_read_b128 v[32:35], v6 offset:8192
    v_mfma_f32_16x16x32_bf16 v[20:23], v[108:111], v[40:43], v[20:23]
    s_add_u32 m0, s79, 3072
    s_add_u32 s78, s78, 64
    buffer_load_dwordx4 v5, s[12:15], s78 offen lds
    s_waitcnt lgkmcnt(5)
    v_mfma_f32_16x16x32_bf16 v[24:27], v[104:107], v[44:47], v[24:27]
    ds_read_b128 v[36:39], v6 offset:26624
    v_mfma_f32_16x16x32_bf16 v[28:31], v[108:111], v[44:47], v[28:31]
    s_waitcnt lgkmcnt(5)
    v_mfma_f32_16x16x32_bf16 v[16:19], v[112:115], v[48:51], v[16:19]
    ds_read_b128 v[40:43], v6 offset:9216
    v_mfma_f32_16x16x32_bf16 v[20:23], v[116:119], v[48:51], v[20:23]
    s_waitcnt lgkmcnt(5)
    v_mfma_f32_16x16x32_bf16 v[24:27], v[112:115], v[52:55], v[24:27]
    ds_read_b128 v[44:47], v6 offset:27648
    v_mfma_f32_16x16x32_bf16 v[28:31], v[116:119], v[52:55], v[28:31]
    s_add_u32 m0, s79, 4096
    s_add_u32 s78, s78, 64
    buffer_load_dwordx4 v5, s[12:15], s78 offen lds
    s_waitcnt lgkmcnt(5)
    v_mfma_f32_16x16x32_bf16 v[16:19], v[120:123], v[56:59], v[16:19]
    ds_read_b128 v[48:51], v6 offset:10240
    v_mfma_f32_16x16x32_bf16 v[20:23], v[124:127], v[56:59], v[20:23]
    s_waitcnt lgkmcnt(5)
    v_mfma_f32_16x16x32_bf16 v[24:27], v[120:123], v[60:63], v[24:27]
    ds_read_b128 v[52:55], v6 offset:28672
    v_mfma_f32_16x16x32_bf16 v[28:31], v[124:127], v[60:63], v[28:31]
    s_waitcnt lgkmcnt(5)
    v_mfma_f32_16x16x32_bf16 v[16:19], v[128:131], v[32:35], v[16:19]
    ds_read_b128 v[56:59], v6 offset:11264
    v_mfma_f32_16x16x32_bf16 v[20:23], v[132:135], v[32:35], v[20:23]
    s_add_u32 m0, s79, 5120
    s_add_u32 s78, s78, 64
    buffer_load_dwordx4 v5, s[12:15], s78 offen lds
    s_waitcnt lgkmcnt(5)
    v_mfma_f32_16x16x32_bf16 v[24:27], v[128:131], v[36:39], v[24:27]
    ds_read_b128 v[60:63], v6 offset:29696
    v_mfma_f32_16x16x32_bf16 v[28:31], v[132:135], v[36:39], v[28:31]
    s_waitcnt lgkmcnt(5)
    v_mfma_f32_16x16x32_bf16 v[16:19], v[136:139], v[40:43], v[16:19]
    ds_read_b128 v[32:35], v6 offset:12288
    v_mfma_f32_16x16x32_bf16 v[20:23], v[140:143], v[40:43], v[20:23]
    s_waitcnt lgkmcnt(5)
    v_mfma_f32_16x16x32_bf16 v[24:27], v[136:139], v[44:47], v[24:27]
    ds_read_b128 v[36:39], v6 offset:30720
    v_mfma_f32_16x16x32_bf16 v[28:31], v[140:143], v[44:47], v[28:31]
    s_add_u32 m0, s79, 6144
    s_add_u32 s78, s78, 64
    buffer_load_dwordx4 v5, s[12:15], s78 offen lds
    s_waitcnt lgkmcnt(5)
    v_mfma_f32_16x16x32_bf16 v[16:19], v[144:147], v[48:51], v[16:19]
    ds_read_b128 v[40:43], v6 offset:13312
    v_mfma_f32_16x16x32_bf16 v[20:23], v[148:151], v[48:51], v[20:23]
    s_waitcnt lgkmcnt(5)
    v_mfma_f32_16x16x32_bf16 v[24:27], v[144:147], v[52:55], v[24:27]
    ds_read_b128 v[44:47], v6 offset:31744
    v_mfma_f32_16x16x32_bf16 v[28:31], v[148:151], v[52:55], v[28:31]
    s_waitcnt lgkmcnt(5)
    v_mfma_f32_16x16x32_bf16 v[16:19], v[152:155], v[56:59], v[16:19]
    ds_read_b128 v[48:51], v6 offset:14336
    v_mfma_f32_16x16x32_bf16 v[20:23], v[156:159], v[56:59], v[20:23]
    s_add_u32 m0, s79, 7168
    s_add_u32 s78, s78, 64
    buffer_load_dwordx4 v5, s[12:15], s78 offen lds
    s_waitcnt lgkmcnt(5)
    v_mfma_f32_16x16x32_bf16 v[24:27], v[152:155], v[60:63], v[24:27]
    ds_read_b128 v[52:55], v6 offset:32768
    v_mfma_f32_16x16x32_bf16 v[28:31], v[156:159], v[60:63], v[28:31]
    s_waitcnt lgkmcnt(5)
    v_mfma_f32_16x16x32_bf16 v[16:19], v[160:163], v[32:35], v[16:19]
    ds_read_b128 v[56:59], v6 offset:15360
    v_mfma_f32_16x16x32_bf16 v[20:23], v[164:167], v[32:35], v[20:23]
    s_waitcnt lgkmcnt(5)
    v_mfma_f32_16x16x32_bf16 v[24:27], v[160:163], v[36:39], v[24:27]
    ds_read_b128 v[60:63], v6 offset:33792
    v_mfma_f32_16x16x32_bf16 v[28:31], v[164:167], v[36:39], v[28:31]
    s_add_u32 m0, s79, 8192
    s_add_u32 s78, s78, 64
    buffer_load_dwordx4 v5, s[12:15], s78 offen lds
    s_waitcnt lgkmcnt(5)
    v_mfma_f32_16x16x32_bf16 v[16:19], v[168:171], v[40:43], v[16:19]
    ds_read_b128 v[32:35], v6 offset:16384
    v_mfma_f32_16x16x32_bf16 v[20:23], v[172:175], v[40:43], v[20:23]
    s_waitcnt lgkmcnt(5)
    v_mfma_f32_16x16x32_bf16 v[24:27], v[168:171], v[44:47], v[24:27]
    ds_read_b128 v[36:39], v6 offset:34816
    v_mfma_f32_16x16x32_bf16 v[28:31], v[172:175], v[44:47], v[28:31]
    s_waitcnt lgkmcnt(5)
    v_mfma_f32_16x16x32_bf16 v[16:19], v[176:179], v[48:51], v[16:19]
    ds_read_b128 v[40:43], v6 offset:17408
    v_mfma_f32_16x16x32_bf16 v[20:23], v[180:183], v[48:51], v[20:23]
    s_waitcnt lgkmcnt(5)
    v_mfma_f32_16x16x32_bf16 v[24:27], v[176:179], v[52:55], v[24:27]
    ds_read_b128 v[44:47], v6 offset:35840
    v_mfma_f32_16x16x32_bf16 v[28:31], v[180:183], v[52:55], v[28:31]
    s_waitcnt lgkmcnt(5)
    v_mfma_f32_16x16x32_bf16 v[16:19], v[184:187], v[56:59], v[16:19]
    v_mfma_f32_16x16x32_bf16 v[20:23], v[188:191], v[56:59], v[20:23]
    s_waitcnt lgkmcnt(4)
    v_mfma_f32_16x16x32_bf16 v[24:27], v[184:187], v[60:63], v[24:27]
    v_mfma_f32_16x16x32_bf16 v[28:31], v[188:191], v[60:63], v[28:31]
    s_waitcnt lgkmcnt(3)
    v_mfma_f32_16x16x32_bf16 v[16:19], v[192:195], v[32:35], v[16:19]
    v_mfma_f32_16x16x32_bf16 v[20:23], v[196:199], v[32:35], v[20:23]
    s_waitcnt lgkmcnt(2)
    v_mfma_f32_16x16x32_bf16 v[24:27], v[192:195], v[36:39], v[24:27]
    v_mfma_f32_16x16x32_bf16 v[28:31], v[196:199], v[36:39], v[28:31]
    s_waitcnt lgkmcnt(1)
    v_mfma_f32_16x16x32_bf16 v[16:19], v[200:203], v[40:43], v[16:19]
    v_mfma_f32_16x16x32_bf16 v[20:23], v[204:207], v[40:43], v[20:23]
    s_waitcnt lgkmcnt(0)
    v_mfma_f32_16x16x32_bf16 v[24:27], v[200:203], v[44:47], v[24:27]
    v_mfma_f32_16x16x32_bf16 v[28:31], v[204:207], v[44:47], v[28:31]
    s_nop 3
    v_cvt_pk_bf16_f32 v8, v16, v17
    v_cvt_pk_bf16_f32 v9, v18, v19
    v_cvt_pk_bf16_f32 v10, v20, v21
    v_cvt_pk_bf16_f32 v11, v22, v23
    ds_write_b128 v249, v[8:11] offset:0
    v_cvt_pk_bf16_f32 v12, v24, v25
    v_cvt_pk_bf16_f32 v13, v26, v27
    v_cvt_pk_bf16_f32 v14, v28, v29
    v_cvt_pk_bf16_f32 v15, v30, v31
    ds_write_b128 v249, v[12:15] offset:4096
    s_cmp_lg_u32 s36, 0
    s_cbranch_scc1 WTX_19
    s_mov_b32 s68, 0
WT_18:
    buffer_load_dword v240, off, s[8:11], s73 offset:0 sc1
    s_waitcnt vmcnt(0)
    v_readfirstlane_b32 s70, v240
    s_nop 0
    s_cmp_ge_u32 s70, s74
    s_cbranch_scc1 WTX_19
    s_sleep 1
    s_add_u32 s68, s68, 1
    s_cmp_lt_u32 s68, 0x80000
    s_cbranch_scc1 WT_18
    s_branch L_exit
WTX_19:
    s_barrier
    s_add_u32 s40, s75, 131072
    buffer_load_dwordx2 v[240:241], v4, s[8:11], s75 offen sc1
    buffer_load_dwordx2 v[242:243], v4, s[8:11], s40 offen offset:8 sc1
    s_waitcnt vmcnt(0)
    ds_write_b32 v245, v240
    ds_write_b32 v245, v241 offset:256
    ds_write_b32 v245, v242 offset:2048
    ds_write_b32 v245, v243 offset:2304
    s_waitcnt lgkmcnt(0)
    s_barrier
    ds_read_b128 v[32:35], v244 offset:0
    ds_read_b128 v[36:39], v244 offset:1024
    ds_read_b128 v[40:43], v244 offset:2048
    ds_read_b128 v[44:47], v244 offset:3072
    ds_read_b64_tr_b16 a[24:25], v246 offset:0
    ds_read_b64_tr_b16 a[26:27], v246 offset:64
    ds_read_b64_tr_b16 a[28:29], v246 offset:512
    ds_read_b64_tr_b16 a[30:31], v246 offset:576
    ds_read_b64_tr_b16 a[32:33], v246 offset:1024
    ds_read_b64_tr_b16 a[34:35], v246 offset:1088
    ds_read_b64_tr_b16 a[36:37], v246 offset:1536
    ds_read_b64_tr_b16 a[38:39], v246 offset:1600
    ds_read_b64 a[16:17], v248 offset:0
    ds_read_b64 a[18:19], v248 offset:64
    ds_read_b64 a[20:21], v248 offset:512
    ds_read_b64 a[22:23], v248 offset:576
    s_waitcnt lgkmcnt(0)
    v_mfma_f32_16x16x32_bf16 v[16:19], v[208:211], v[32:35], 0
    v_mfma_f32_16x16x32_bf16 v[20:23], v[224:227], v[32:35], 0
    v_mfma_f32_16x16x32_bf16 v[24:27], a[24:27], v[32:35], 0
    v_mfma_f32_16x16x32_bf16 v[16:19], v[212:215], v[36:39], v[16:19]
    v_mfma_f32_16x16x32_bf16 v[20:23], v[228:231], v[36:39], v[20:23]
    v_mfma_f32_16x16x32_bf16 v[24:27], a[28:31], v[36:39], v[24:27]
    v_mfma_f32_16x16x32_bf16 v[16:19], v[216:219], v[40:43], v[16:19]
    v_mfma_f32_16x16x32_bf16 v[20:23], v[232:235], v[40:43], v[20:23]
    v_mfma_f32_16x16x32_bf16 v[24:27], a[32:35], v[40:43], v[24:27]
    v_mfma_f32_16x16x32_bf16 v[16:19], v[220:223], v[44:47], v[16:19]
    v_mfma_f32_16x16x32_bf16 v[20:23], v[236:239], v[44:47], v[20:23]
    v_mfma_f32_16x16x32_bf16 v[24:27], a[36:39], v[44:47], v[24:27]
    v_mov_b32 v28, s67
    s_nop 4
    v_cndmask_b32 v16, v28, v16, s[48:49]
    v_cndmask_b32 v17, v28, v17, s[50:51]
    v_cndmask_b32 v18, v28, v18, s[52:53]
    v_cndmask_b32 v19, v28, v19, s[54:55]
    v_cndmask_b32 v20, v28, v20, s[56:57]
    v_cndmask_b32 v21, v28, v21, s[58:59]
    v_cndmask_b32 v22, v28, v22, s[60:61]
    v_cndmask_b32 v23, v28, v23, s[62:63]
    v_cndmask_b32 v24, v28, v24, s[64:65]
    v_cndmask_b32 v25, v28, v25, s[64:65]
    v_cndmask_b32 v26, v28, v26, s[64:65]
    v_cndmask_b32 v27, v28, v27, s[64:65]
    v_max3_f32 v29, v16, v17, v18
    v_max3_f32 v29, v29, v19, v20
    v_max3_f32 v29, v29, v21, v22
    v_max3_f32 v29, v29, v23, v24
    v_max3_f32 v29, v29, v25, v26
    v_max_f32 v29, v29, v27
    v_mov_b32 v30, v29
    s_nop 1
    v_permlane16_swap_b32 v30, v29
    v_max_f32 v29, v30, v29
    v_mov_b32 v30, v29
    s_nop 1
    v_permlane32_swap_b32 v30, v29
    v_max_f32 v29, v30, v29
    v_mul_f32 v29, s66, v29
    v_fma_f32 v16, v16, s66, -v29
    v_fma_f32 v17, v17, s66, -v29
    v_fma_f32 v18, v18, s66, -v29
    v_fma_f32 v19, v19, s66, -v29
    v_fma_f32 v20, v20, s66, -v29
    v_fma_f32 v21, v21, s66, -v29
    v_fma_f32 v22, v22, s66, -v29
    v_fma_f32 v23, v23, s66, -v29
    v_fma_f32 v24, v24, s66, -v29
    v_fma_f32 v25, v25, s66, -v29
    v_fma_f32 v26, v26, s66, -v29
    v_fma_f32 v27, v27, s66, -v29
    v_exp_f32 v16, v16
    v_exp_f32 v17, v17
    v_exp_f32 v18, v18
    v_exp_f32 v19, v19
    v_exp_f32 v20, v20
    v_exp_f32 v21, v21
    v_exp_f32 v22, v22
    v_exp_f32 v23, v23
    v_exp_f32 v24, v24
    v_exp_f32 v25, v25
    v_exp_f32 v26, v26
    v_exp_f32 v27, v27
    v_add_f32 v29, v16, v17
    v_add_f32 v29, v29, v18
    v_add_f32 v29, v29, v19
    v_add_f32 v29, v29, v20
    v_add_f32 v29, v29, v21
    v_add_f32 v29, v29, v22
    v_add_f32 v29, v29, v23
    v_add_f32 v29, v29, v24
    v_add_f32 v29, v29, v25
    v_add_f32 v29, v29, v26
    v_add_f32 v29, v29, v27
    v_mov_b32 v30, v29
    s_nop 1
    v_permlane16_swap_b32 v30, v29
    v_add_f32 v29, v30, v29
    v_mov_b32 v30, v29
    s_nop 1
    v_permlane32_swap_b32 v30, v29
    v_add_f32 v29, v30, v29
    v_rcp_f32 v29, v29
    s_nop 0
    v_mul_f32 v16, v16, v29
    v_mul_f32 v17, v17, v29
    v_mul_f32 v18, v18, v29
    v_mul_f32 v19, v19, v29
    v_mul_f32 v20, v20, v29
    v_mul_f32 v21, v21, v29
    v_mul_f32 v22, v22, v29
    v_mul_f32 v23, v23, v29
    v_mul_f32 v24, v24, v29
    v_mul_f32 v25, v25, v29
    v_mul_f32 v26, v26, v29
    v_mul_f32 v27, v27, v29
    v_cvt_pk_bf16_f32 v8, v16, v17
    v_cvt_pk_bf16_f32 v9, v20, v21
    v_cvt_pk_bf16_f32 v10, v18, v19
    v_cvt_pk_bf16_f32 v11, v22, v23
    v_cvt_pk_bf16_f32 v12, v24, v25
    v_cvt_pk_bf16_f32 v13, v26, v27
    v_mfma_f32_16x16x32_bf16 v[48:51], a[0:3], v[8:11], 0
    v_mfma_f32_16x16x32_bf16 v[52:55], a[4:7], v[8:11], 0
    v_mfma_f32_16x16x32_bf16 v[56:59], a[8:11], v[8:11], 0
    v_mfma_f32_16x16x32_bf16 v[60:63], a[12:15], v[8:11], 0
    v_mfma_f32_16x16x16_bf16 v[48:51], a[16:17], v[12:13], v[48:51]
    v_mfma_f32_16x16x16_bf16 v[52:55], a[18:19], v[12:13], v[52:55]
    v_mfma_f32_16x16x16_bf16 v[56:59], a[20:21], v[12:13], v[56:59]
    v_mfma_f32_16x16x16_bf16 v[60:63], a[22:23], v[12:13], v[60:63]
    s_lshl_b32 s40, s47, 13
    s_add_u32 s40, s40, s46
    s_add_u32 s40, s40, 33554432
    s_nop 1
    v_cvt_pk_bf16_f32 v16, v48, v49
    v_cvt_pk_bf16_f32 v17, v50, v51
    v_cvt_pk_bf16_f32 v18, v52, v53
    v_cvt_pk_bf16_f32 v19, v54, v55
    buffer_store_dwordx4 v[16:19], v250, s[8:11], s40 offen offset:0 sc1
    v_cvt_pk_bf16_f32 v20, v56, v57
    v_cvt_pk_bf16_f32 v21, v58, v59
    v_cvt_pk_bf16_f32 v22, v60, v61
    v_cvt_pk_bf16_f32 v23, v62, v63
    buffer_store_dwordx4 v[20:23], v250, s[8:11], s40 offen offset:1024 sc1
    s_waitcnt vmcnt(0)
    s_barrier
    s_lshl_b32 s40, s38, 2
    s_add_u32 s40, s40, 61939712
    s_lshl_b32 s41, s37, 8
    s_add_u32 s40, s40, s41
    s_cmp_lg_u32 s36, 0
    s_cbranch_scc1 OL_20
    s_mov_b64 exec, 1
    v_mov_b32 v8, 1
    buffer_store_dword v8, off, s[8:11], s40 sc1
    s_mov_b64 exec, -1
OL_20:
    s_add_u32 s38, s38, s39
    s_cmp_lt_u32 s38, s77
    s_cbranch_scc1 QA_loop
    s_waitcnt vmcnt(0)
    s_branch L_exit
W_B:
    s_sub_u32 s37, s3, 86
    s_cmp_ge_u32 s37, 32
    s_cbranch_scc1 W_B2
    s_load_dwordx2 s[4:5], s[0:1], 0
    s_load_dwordx2 s[6:7], s[0:1], 64
    s_load_dwordx2 s[28:29], s[0:1], 120
    s_load_dwordx2 s[30:31], s[0:1], 96
    v_lshrrev_b32 v1, 6, v0
    s_nop 0
    v_readfirstlane_b32 s36, v1
    v_and_b32 v1, 63, v0
    v_and_b32 v2, 15, v0
    v_bfe_u32 v3, v0, 4, 2
    v_lshlrev_b32 v4, 4, v0
    s_waitcnt lgkmcnt(0)
    s_mov_b32 s12, s4
    s_and_b32 s13, s5, 0xffff
    s_mov_b32 s14, 0x240000
    s_mov_b32 s15, 0x20000
    s_mov_b32 s16, s6
    s_and_b32 s17, s7, 0xffff
    s_mov_b32 s18, 0x480
    s_mov_b32 s19, 0x20000
    s_mov_b32 s8, s28
    s_and_b32 s9, s29, 0xffff
    s_mov_b32 s10, 0x10000000
    s_mov_b32 s11, 0x20000
    s_mov_b32 s20, s30
    s_and_b32 s21, s31, 0xffff
    s_mov_b32 s22, 0x480
    s_mov_b32 s23, 0x20000
    v_lshlrev_b32 v5, 4, v3
    s_lshl_b32 s40, s37, 6
    s_lshl_b32 s41, s36, 4
    s_add_u32 s40, s40, s41
    v_add_u32 v6, s40, v2
    v_mul_u32_u24 v7, 1152, v6
    v_add_u32 v7, v7, v5
    buffer_load_dwordx4 v[16:19], v7, s[12:15], 0 offen offset:0
    buffer_load_dwordx4 v[88:91], v5, s[16:19], 0 offen offset:0
    buffer_load_dwordx4 v[160:163], v5, s[20:23], 0 offen offset:0
    buffer_load_dwordx4 v[20:23], v7, s[12:15], 0 offen offset:64
    buffer_load_dwordx4 v[92:95], v5, s[16:19], 0 offen offset:64
    buffer_load_dwordx4 v[164:167], v5, s[20:23], 0 offen offset:64
    buffer_load_dwordx4 v[24:27], v7, s[12:15], 0 offen offset:128
    buffer_load_dwordx4 v[96:99], v5, s[16:19], 0 offen offset:128
    buffer_load_dwordx4 v[168:171], v5, s[20:23], 0 offen offset:128
    buffer_load_dwordx4 v[28:31], v7, s[12:15], 0 offen offset:192
    buffer_load_dwordx4 v[100:103], v5, s[16:19], 0 offen offset:192
    buffer_load_dwordx4 v[172:175], v5, s[20:23], 0 offen offset:192
    buffer_load_dwordx4 v[32:35], v7, s[12:15], 0 offen offset:256
    buffer_load_dwordx4 v[104:107], v5, s[16:19], 0 offen offset:256
    buffer_load_dwordx4 v[176:179], v5, s[20:23], 0 offen offset:256
    buffer_load_dwordx4 v[36:39], v7, s[12:15], 0 offen offset:320
    buffer_load_dwordx4 v[108:111], v5, s[16:19], 0 offen offset:320
    buffer_load_dwordx4 v[180:183], v5, s[20:23], 0 offen offset:320
    buffer_load_dwordx4 v[40:43], v7, s[12:15], 0 offen offset:384
    buffer_load_dwordx4 v[112:115], v5, s[16:19], 0 offen offset:384
    buffer_load_dwordx4 v[184:187], v5, s[20:23], 0 offen offset:384
    buffer_load_dwordx4 v[44:47], v7, s[12:15], 0 offen offset:448
    buffer_load_dwordx4 v[116:119], v5, s[16:19], 0 offen offset:448
    buffer_load_dwordx4 v[188:191], v5, s[20:23], 0 offen offset:448
    buffer_load_dwordx4 v[48:51], v7, s[12:15], 0 offen offset:512
    buffer_load_dwordx4 v[120:123], v5, s[16:19], 0 offen offset:512
    buffer_load_dwordx4 v[192:195], v5, s[20:23], 0 offen offset:512
    buffer_load_dwordx4 v[52:55], v7, s[12:15], 0 offen offset:576
    buffer_load_dwordx4 v[124:127], v5, s[16:19], 0 offen offset:576
    buffer_load_dwordx4 v[196:199], v5, s[20:23], 0 offen offset:576
    buffer_load_dwordx4 v[56:59], v7, s[12:15], 0 offen offset:640
    buffer_load_dwordx4 v[128:131], v5, s[16:19], 0 offen offset:640
    buffer_load_dwordx4 v[200:203], v5, s[20:23], 0 offen offset:640
    buffer_load_dwordx4 v[60:63], v7, s[12:15], 0 offen offset:704
    buffer_load_dwordx4 v[132:135], v5, s[16:19], 0 offen offset:704
    buffer_load_dwordx4 v[204:207], v5, s[20:23], 0 offen offset:704
    buffer_load_dwordx4 v[64:67], v7, s[12:15], 0 offen offset:768
    buffer_load_dwordx4 v[136:139], v5, s[16:19], 0 offen offset:768
    buffer_load_dwordx4 v[208:211], v5, s[20:23], 0 offen offset:768
    buffer_load_dwordx4 v[68:71], v7, s[12:15], 0 offen offset:832
    buffer_load_dwordx4 v[140:143], v5, s[16:19], 0 offen offset:832
    buffer_load_dwordx4 v[212:215], v5, s[20:23], 0 offen offset:832
    buffer_load_dwordx4 v[72:75], v7, s[12:15], 0 offen offset:896
    buffer_load_dwordx4 v[144:147], v5, s[16:19], 0 offen offset:896
    buffer_load_dwordx4 v[216:219], v5, s[20:23], 0 offen offset:896
    buffer_load_dwordx4 v[76:79], v7, s[12:15], 0 offen offset:960
    buffer_load_dwordx4 v[148:151], v5, s[16:19], 0 offen offset:960
    buffer_load_dwordx4 v[220:223], v5, s[20:23], 0 offen offset:960
    buffer_load_dwordx4 v[80:83], v7, s[12:15], 0 offen offset:1024
    buffer_load_dwordx4 v[152:155], v5, s[16:19], 0 offen offset:1024
    buffer_load_dwordx4 v[224:227], v5, s[20:23], 0 offen offset:1024
    buffer_load_dwordx4 v[84:87], v7, s[12:15], 0 offen offset:1088
    buffer_load_dwordx4 v[156:159], v5, s[16:19], 0 offen offset:1088
    buffer_load_dwordx4 v[228:231], v5, s[20:23], 0 offen offset:1088
    s_waitcnt vmcnt(0)
    v_mfma_f32_16x16x32_bf16 v[8:11], v[88:91], v[16:19], 0
    v_mfma_f32_16x16x32_bf16 v[12:15], v[160:163], v[16:19], 0
    v_mfma_f32_16x16x32_bf16 v[8:11], v[92:95], v[20:23], v[8:11]
    v_mfma_f32_16x16x32_bf16 v[12:15], v[164:167], v[20:23], v[12:15]
    v_mfma_f32_16x16x32_bf16 v[8:11], v[96:99], v[24:27], v[8:11]
    v_mfma_f32_16x16x32_bf16 v[12:15], v[168:171], v[24:27], v[12:15]
    v_mfma_f32_16x16x32_bf16 v[8:11], v[100:103], v[28:31], v[8:11]
    v_mfma_f32_16x16x32_bf16 v[12:15], v[172:175], v[28:31], v[12:15]
    v_mfma_f32_16x16x32_bf16 v[8:11], v[104:107], v[32:35], v[8:11]
    v_mfma_f32_16x16x32_bf16 v[12:15], v[176:179], v[32:35], v[12:15]
    v_mfma_f32_16x16x32_bf16 v[8:11], v[108:111], v[36:39], v[8:11]
    v_mfma_f32_16x16x32_bf16 v[12:15], v[180:183], v[36:39], v[12:15]
    v_mfma_f32_16x16x32_bf16 v[8:11], v[112:115], v[40:43], v[8:11]
    v_mfma_f32_16x16x32_bf16 v[12:15], v[184:187], v[40:43], v[12:15]
    v_mfma_f32_16x16x32_bf16 v[8:11], v[116:119], v[44:47], v[8:11]
    v_mfma_f32_16x16x32_bf16 v[12:15], v[188:191], v[44:47], v[12:15]
    v_mfma_f32_16x16x32_bf16 v[8:11], v[120:123], v[48:51], v[8:11]
    v_mfma_f32_16x16x32_bf16 v[12:15], v[192:195], v[48:51], v[12:15]
    v_mfma_f32_16x16x32_bf16 v[8:11], v[124:127], v[52:55], v[8:11]
    v_mfma_f32_16x16x32_bf16 v[12:15], v[196:199], v[52:55], v[12:15]
    v_mfma_f32_16x16x32_bf16 v[8:11], v[128:131], v[56:59], v[8:11]
    v_mfma_f32_16x16x32_bf16 v[12:15], v[200:203], v[56:59], v[12:15]
    v_mfma_f32_16x16x32_bf16 v[8:11], v[132:135], v[60:63], v[8:11]
    v_mfma_f32_16x16x32_bf16 v[12:15], v[204:207], v[60:63], v[12:15]
    v_mfma_f32_16x16x32_bf16 v[8:11], v[136:139], v[64:67], v[8:11]
    v_mfma_f32_16x16x32_bf16 v[12:15], v[208:211], v[64:67], v[12:15]
    v_mfma_f32_16x16x32_bf16 v[8:11], v[140:143], v[68:71], v[8:11]
    v_mfma_f32_16x16x32_bf16 v[12:15], v[212:215], v[68:71], v[12:15]
    v_mfma_f32_16x16x32_bf16 v[8:11], v[144:147], v[72:75], v[8:11]
    v_mfma_f32_16x16x32_bf16 v[12:15], v[216:219], v[72:75], v[12:15]
    v_mfma_f32_16x16x32_bf16 v[8:11], v[148:151], v[76:79], v[8:11]
    v_mfma_f32_16x16x32_bf16 v[12:15], v[220:223], v[76:79], v[12:15]
    v_mfma_f32_16x16x32_bf16 v[8:11], v[152:155], v[80:83], v[8:11]
    v_mfma_f32_16x16x32_bf16 v[12:15], v[224:227], v[80:83], v[12:15]
    v_mfma_f32_16x16x32_bf16 v[8:11], v[156:159], v[84:87], v[8:11]
    v_mfma_f32_16x16x32_bf16 v[12:15], v[228:231], v[84:87], v[12:15]
    s_mov_b32 s42, 0xbfb8aa3b
    s_nop 5
    v_cvt_pk_bf16_f32 v8, v8, v8
    v_and_b32 v8, 0xffff0000, v8
    v_cvt_pk_bf16_f32 v12, v12, v12
    v_and_b32 v12, 0xffff0000, v12
    v_mul_f32 v12, s42, v12
    v_exp_f32 v12, v12
    s_nop 0
    v_add_f32 v12, 1.0, v12
    v_rcp_f32 v12, v12
    s_nop 0
    v_cvt_pk_bf16_f32 v12, v12, v12
    v_and_b32 v12, 0xffff0000, v12
    v_lshlrev_b32 v6, 2, v6
    s_mov_b64 exec, 0xffff
    s_mov_b32 s40, 60817408
    s_mov_b32 s41, 60825600
    buffer_store_dword v8, v6, s[8:11], s40 offen sc1
    buffer_store_dword v12, v6, s[8:11], s41 offen sc1
    s_mov_b64 exec, -1
    s_waitcnt vmcnt(0)
    s_barrier
    s_cmp_lg_u32 s36, 0
    s_cbranch_scc1 OL_21
    s_mov_b64 exec, 1
    v_mov_b32 v8, 1
    buffer_atomic_add v8, off, s[32:35], 0 offset:132
    s_mov_b64 exec, -1
OL_21:
W_B2:
    s_sub_u32 s37, s3, 64
    s_cmp_ge_u32 s37, 36
    s_cbranch_scc1 W_B3
    s_load_dwordx2 s[4:5], s[0:1], 0
    s_load_dwordx4 s[28:31], s[0:1], 72
    s_load_dwordx2 s[6:7], s[0:1], 88
    s_load_dwordx2 s[46:47], s[0:1], 120
    v_lshrrev_b32 v1, 6, v0
    s_nop 0
    v_readfirstlane_b32 s36, v1
    v_and_b32 v1, 63, v0
    v_and_b32 v2, 15, v0
    v_bfe_u32 v3, v0, 4, 2
    v_lshlrev_b32 v4, 4, v0
    s_waitcnt lgkmcnt(0)
    s_mov_b32 s12, s4
    s_and_b32 s13, s5, 0xffff
    s_mov_b32 s14, 0x240000
    s_mov_b32 s15, 0x20000
    s_mov_b32 s16, s28
    s_and_b32 s17, s29, 0xffff
    s_mov_b32 s18, 0x510000
    s_mov_b32 s19, 0x20000
    s_mov_b32 s20, s30
    s_and_b32 s21, s31, 0xffff
    s_mov_b32 s22, 0x510000
    s_mov_b32 s23, 0x20000
    s_mov_b32 s24, s6
    s_and_b32 s25, s7, 0xffff
    s_mov_b32 s26, 0x510000
    s_mov_b32 s27, 0x20000
    s_mov_b32 s8, s46
    s_and_b32 s9, s47, 0xffff
    s_mov_b32 s10, 0x10000000
    s_mov_b32 s11, 0x20000
    s_mov_b32 s68, 0
WT_22:
    buffer_load_dword v8, off, s[32:35], 0 offset:8 sc1
    s_waitcnt vmcnt(0)
    v_readfirstlane_b32 s70, v8
    s_nop 0
    s_cmp_ge_u32 s70, 1
    s_cbranch_scc1 WTX_23
    s_sleep 8
    s_add_u32 s68, s68, 1
    s_cmp_lt_u32 s68, 0x80000
    s_cbranch_scc1 WT_22
    s_branch L_exit
WTX_23:
    s_and_b32 s72, s37, 31
    s_lshl_b32 s72, s72, 7
    s_add_u32 s72, s72, 61931520
    s_mov_b32 s68, 0
WT_24:
    buffer_load_dword v8, off, s[8:11], s72 offset:0 sc1
    s_waitcnt vmcnt(0)
    v_readfirstlane_b32 s70, v8
    s_nop 0
    s_lshr_b32 s71, s70, 16
    s_and_b32 s70, s70, 0xffff
    s_min_u32 s70, s70, s71
    s_cmp_ge_u32 s70, 10
    s_cbranch_scc1 WTX_25
    s_sleep 16
    s_add_u32 s68, s68, 1
    s_cmp_lt_u32 s68, 0x80000
    s_cbranch_scc1 WT_24
    s_branch L_exit
WTX_25:
    s_lshl_b32 s46, s37, 8
    v_lshlrev_b32 v8, 2, v3
    v_xor_b32 v8, v8, v2
    v_lshlrev_b32 v8, 4, v8
    s_lshl_b32 s40, s36, 2
    v_add_u32 v9, s40, v3
    s_mov_b32 s41, 9216
    v_mul_lo_u32 v9, v9, s41
    v_add_u32 v8, v8, v9
    s_lshl_b32 s42, s36, 10
    s_add_u32 m0, s42, 0
    s_add_u32 s40, s46, 0
    buffer_load_dwordx4 v8, s[16:19], s40 offen lds
    s_add_u32 m0, s42, 4096
    s_add_u32 s40, s46, 147456
    buffer_load_dwordx4 v8, s[16:19], s40 offen lds
    s_add_u32 m0, s42, 8192
    s_add_u32 s40, s46, 294912
    buffer_load_dwordx4 v8, s[16:19], s40 offen lds
    s_add_u32 m0, s42, 12288
    s_add_u32 s40, s46, 442368
    buffer_load_dwordx4 v8, s[16:19], s40 offen lds
    s_add_u32 m0, s42, 16384
    s_add_u32 s40, s46, 589824
    buffer_load_dwordx4 v8, s[16:19], s40 offen lds
    s_add_u32 m0, s42, 20480
    s_add_u32 s40, s46, 737280
    buffer_load_dwordx4 v8, s[16:19], s40 offen lds
    s_add_u32 m0, s42, 24576
    s_add_u32 s40, s46, 884736
    buffer_load_dwordx4 v8, s[16:19], s40 offen lds
    s_add_u32 m0, s42, 28672
    s_add_u32 s40, s46, 1032192
    buffer_load_dwordx4 v8, s[16:19], s40 offen lds
    s_add_u32 m0, s42, 32768
    s_add_u32 s40, s46, 1179648
    buffer_load_dwordx4 v8, s[16:19], s40 offen lds
    s_add_u32 m0, s42, 36864
    s_add_u32 s40, s46, 1327104
    buffer_load_dwordx4 v8, s[16:19], s40 offen lds
    s_add_u32 m0, s42, 40960
    s_add_u32 s40, s46, 1474560
    buffer_load_dwordx4 v8, s[16:19], s40 offen lds
    s_add_u32 m0, s42, 45056
    s_add_u32 s40, s46, 1622016
    buffer_load_dwordx4 v8, s[16:19], s40 offen lds
    s_add_u32 m0, s42, 49152
    s_add_u32 s40, s46, 1769472
    buffer_load_dwordx4 v8, s[16:19], s40 offen lds
    s_add_u32 m0, s42, 53248
    s_add_u32 s40, s46, 1916928
    buffer_load_dwordx4 v8, s[16:19], s40 offen lds
    s_add_u32 m0, s42, 57344
    s_add_u32 s40, s46, 2064384
    buffer_load_dwordx4 v8, s[16:19], s40 offen lds
    s_add_u32 m0, s42, 61440
    s_add_u32 s40, s46, 2211840
    buffer_load_dwordx4 v8, s[16:19], s40 offen lds
    s_add_u32 m0, s42, 65536
    s_add_u32 s40, s46, 2359296
    buffer_load_dwordx4 v8, s[16:19], s40 offen lds
    s_add_u32 m0, s42, 69632
    s_add_u32 s40, s46, 2506752
    buffer_load_dwordx4 v8, s[16:19], s40 offen lds
    s_add_u32 m0, s42, 73728
    s_add_u32 s40, s46, 2654208
    buffer_load_dwordx4 v8, s[16:19], s40 offen lds
    s_add_u32 m0, s42, 77824
    s_add_u32 s40, s46, 2801664
    buffer_load_dwordx4 v8, s[16:19], s40 offen lds
    s_add_u32 m0, s42, 81920
    s_add_u32 s40, s46, 2949120
    buffer_load_dwordx4 v8, s[16:19], s40 offen lds
    s_add_u32 m0, s42, 86016
    s_add_u32 s40, s46, 3096576
    buffer_load_dwordx4 v8, s[16:19], s40 offen lds
    s_add_u32 m0, s42, 90112
    s_add_u32 s40, s46, 3244032
    buffer_load_dwordx4 v8, s[16:19], s40 offen lds
    s_add_u32 m0, s42, 94208
    s_add_u32 s40, s46, 3391488
    buffer_load_dwordx4 v8, s[16:19], s40 offen lds
    s_add_u32 m0, s42, 98304
    s_add_u32 s40, s46, 3538944
    buffer_load_dwordx4 v8, s[16:19], s40 offen lds
    s_add_u32 m0, s42, 102400
    s_add_u32 s40, s46, 3686400
    buffer_load_dwordx4 v8, s[16:19], s40 offen lds
    s_add_u32 m0, s42, 106496
    s_add_u32 s40, s46, 3833856
    buffer_load_dwordx4 v8, s[16:19], s40 offen lds
    s_add_u32 m0, s42, 110592
    s_add_u32 s40, s46, 3981312
    buffer_load_dwordx4 v8, s[16:19], s40 offen lds
    s_add_u32 m0, s42, 114688
    s_add_u32 s40, s46, 4128768
    buffer_load_dwordx4 v8, s[16:19], s40 offen lds
    s_add_u32 m0, s42, 118784
    s_add_u32 s40, s46, 4276224
    buffer_load_dwordx4 v8, s[16:19], s40 offen lds
    s_add_u32 m0, s42, 122880
    s_add_u32 s40, s46, 4423680
    buffer_load_dwordx4 v8, s[16:19], s40 offen lds
    s_add_u32 m0, s42, 126976
    s_add_u32 s40, s46, 4571136
    buffer_load_dwordx4 v8, s[16:19], s40 offen lds
    s_add_u32 m0, s42, 131072
    s_add_u32 s40, s46, 4718592
    buffer_load_dwordx4 v8, s[16:19], s40 offen lds
    s_add_u32 m0, s42, 135168
    s_add_u32 s40, s46, 4866048
    buffer_load_dwordx4 v8, s[16:19], s40 offen lds
    s_add_u32 m0, s42, 139264
    s_add_u32 s40, s46, 5013504
    buffer_load_dwordx4 v8, s[16:19], s40 offen lds
    s_add_u32 m0, s42, 143360
    s_add_u32 s40, s46, 5160960
    buffer_load_dwordx4 v8, s[16:19], s40 offen lds
    v_lshrrev_b32 v9, 2, v2
    v_lshl_add_u32 v10, v3, 3, v9
    v_lshlrev_b32 v10, 8, v10
    v_xor_b32 v9, s36, v9
    v_lshl_or_b32 v10, v9, 6, v10
    v_and_b32 v9, 3, v2
    v_lshl_or_b32 v10, v9, 4, v10
    v_add_u32 v11, 0xc000, v10
    v_add_u32 v12, 0x18000, v10
    s_waitcnt vmcnt(0)
    s_barrier
    ds_read_b64_tr_b16 a[0:1], v10 offset:0
    ds_read_b64_tr_b16 a[2:3], v10 offset:1024
    ds_read_b64_tr_b16 a[4:5], v10 offset:8
    ds_read_b64_tr_b16 a[6:7], v10 offset:1032
    ds_read_b64_tr_b16 a[8:9], v10 offset:8192
    ds_read_b64_tr_b16 a[10:11], v10 offset:9216
    ds_read_b64_tr_b16 a[12:13], v10 offset:8200
    ds_read_b64_tr_b16 a[14:15], v10 offset:9224
    ds_read_b64_tr_b16 a[16:17], v10 offset:16384
    ds_read_b64_tr_b16 a[18:19], v10 offset:17408
    ds_read_b64_tr_b16 a[20:21], v10 offset:16392
    ds_read_b64_tr_b16 a[22:23], v10 offset:17416
    ds_read_b64_tr_b16 a[24:25], v10 offset:24576
    ds_read_b64_tr_b16 a[26:27], v10 offset:25600
    ds_read_b64_tr_b16 a[28:29], v10 offset:24584
    ds_read_b64_tr_b16 a[30:31], v10 offset:25608
    ds_read_b64_tr_b16 a[32:33], v10 offset:32768
    ds_read_b64_tr_b16 a[34:35], v10 offset:33792
    ds_read_b64_tr_b16 a[36:37], v10 offset:32776
    ds_read_b64_tr_b16 a[38:39], v10 offset:33800
    ds_read_b64_tr_b16 a[40:41], v10 offset:40960
    ds_read_b64_tr_b16 a[42:43], v10 offset:41984
    ds_read_b64_tr_b16 a[44:45], v10 offset:40968
    ds_read_b64_tr_b16 a[46:47], v10 offset:41992
    ds_read_b64_tr_b16 a[48:49], v11 offset:0
    ds_read_b64_tr_b16 a[50:51], v11 offset:1024
    ds_read_b64_tr_b16 a[52:53], v11 offset:8
    ds_read_b64_tr_b16 a[54:55], v11 offset:1032
    ds_read_b64_tr_b16 a[56:57], v11 offset:8192
    ds_read_b64_tr_b16 a[58:59], v11 offset:9216
    ds_read_b64_tr_b16 a[60:61], v11 offset:8200
    ds_read_b64_tr_b16 a[62:63], v11 offset:9224
    ds_read_b64_tr_b16 a[64:65], v11 offset:16384
    ds_read_b64_tr_b16 a[66:67], v11 offset:17408
    ds_read_b64_tr_b16 a[68:69], v11 offset:16392
    ds_read_b64_tr_b16 a[70:71], v11 offset:17416
    ds_read_b64_tr_b16 a[72:73], v11 offset:24576
    ds_read_b64_tr_b16 a[74:75], v11 offset:25600
    ds_read_b64_tr_b16 a[76:77], v11 offset:24584
    ds_read_b64_tr_b16 a[78:79], v11 offset:25608
    ds_read_b64_tr_b16 a[80:81], v11 offset:32768
    ds_read_b64_tr_b16 a[82:83], v11 offset:33792
    ds_read_b64_tr_b16 a[84:85], v11 offset:32776
    ds_read_b64_tr_b16 a[86:87], v11 offset:33800
    ds_read_b64_tr_b16 a[88:89], v11 offset:40960
    ds_read_b64_tr_b16 a[90:91], v11 offset:41984
    ds_read_b64_tr_b16 a[92:93], v11 offset:40968
    ds_read_b64_tr_b16 a[94:95], v11 offset:41992
    ds_read_b64_tr_b16 a[96:97], v12 offset:0
    ds_read_b64_tr_b16 a[98:99], v12 offset:1024
    ds_read_b64_tr_b16 a[100:101], v12 offset:8
    ds_read_b64_tr_b16 a[102:103], v12 offset:1032
    ds_read_b64_tr_b16 a[104:105], v12 offset:8192
    ds_read_b64_tr_b16 a[106:107], v12 offset:9216
    ds_read_b64_tr_b16 a[108:109], v12 offset:8200
    ds_read_b64_tr_b16 a[110:111], v12 offset:9224
    ds_read_b64_tr_b16 a[112:113], v12 offset:16384
    ds_read_b64_tr_b16 a[114:115], v12 offset:17408
    ds_read_b64_tr_b16 a[116:117], v12 offset:16392
    ds_read_b64_tr_b16 a[118:119], v12 offset:17416
    ds_read_b64_tr_b16 a[120:121], v12 offset:24576
    ds_read_b64_tr_b16 a[122:123], v12 offset:25600
    ds_read_b64_tr_b16 a[124:125], v12 offset:24584
    ds_read_b64_tr_b16 a[126:127], v12 offset:25608
    ds_read_b64_tr_b16 a[128:129], v12 offset:32768
    ds_read_b64_tr_b16 a[130:131], v12 offset:33792
    ds_read_b64_tr_b16 a[132:133], v12 offset:32776
    ds_read_b64_tr_b16 a[134:135], v12 offset:33800
    ds_read_b64_tr_b16 a[136:137], v12 offset:40960
    ds_read_b64_tr_b16 a[138:139], v12 offset:41984
    ds_read_b64_tr_b16 a[140:141], v12 offset:40968
    ds_read_b64_tr_b16 a[142:143], v12 offset:41992
    s_waitcnt lgkmcnt(0)
    s_barrier
    v_lshlrev_b32 v8, 2, v3
    v_xor_b32 v8, v8, v2
    v_lshlrev_b32 v8, 4, v8
    s_lshl_b32 s40, s36, 2
    v_add_u32 v9, s40, v3
    s_mov_b32 s41, 9216
    v_mul_lo_u32 v9, v9, s41
    v_add_u32 v8, v8, v9
    s_lshl_b32 s42, s36, 10
    s_add_u32 m0, s42, 0
    s_add_u32 s40, s46, 0
    buffer_load_dwordx4 v8, s[20:23], s40 offen lds
    s_add_u32 m0, s42, 4096
    s_add_u32 s40, s46, 147456
    buffer_load_dwordx4 v8, s[20:23], s40 offen lds
    s_add_u32 m0, s42, 8192
    s_add_u32 s40, s46, 294912
    buffer_load_dwordx4 v8, s[20:23], s40 offen lds
    s_add_u32 m0, s42, 12288
    s_add_u32 s40, s46, 442368
    buffer_load_dwordx4 v8, s[20:23], s40 offen lds
    s_add_u32 m0, s42, 16384
    s_add_u32 s40, s46, 589824
    buffer_load_dwordx4 v8, s[20:23], s40 offen lds
    s_add_u32 m0, s42, 20480
    s_add_u32 s40, s46, 737280
    buffer_load_dwordx4 v8, s[20:23], s40 offen lds
    s_add_u32 m0, s42, 24576
    s_add_u32 s40, s46, 884736
    buffer_load_dwordx4 v8, s[20:23], s40 offen lds
    s_add_u32 m0, s42, 28672
    s_add_u32 s40, s46, 1032192
    buffer_load_dwordx4 v8, s[20:23], s40 offen lds
    s_add_u32 m0, s42, 32768
    s_add_u32 s40, s46, 1179648
    buffer_load_dwordx4 v8, s[20:23], s40 offen lds
    s_add_u32 m0, s42, 36864
    s_add_u32 s40, s46, 1327104
    buffer_load_dwordx4 v8, s[20:23], s40 offen lds
    s_add_u32 m0, s42, 40960
    s_add_u32 s40, s46, 1474560
    buffer_load_dwordx4 v8, s[20:23], s40 offen lds
    s_add_u32 m0, s42, 45056
    s_add_u32 s40, s46, 1622016
    buffer_load_dwordx4 v8, s[20:23], s40 offen lds
    s_add_u32 m0, s42, 49152
    s_add_u32 s40, s46, 1769472
    buffer_load_dwordx4 v8, s[20:23], s40 offen lds
    s_add_u32 m0, s42, 53248
    s_add_u32 s40, s46, 1916928
    buffer_load_dwordx4 v8, s[20:23], s40 offen lds
    s_add_u32 m0, s42, 57344
    s_add_u32 s40, s46, 2064384
    buffer_load_dwordx4 v8, s[20:23], s40 offen lds
    s_add_u32 m0, s42, 61440
    s_add_u32 s40, s46, 2211840
    buffer_load_dwordx4 v8, s[20:23], s40 offen lds
    s_add_u32 m0, s42, 65536
    s_add_u32 s40, s46, 2359296
    buffer_load_dwordx4 v8, s[20:23], s40 offen lds
    s_add_u32 m0, s42, 69632
    s_add_u32 s40, s46, 2506752
    buffer_load_dwordx4 v8, s[20:23], s40 offen lds
    s_add_u32 m0, s42, 73728
    s_add_u32 s40, s46, 2654208
    buffer_load_dwordx4 v8, s[20:23], s40 offen lds
    s_add_u32 m0, s42, 77824
    s_add_u32 s40, s46, 2801664
    buffer_load_dwordx4 v8, s[20:23], s40 offen lds
    s_add_u32 m0, s42, 81920
    s_add_u32 s40, s46, 2949120
    buffer_load_dwordx4 v8, s[20:23], s40 offen lds
    s_add_u32 m0, s42, 86016
    s_add_u32 s40, s46, 3096576
    buffer_load_dwordx4 v8, s[20:23], s40 offen lds
    s_add_u32 m0, s42, 90112
    s_add_u32 s40, s46, 3244032
    buffer_load_dwordx4 v8, s[20:23], s40 offen lds
    s_add_u32 m0, s42, 94208
    s_add_u32 s40, s46, 3391488
    buffer_load_dwordx4 v8, s[20:23], s40 offen lds
    s_add_u32 m0, s42, 98304
    s_add_u32 s40, s46, 3538944
    buffer_load_dwordx4 v8, s[20:23], s40 offen lds
    s_add_u32 m0, s42, 102400
    s_add_u32 s40, s46, 3686400
    buffer_load_dwordx4 v8, s[20:23], s40 offen lds
    s_add_u32 m0, s42, 106496
    s_add_u32 s40, s46, 3833856
    buffer_load_dwordx4 v8, s[20:23], s40 offen lds
    s_add_u32 m0, s42, 110592
    s_add_u32 s40, s46, 3981312
    buffer_load_dwordx4 v8, s[20:23], s40 offen lds
    s_add_u32 m0, s42, 114688
    s_add_u32 s40, s46, 4128768
    buffer_load_dwordx4 v8, s[20:23], s40 offen lds
    s_add_u32 m0, s42, 118784
    s_add_u32 s40, s46, 4276224
    buffer_load_dwordx4 v8, s[20:23], s40 offen lds
    s_add_u32 m0, s42, 122880
    s_add_u32 s40, s46, 4423680
    buffer_load_dwordx4 v8, s[20:23], s40 offen lds
    s_add_u32 m0, s42, 126976
    s_add_u32 s40, s46, 4571136
    buffer_load_dwordx4 v8, s[20:23], s40 offen lds
    s_add_u32 m0, s42, 131072
    s_add_u32 s40, s46, 4718592
    buffer_load_dwordx4 v8, s[20:23], s40 offen lds
    s_add_u32 m0, s42, 135168
    s_add_u32 s40, s46, 4866048
    buffer_load_dwordx4 v8, s[20:23], s40 offen lds
    s_add_u32 m0, s42, 139264
    s_add_u32 s40, s46, 5013504
    buffer_load_dwordx4 v8, s[20:23], s40 offen lds
    s_add_u32 m0, s42, 143360
    s_add_u32 s40, s46, 5160960
    buffer_load_dwordx4 v8, s[20:23], s40 offen lds
    v_lshrrev_b32 v9, 2, v2
    v_lshl_add_u32 v10, v3, 3, v9
    v_lshlrev_b32 v10, 8, v10
    v_xor_b32 v9, s36, v9
    v_lshl_or_b32 v10, v9, 6, v10
    v_and_b32 v9, 3, v2
    v_lshl_or_b32 v10, v9, 4, v10
    v_add_u32 v11, 0xc000, v10
    v_add_u32 v12, 0x18000, v10
    s_waitcnt vmcnt(0)
    s_barrier
    ds_read_b64_tr_b16 v[112:113], v10 offset:0
    ds_read_b64_tr_b16 v[114:115], v10 offset:1024
    ds_read_b64_tr_b16 v[116:117], v10 offset:8
    ds_read_b64_tr_b16 v[118:119], v10 offset:1032
    ds_read_b64_tr_b16 v[120:121], v10 offset:8192
    ds_read_b64_tr_b16 v[122:123], v10 offset:9216
    ds_read_b64_tr_b16 v[124:125], v10 offset:8200
    ds_read_b64_tr_b16 v[126:127], v10 offset:9224
    ds_read_b64_tr_b16 v[128:129], v10 offset:16384
    ds_read_b64_tr_b16 v[130:131], v10 offset:17408
    ds_read_b64_tr_b16 v[132:133], v10 offset:16392
    ds_read_b64_tr_b16 v[134:135], v10 offset:17416
    ds_read_b64_tr_b16 v[136:137], v10 offset:24576
    ds_read_b64_tr_b16 v[138:139], v10 offset:25600
    ds_read_b64_tr_b16 v[140:141], v10 offset:24584
    ds_read_b64_tr_b16 v[142:143], v10 offset:25608
    ds_read_b64_tr_b16 v[144:145], v10 offset:32768
    ds_read_b64_tr_b16 v[146:147], v10 offset:33792
    ds_read_b64_tr_b16 v[148:149], v10 offset:32776
    ds_read_b64_tr_b16 v[150:151], v10 offset:33800
    ds_read_b64_tr_b16 v[152:153], v10 offset:40960
    ds_read_b64_tr_b16 v[154:155], v10 offset:41984
    ds_read_b64_tr_b16 v[156:157], v10 offset:40968
    ds_read_b64_tr_b16 v[158:159], v10 offset:41992
    ds_read_b64_tr_b16 v[160:161], v11 offset:0
    ds_read_b64_tr_b16 v[162:163], v11 offset:1024
    ds_read_b64_tr_b16 v[164:165], v11 offset:8
    ds_read_b64_tr_b16 v[166:167], v11 offset:1032
    ds_read_b64_tr_b16 v[168:169], v11 offset:8192
    ds_read_b64_tr_b16 v[170:171], v11 offset:9216
    ds_read_b64_tr_b16 v[172:173], v11 offset:8200
    ds_read_b64_tr_b16 v[174:175], v11 offset:9224
    ds_read_b64_tr_b16 v[176:177], v11 offset:16384
    ds_read_b64_tr_b16 v[178:179], v11 offset:17408
    ds_read_b64_tr_b16 v[180:181], v11 offset:16392
    ds_read_b64_tr_b16 v[182:183], v11 offset:17416
    ds_read_b64_tr_b16 v[184:185], v11 offset:24576
    ds_read_b64_tr_b16 v[186:187], v11 offset:25600
    ds_read_b64_tr_b16 v[188:189], v11 offset:24584
    ds_read_b64_tr_b16 v[190:191], v11 offset:25608
    ds_read_b64_tr_b16 v[192:193], v11 offset:32768
    ds_read_b64_tr_b16 v[194:195], v11 offset:33792
    ds_read_b64_tr_b16 v[196:197], v11 offset:32776
    ds_read_b64_tr_b16 v[198:199], v11 offset:33800
    ds_read_b64_tr_b16 v[200:201], v11 offset:40960
    ds_read_b64_tr_b16 v[202:203], v11 offset:41984
    ds_read_b64_tr_b16 v[204:205], v11 offset:40968
    ds_read_b64_tr_b16 v[206:207], v11 offset:41992
    ds_read_b64_tr_b16 v[208:209], v12 offset:0
    ds_read_b64_tr_b16 v[210:211], v12 offset:1024
    ds_read_b64_tr_b16 v[212:213], v12 offset:8
    ds_read_b64_tr_b16 v[214:215], v12 offset:1032
    ds_read_b64_tr_b16 v[216:217], v12 offset:8192
    ds_read_b64_tr_b16 v[218:219], v12 offset:9216
    ds_read_b64_tr_b16 v[220:221], v12 offset:8200
    ds_read_b64_tr_b16 v[222:223], v12 offset:9224
    ds_read_b64_tr_b16 v[224:225], v12 offset:16384
    ds_read_b64_tr_b16 v[226:227], v12 offset:17408
    ds_read_b64_tr_b16 v[228:229], v12 offset:16392
    ds_read_b64_tr_b16 v[230:231], v12 offset:17416
    ds_read_b64_tr_b16 v[232:233], v12 offset:24576
    ds_read_b64_tr_b16 v[234:235], v12 offset:25600
    ds_read_b64_tr_b16 v[236:237], v12 offset:24584
    ds_read_b64_tr_b16 v[238:239], v12 offset:25608
    ds_read_b64_tr_b16 v[240:241], v12 offset:32768
    ds_read_b64_tr_b16 v[242:243], v12 offset:33792
    ds_read_b64_tr_b16 v[244:245], v12 offset:32776
    ds_read_b64_tr_b16 v[246:247], v12 offset:33800
    ds_read_b64_tr_b16 v[248:249], v12 offset:40960
    ds_read_b64_tr_b16 v[250:251], v12 offset:41984
    ds_read_b64_tr_b16 v[252:253], v12 offset:40968
    ds_read_b64_tr_b16 v[254:255], v12 offset:41992
    s_waitcnt lgkmcnt(0)
    s_barrier
    s_mul_i32 s46, s37, 147456
    s_lshl_b32 s42, s36, 10
    s_add_u32 m0, s42, 0
    s_add_u32 s40, s46, 0
    buffer_load_dwordx4 v4, s[24:27], s40 offen lds
    s_add_u32 m0, s42, 4096
    s_add_u32 s40, s46, 4096
    buffer_load_dwordx4 v4, s[24:27], s40 offen lds
    s_add_u32 m0, s42, 8192
    s_add_u32 s40, s46, 8192
    buffer_load_dwordx4 v4, s[24:27], s40 offen lds
    s_add_u32 m0, s42, 12288
    s_add_u32 s40, s46, 12288
    buffer_load_dwordx4 v4, s[24:27], s40 offen lds
    s_add_u32 m0, s42, 16384
    s_add_u32 s40, s46, 16384
    buffer_load_dwordx4 v4, s[24:27], s40 offen lds
    s_add_u32 m0, s42, 20480
    s_add_u32 s40, s46, 20480
    buffer_load_dwordx4 v4, s[24:27], s40 offen lds
    s_add_u32 m0, s42, 24576
    s_add_u32 s40, s46, 24576
    buffer_load_dwordx4 v4, s[24:27], s40 offen lds
    s_add_u32 m0, s42, 28672
    s_add_u32 s40, s46, 28672
    buffer_load_dwordx4 v4, s[24:27], s40 offen lds
    s_add_u32 m0, s42, 32768
    s_add_u32 s40, s46, 32768
    buffer_load_dwordx4 v4, s[24:27], s40 offen lds
    s_add_u32 m0, s42, 36864
    s_add_u32 s40, s46, 36864
    buffer_load_dwordx4 v4, s[24:27], s40 offen lds
    s_add_u32 m0, s42, 40960
    s_add_u32 s40, s46, 40960
    buffer_load_dwordx4 v4, s[24:27], s40 offen lds
    s_add_u32 m0, s42, 45056
    s_add_u32 s40, s46, 45056
    buffer_load_dwordx4 v4, s[24:27], s40 offen lds
    s_add_u32 m0, s42, 49152
    s_add_u32 s40, s46, 49152
    buffer_load_dwordx4 v4, s[24:27], s40 offen lds
    s_add_u32 m0, s42, 53248
    s_add_u32 s40, s46, 53248
    buffer_load_dwordx4 v4, s[24:27], s40 offen lds
    s_add_u32 m0, s42, 57344
    s_add_u32 s40, s46, 57344
    buffer_load_dwordx4 v4, s[24:27], s40 offen lds
    s_add_u32 m0, s42, 61440
    s_add_u32 s40, s46, 61440
    buffer_load_dwordx4 v4, s[24:27], s40 offen lds
    s_add_u32 m0, s42, 65536
    s_add_u32 s40, s46, 65536
    buffer_load_dwordx4 v4, s[24:27], s40 offen lds
    s_add_u32 m0, s42, 69632
    s_add_u32 s40, s46, 69632
    buffer_load_dwordx4 v4, s[24:27], s40 offen lds
    s_add_u32 m0, s42, 73728
    s_add_u32 s40, s46, 73728
    buffer_load_dwordx4 v4, s[24:27], s40 offen lds
    s_add_u32 m0, s42, 77824
    s_add_u32 s40, s46, 77824
    buffer_load_dwordx4 v4, s[24:27], s40 offen lds
    s_add_u32 m0, s42, 81920
    s_add_u32 s40, s46, 81920
    buffer_load_dwordx4 v4, s[24:27], s40 offen lds
    s_add_u32 m0, s42, 86016
    s_add_u32 s40, s46, 86016
    buffer_load_dwordx4 v4, s[24:27], s40 offen lds
    s_add_u32 m0, s42, 90112
    s_add_u32 s40, s46, 90112
    buffer_load_dwordx4 v4, s[24:27], s40 offen lds
    s_add_u32 m0, s42, 94208
    s_add_u32 s40, s46, 94208
    buffer_load_dwordx4 v4, s[24:27], s40 offen lds
    s_add_u32 m0, s42, 98304
    s_add_u32 s40, s46, 98304
    buffer_load_dwordx4 v4, s[24:27], s40 offen lds
    s_add_u32 m0, s42, 102400
    s_add_u32 s40, s46, 102400
    buffer_load_dwordx4 v4, s[24:27], s40 offen lds
    s_add_u32 m0, s42, 106496
    s_add_u32 s40, s46, 106496
    buffer_load_dwordx4 v4, s[24:27], s40 offen lds
    s_add_u32 m0, s42, 110592
    s_add_u32 s40, s46, 110592
    buffer_load_dwordx4 v4, s[24:27], s40 offen lds
    s_add_u32 m0, s42, 114688
    s_add_u32 s40, s46, 114688
    buffer_load_dwordx4 v4, s[24:27], s40 offen lds
    s_add_u32 m0, s42, 118784
    s_add_u32 s40, s46, 118784
    buffer_load_dwordx4 v4, s[24:27], s40 offen lds
    s_add_u32 m0, s42, 122880
    s_add_u32 s40, s46, 122880
    buffer_load_dwordx4 v4, s[24:27], s40 offen lds
    s_add_u32 m0, s42, 126976
    s_add_u32 s40, s46, 126976
    buffer_load_dwordx4 v4, s[24:27], s40 offen lds
    s_add_u32 m0, s42, 131072
    s_add_u32 s40, s46, 131072
    buffer_load_dwordx4 v4, s[24:27], s40 offen lds
    s_add_u32 m0, s42, 135168
    s_add_u32 s40, s46, 135168
    buffer_load_dwordx4 v4, s[24:27], s40 offen lds
    s_add_u32 m0, s42, 139264
    s_add_u32 s40, s46, 139264
    buffer_load_dwordx4 v4, s[24:27], s40 offen lds
    s_add_u32 m0, s42, 143360
    s_add_u32 s40, s46, 143360
    buffer_load_dwordx4 v4, s[24:27], s40 offen lds
    s_mov_b32 s68, 0
WT_26:
    buffer_load_dword v8, off, s[32:35], 0 offset:132 sc1
    s_waitcnt vmcnt(0)
    v_readfirstlane_b32 s70, v8
    s_nop 0
    s_cmp_ge_u32 s70, 32
    s_cbranch_scc1 WTX_27
    s_sleep 4
    s_add_u32 s68, s68, 1
    s_cmp_lt_u32 s68, 0x80000
    s_cbranch_scc1 WT_26
    s_branch L_exit
WTX_27:
    v_lshlrev_b32 v8, 4, v1
    s_mov_b32 s40, 60817408
    s_mov_b32 s41, 60821504
    buffer_load_dwordx4 v[16:19], v8, s[8:11], s40 offen offset:0 sc1
    buffer_load_dwordx4 v[20:23], v8, s[8:11], s40 offen offset:1024 sc1
    buffer_load_dwordx4 v[24:27], v8, s[8:11], s40 offen offset:2048 sc1
    buffer_load_dwordx4 v[28:31], v8, s[8:11], s40 offen offset:3072 sc1
    buffer_load_dwordx4 v[32:35], v8, s[8:11], s41 offen offset:0 sc1
    buffer_load_dwordx4 v[36:39], v8, s[8:11], s41 offen offset:1024 sc1
    buffer_load_dwordx4 v[40:43], v8, s[8:11], s41 offen offset:2048 sc1
    buffer_load_dwordx4 v[44:47], v8, s[8:11], s41 offen offset:3072 sc1
    v_lshlrev_b32 v9, 2, v1
    v_sub_u32 v9, 2047, v9
    s_waitcnt vmcnt(0)
    v_ashrrev_i32 v10, 31, v16
    v_or_b32 v10, 0x80000000, v10
    v_xor_b32 v16, v16, v10
    v_and_b32 v16, 0xffff0000, v16
    v_subrev_u32 v10, 0, v9
    v_or_b32 v16, v16, v10
    v_ashrrev_i32 v10, 31, v17
    v_or_b32 v10, 0x80000000, v10
    v_xor_b32 v17, v17, v10
    v_and_b32 v17, 0xffff0000, v17
    v_subrev_u32 v10, 1, v9
    v_or_b32 v17, v17, v10
    v_ashrrev_i32 v10, 31, v18
    v_or_b32 v10, 0x80000000, v10
    v_xor_b32 v18, v18, v10
    v_and_b32 v18, 0xffff0000, v18
    v_subrev_u32 v10, 2, v9
    v_or_b32 v18, v18, v10
    v_ashrrev_i32 v10, 31, v19
    v_or_b32 v10, 0x80000000, v10
    v_xor_b32 v19, v19, v10
    v_and_b32 v19, 0xffff0000, v19
    v_subrev_u32 v10, 3, v9
    v_or_b32 v19, v19, v10
    v_ashrrev_i32 v10, 31, v20
    v_or_b32 v10, 0x80000000, v10
    v_xor_b32 v20, v20, v10
    v_and_b32 v20, 0xffff0000, v20
    v_subrev_u32 v10, 256, v9
    v_or_b32 v20, v20, v10
    v_ashrrev_i32 v10, 31, v21
    v_or_b32 v10, 0x80000000, v10
    v_xor_b32 v21, v21, v10
    v_and_b32 v21, 0xffff0000, v21
    v_subrev_u32 v10, 257, v9
    v_or_b32 v21, v21, v10
    v_ashrrev_i32 v10, 31, v22
    v_or_b32 v10, 0x80000000, v10
    v_xor_b32 v22, v22, v10
    v_and_b32 v22, 0xffff0000, v22
    v_subrev_u32 v10, 258, v9
    v_or_b32 v22, v22, v10
    v_ashrrev_i32 v10, 31, v23
    v_or_b32 v10, 0x80000000, v10
    v_xor_b32 v23, v23, v10
    v_and_b32 v23, 0xffff0000, v23
    v_subrev_u32 v10, 259, v9
    v_or_b32 v23, v23, v10
    v_ashrrev_i32 v10, 31, v24
    v_or_b32 v10, 0x80000000, v10
    v_xor_b32 v24, v24, v10
    v_and_b32 v24, 0xffff0000, v24
    v_subrev_u32 v10, 512, v9
    v_or_b32 v24, v24, v10
    v_ashrrev_i32 v10, 31, v25
    v_or_b32 v10, 0x80000000, v10
    v_xor_b32 v25, v25, v10
    v_and_b32 v25, 0xffff0000, v25
    v_subrev_u32 v10, 513, v9
    v_or_b32 v25, v25, v10
    v_ashrrev_i32 v10, 31, v26
    v_or_b32 v10, 0x80000000, v10
    v_xor_b32 v26, v26, v10
    v_and_b32 v26, 0xffff0000, v26
    v_subrev_u32 v10, 514, v9
    v_or_b32 v26, v26, v10
    v_ashrrev_i32 v10, 31, v27
    v_or_b32 v10, 0x80000000, v10
    v_xor_b32 v27, v27, v10
    v_and_b32 v27, 0xffff0000, v27
    v_subrev_u32 v10, 515, v9
    v_or_b32 v27, v27, v10
    v_ashrrev_i32 v10, 31, v28
    v_or_b32 v10, 0x80000000, v10
    v_xor_b32 v28, v28, v10
    v_and_b32 v28, 0xffff0000, v28
    v_subrev_u32 v10, 768, v9
    v_or_b32 v28, v28, v10
    v_ashrrev_i32 v10, 31, v29
    v_or_b32 v10, 0x80000000, v10
    v_xor_b32 v29, v29, v10
    v_and_b32 v29, 0xffff0000, v29
    v_subrev_u32 v10, 769, v9
    v_or_b32 v29, v29, v10
    v_ashrrev_i32 v10, 31, v30
    v_or_b32 v10, 0x80000000, v10
    v_xor_b32 v30, v30, v10
    v_and_b32 v30, 0xffff0000, v30
    v_subrev_u32 v10, 770, v9
    v_or_b32 v30, v30, v10
    v_ashrrev_i32 v10, 31, v31
    v_or_b32 v10, 0x80000000, v10
    v_xor_b32 v31, v31, v10
    v_and_b32 v31, 0xffff0000, v31
    v_subrev_u32 v10, 771, v9
    v_or_b32 v31, v31, v10
    v_ashrrev_i32 v10, 31, v32
    v_or_b32 v10, 0x80000000, v10
    v_xor_b32 v32, v32, v10
    v_and_b32 v32, 0xffff0000, v32
    v_subrev_u32 v10, 1024, v9
    v_or_b32 v32, v32, v10
    v_ashrrev_i32 v10, 31, v33
    v_or_b32 v10, 0x80000000, v10
    v_xor_b32 v33, v33, v10
    v_and_b32 v33, 0xffff0000, v33
    v_subrev_u32 v10, 1025, v9
    v_or_b32 v33, v33, v10
    v_ashrrev_i32 v10, 31, v34
    v_or_b32 v10, 0x80000000, v10
    v_xor_b32 v34, v34, v10
    v_and_b32 v34, 0xffff0000, v34
    v_subrev_u32 v10, 1026, v9
    v_or_b32 v34, v34, v10
    v_ashrrev_i32 v10, 31, v35
    v_or_b32 v10, 0x80000000, v10
    v_xor_b32 v35, v35, v10
    v_and_b32 v35, 0xffff0000, v35
    v_subrev_u32 v10, 1027, v9
    v_or_b32 v35, v35, v10
    v_ashrrev_i32 v10, 31, v36
    v_or_b32 v10, 0x80000000, v10
    v_xor_b32 v36, v36, v10
    v_and_b32 v36, 0xffff0000, v36
    v_subrev_u32 v10, 1280, v9
    v_or_b32 v36, v36, v10
    v_ashrrev_i32 v10, 31, v37
    v_or_b32 v10, 0x80000000, v10
    v_xor_b32 v37, v37, v10
    v_and_b32 v37, 0xffff0000, v37
    v_subrev_u32 v10, 1281, v9
    v_or_b32 v37, v37, v10
    v_ashrrev_i32 v10, 31, v38
    v_or_b32 v10, 0x80000000, v10
    v_xor_b32 v38, v38, v10
    v_and_b32 v38, 0xffff0000, v38
    v_subrev_u32 v10, 1282, v9
    v_or_b32 v38, v38, v10
    v_ashrrev_i32 v10, 31, v39
    v_or_b32 v10, 0x80000000, v10
    v_xor_b32 v39, v39, v10
    v_and_b32 v39, 0xffff0000, v39
    v_subrev_u32 v10, 1283, v9
    v_or_b32 v39, v39, v10
    v_ashrrev_i32 v10, 31, v40
    v_or_b32 v10, 0x80000000, v10
    v_xor_b32 v40, v40, v10
    v_and_b32 v40, 0xffff0000, v40
    v_subrev_u32 v10, 1536, v9
    v_or_b32 v40, v40, v10
    v_ashrrev_i32 v10, 31, v41
    v_or_b32 v10, 0x80000000, v10
    v_xor_b32 v41, v41, v10
    v_and_b32 v41, 0xffff0000, v41
    v_subrev_u32 v10, 1537, v9
    v_or_b32 v41, v41, v10
    v_ashrrev_i32 v10, 31, v42
    v_or_b32 v10, 0x80000000, v10
    v_xor_b32 v42, v42, v10
    v_and_b32 v42, 0xffff0000, v42
    v_subrev_u32 v10, 1538, v9
    v_or_b32 v42, v42, v10
    v_ashrrev_i32 v10, 31, v43
    v_or_b32 v10, 0x80000000, v10
    v_xor_b32 v43, v43, v10
    v_and_b32 v43, 0xffff0000, v43
    v_subrev_u32 v10, 1539, v9
    v_or_b32 v43, v43, v10
    v_ashrrev_i32 v10, 31, v44
    v_or_b32 v10, 0x80000000, v10
    v_xor_b32 v44, v44, v10
    v_and_b32 v44, 0xffff0000, v44
    v_subrev_u32 v10, 1792, v9
    v_or_b32 v44, v44, v10
    v_ashrrev_i32 v10, 31, v45
    v_or_b32 v10, 0x80000000, v10
    v_xor_b32 v45, v45, v10
    v_and_b32 v45, 0xffff0000, v45
    v_subrev_u32 v10, 1793, v9
    v_or_b32 v45, v45, v10
    v_ashrrev_i32 v10, 31, v46
    v_or_b32 v10, 0x80000000, v10
    v_xor_b32 v46, v46, v10
    v_and_b32 v46, 0xffff0000, v46
    v_subrev_u32 v10, 1794, v9
    v_or_b32 v46, v46, v10
    v_ashrrev_i32 v10, 31, v47
    v_or_b32 v10, 0x80000000, v10
    v_xor_b32 v47, v47, v10
    v_and_b32 v47, 0xffff0000, v47
    v_subrev_u32 v10, 1795, v9
    v_or_b32 v47, v47, v10
    v_max3_u32 v48, v16, v17, v18
    v_max3_u32 v48, v48, v19, v20
    v_max3_u32 v48, v48, v21, v22
    v_max3_u32 v48, v48, v23, v24
    v_max3_u32 v48, v48, v25, v26
    v_max3_u32 v48, v48, v27, v28
    v_max3_u32 v48, v48, v29, v30
    v_max3_u32 v48, v48, v31, v32
    v_max3_u32 v48, v48, v33, v34
    v_max3_u32 v48, v48, v35, v36
    v_max3_u32 v48, v48, v37, v38
    v_max3_u32 v48, v48, v39, v40
    v_max3_u32 v48, v48, v41, v42
    v_max3_u32 v48, v48, v43, v44
    v_max3_u32 v48, v48, v45, v46
    v_max_u32 v48, v48, v47
    s_nop 1
    v_max_u32_dpp v48, v48, v48 quad_perm:[1,0,3,2] row_mask:0xf bank_mask:0xf
    s_nop 1
    v_max_u32_dpp v48, v48, v48 quad_perm:[2,3,0,1] row_mask:0xf bank_mask:0xf
    s_nop 1
    v_max_u32_dpp v48, v48, v48 row_half_mirror row_mask:0xf bank_mask:0xf
    s_nop 1
    v_max_u32_dpp v48, v48, v48 row_mirror row_mask:0xf bank_mask:0xf
    v_mov_b32 v49, v48
    s_nop 1
    v_permlane16_swap_b32 v49, v48
    v_max_u32 v48, v49, v48
    v_mov_b32 v49, v48
    s_nop 1
    v_permlane32_swap_b32 v49, v48
    v_max_u32 v48, v49, v48
    s_nop 0
    v_readfirstlane_b32 s48, v48
    v_cmp_ne_u32 vcc, v48, v16
    s_nop 1
    v_cndmask_b32 v16, 0, v16, vcc
    v_cmp_ne_u32 vcc, v48, v17
    s_nop 1
    v_cndmask_b32 v17, 0, v17, vcc
    v_cmp_ne_u32 vcc, v48, v18
    s_nop 1
    v_cndmask_b32 v18, 0, v18, vcc
    v_cmp_ne_u32 vcc, v48, v19
    s_nop 1
    v_cndmask_b32 v19, 0, v19, vcc
    v_cmp_ne_u32 vcc, v48, v20
    s_nop 1
    v_cndmask_b32 v20, 0, v20, vcc
    v_cmp_ne_u32 vcc, v48, v21
    s_nop 1
    v_cndmask_b32 v21, 0, v21, vcc
    v_cmp_ne_u32 vcc, v48, v22
    s_nop 1
    v_cndmask_b32 v22, 0, v22, vcc
    v_cmp_ne_u32 vcc, v48, v23
    s_nop 1
    v_cndmask_b32 v23, 0, v23, vcc
    v_cmp_ne_u32 vcc, v48, v24
    s_nop 1
    v_cndmask_b32 v24, 0, v24, vcc
    v_cmp_ne_u32 vcc, v48, v25
    s_nop 1
    v_cndmask_b32 v25, 0, v25, vcc
    v_cmp_ne_u32 vcc, v48, v26
    s_nop 1
    v_cndmask_b32 v26, 0, v26, vcc
    v_cmp_ne_u32 vcc, v48, v27
    s_nop 1
    v_cndmask_b32 v27, 0, v27, vcc
    v_cmp_ne_u32 vcc, v48, v28
    s_nop 1
    v_cndmask_b32 v28, 0, v28, vcc
    v_cmp_ne_u32 vcc, v48, v29
    s_nop 1
    v_cndmask_b32 v29, 0, v29, vcc
    v_cmp_ne_u32 vcc, v48, v30
    s_nop 1
    v_cndmask_b32 v30, 0, v30, vcc
    v_cmp_ne_u32 vcc, v48, v31
    s_nop 1
    v_cndmask_b32 v31, 0, v31, vcc
    v_cmp_ne_u32 vcc, v48, v32
    s_nop 1
    v_cndmask_b32 v32, 0, v32, vcc
    v_cmp_ne_u32 vcc, v48, v33
    s_nop 1
    v_cndmask_b32 v33, 0, v33, vcc
    v_cmp_ne_u32 vcc, v48, v34
    s_nop 1
    v_cndmask_b32 v34, 0, v34, vcc
    v_cmp_ne_u32 vcc, v48, v35
    s_nop 1
    v_cndmask_b32 v35, 0, v35, vcc
    v_cmp_ne_u32 vcc, v48, v36
    s_nop 1
    v_cndmask_b32 v36, 0, v36, vcc
    v_cmp_ne_u32 vcc, v48, v37
    s_nop 1
    v_cndmask_b32 v37, 0, v37, vcc
    v_cmp_ne_u32 vcc, v48, v38
    s_nop 1
    v_cndmask_b32 v38, 0, v38, vcc
    v_cmp_ne_u32 vcc, v48, v39
    s_nop 1
    v_cndmask_b32 v39, 0, v39, vcc
    v_cmp_ne_u32 vcc, v48, v40
    s_nop 1
    v_cndmask_b32 v40, 0, v40, vcc
    v_cmp_ne_u32 vcc, v48, v41
    s_nop 1
    v_cndmask_b32 v41, 0, v41, vcc
    v_cmp_ne_u32 vcc, v48, v42
    s_nop 1
    v_cndmask_b32 v42, 0, v42, vcc
    v_cmp_ne_u32 vcc, v48, v43
    s_nop 1
    v_cndmask_b32 v43, 0, v43, vcc
    v_cmp_ne_u32 vcc, v48, v44
    s_nop 1
    v_cndmask_b32 v44, 0, v44, vcc
    v_cmp_ne_u32 vcc, v48, v45
    s_nop 1
    v_cndmask_b32 v45, 0, v45, vcc
    v_cmp_ne_u32 vcc, v48, v46
    s_nop 1
    v_cndmask_b32 v46, 0, v46, vcc
    v_cmp_ne_u32 vcc, v48, v47
    s_nop 1
    v_cndmask_b32 v47, 0, v47, vcc
    v_max3_u32 v48, v16, v17, v18
    v_max3_u32 v48, v48, v19, v20
    v_max3_u32 v48, v48, v21, v22
    v_max3_u32 v48, v48, v23, v24
    v_max3_u32 v48, v48, v25, v26
    v_max3_u32 v48, v48, v27, v28
    v_max3_u32 v48, v48, v29, v30
    v_max3_u32 v48, v48, v31, v32
    v_max3_u32 v48, v48, v33, v34
    v_max3_u32 v48, v48, v35, v36
    v_max3_u32 v48, v48, v37, v38
    v_max3_u32 v48, v48, v39, v40
    v_max3_u32 v48, v48, v41, v42
    v_max3_u32 v48, v48, v43, v44
    v_max3_u32 v48, v48, v45, v46
    v_max_u32 v48, v48, v47
    s_nop 1
    v_max_u32_dpp v48, v48, v48 quad_perm:[1,0,3,2] row_mask:0xf bank_mask:0xf
    s_nop 1
    v_max_u32_dpp v48, v48, v48 quad_perm:[2,3,0,1] row_mask:0xf bank_mask:0xf
    s_nop 1
    v_max_u32_dpp v48, v48, v48 row_half_mirror row_mask:0xf bank_mask:0xf
    s_nop 1
    v_max_u32_dpp v48, v48, v48 row_mirror row_mask:0xf bank_mask:0xf
    v_mov_b32 v49, v48
    s_nop 1
    v_permlane16_swap_b32 v49, v48
    v_max_u32 v48, v49, v48
    v_mov_b32 v49, v48
    s_nop 1
    v_permlane32_swap_b32 v49, v48
    v_max_u32 v48, v49, v48
    s_nop 0
    v_readfirstlane_b32 s49, v48
    v_cmp_ne_u32 vcc, v48, v16
    s_nop 1
    v_cndmask_b32 v16, 0, v16, vcc
    v_cmp_ne_u32 vcc, v48, v17
    s_nop 1
    v_cndmask_b32 v17, 0, v17, vcc
    v_cmp_ne_u32 vcc, v48, v18
    s_nop 1
    v_cndmask_b32 v18, 0, v18, vcc
    v_cmp_ne_u32 vcc, v48, v19
    s_nop 1
    v_cndmask_b32 v19, 0, v19, vcc
    v_cmp_ne_u32 vcc, v48, v20
    s_nop 1
    v_cndmask_b32 v20, 0, v20, vcc
    v_cmp_ne_u32 vcc, v48, v21
    s_nop 1
    v_cndmask_b32 v21, 0, v21, vcc
    v_cmp_ne_u32 vcc, v48, v22
    s_nop 1
    v_cndmask_b32 v22, 0, v22, vcc
    v_cmp_ne_u32 vcc, v48, v23
    s_nop 1
    v_cndmask_b32 v23, 0, v23, vcc
    v_cmp_ne_u32 vcc, v48, v24
    s_nop 1
    v_cndmask_b32 v24, 0, v24, vcc
    v_cmp_ne_u32 vcc, v48, v25
    s_nop 1
    v_cndmask_b32 v25, 0, v25, vcc
    v_cmp_ne_u32 vcc, v48, v26
    s_nop 1
    v_cndmask_b32 v26, 0, v26, vcc
    v_cmp_ne_u32 vcc, v48, v27
    s_nop 1
    v_cndmask_b32 v27, 0, v27, vcc
    v_cmp_ne_u32 vcc, v48, v28
    s_nop 1
    v_cndmask_b32 v28, 0, v28, vcc
    v_cmp_ne_u32 vcc, v48, v29
    s_nop 1
    v_cndmask_b32 v29, 0, v29, vcc
    v_cmp_ne_u32 vcc, v48, v30
    s_nop 1
    v_cndmask_b32 v30, 0, v30, vcc
    v_cmp_ne_u32 vcc, v48, v31
    s_nop 1
    v_cndmask_b32 v31, 0, v31, vcc
    v_cmp_ne_u32 vcc, v48, v32
    s_nop 1
    v_cndmask_b32 v32, 0, v32, vcc
    v_cmp_ne_u32 vcc, v48, v33
    s_nop 1
    v_cndmask_b32 v33, 0, v33, vcc
    v_cmp_ne_u32 vcc, v48, v34
    s_nop 1
    v_cndmask_b32 v34, 0, v34, vcc
    v_cmp_ne_u32 vcc, v48, v35
    s_nop 1
    v_cndmask_b32 v35, 0, v35, vcc
    v_cmp_ne_u32 vcc, v48, v36
    s_nop 1
    v_cndmask_b32 v36, 0, v36, vcc
    v_cmp_ne_u32 vcc, v48, v37
    s_nop 1
    v_cndmask_b32 v37, 0, v37, vcc
    v_cmp_ne_u32 vcc, v48, v38
    s_nop 1
    v_cndmask_b32 v38, 0, v38, vcc
    v_cmp_ne_u32 vcc, v48, v39
    s_nop 1
    v_cndmask_b32 v39, 0, v39, vcc
    v_cmp_ne_u32 vcc, v48, v40
    s_nop 1
    v_cndmask_b32 v40, 0, v40, vcc
    v_cmp_ne_u32 vcc, v48, v41
    s_nop 1
    v_cndmask_b32 v41, 0, v41, vcc
    v_cmp_ne_u32 vcc, v48, v42
    s_nop 1
    v_cndmask_b32 v42, 0, v42, vcc
    v_cmp_ne_u32 vcc, v48, v43
    s_nop 1
    v_cndmask_b32 v43, 0, v43, vcc
    v_cmp_ne_u32 vcc, v48, v44
    s_nop 1
    v_cndmask_b32 v44, 0, v44, vcc
    v_cmp_ne_u32 vcc, v48, v45
    s_nop 1
    v_cndmask_b32 v45, 0, v45, vcc
    v_cmp_ne_u32 vcc, v48, v46
    s_nop 1
    v_cndmask_b32 v46, 0, v46, vcc
    v_cmp_ne_u32 vcc, v48, v47
    s_nop 1
    v_cndmask_b32 v47, 0, v47, vcc
    v_max3_u32 v48, v16, v17, v18
    v_max3_u32 v48, v48, v19, v20
    v_max3_u32 v48, v48, v21, v22
    v_max3_u32 v48, v48, v23, v24
    v_max3_u32 v48, v48, v25, v26
    v_max3_u32 v48, v48, v27, v28
    v_max3_u32 v48, v48, v29, v30
    v_max3_u32 v48, v48, v31, v32
    v_max3_u32 v48, v48, v33, v34
    v_max3_u32 v48, v48, v35, v36
    v_max3_u32 v48, v48, v37, v38
    v_max3_u32 v48, v48, v39, v40
    v_max3_u32 v48, v48, v41, v42
    v_max3_u32 v48, v48, v43, v44
    v_max3_u32 v48, v48, v45, v46
    v_max_u32 v48, v48, v47
    s_nop 1
    v_max_u32_dpp v48, v48, v48 quad_perm:[1,0,3,2] row_mask:0xf bank_mask:0xf
    s_nop 1
    v_max_u32_dpp v48, v48, v48 quad_perm:[2,3,0,1] row_mask:0xf bank_mask:0xf
    s_nop 1
    v_max_u32_dpp v48, v48, v48 row_half_mirror row_mask:0xf bank_mask:0xf
    s_nop 1
    v_max_u32_dpp v48, v48, v48 row_mirror row_mask:0xf bank_mask:0xf
    v_mov_b32 v49, v48
    s_nop 1
    v_permlane16_swap_b32 v49, v48
    v_max_u32 v48, v49, v48
    v_mov_b32 v49, v48
    s_nop 1
    v_permlane32_swap_b32 v49, v48
    v_max_u32 v48, v49, v48
    s_nop 0
    v_readfirstlane_b32 s50, v48
    v_cmp_ne_u32 vcc, v48, v16
    s_nop 1
    v_cndmask_b32 v16, 0, v16, vcc
    v_cmp_ne_u32 vcc, v48, v17
    s_nop 1
    v_cndmask_b32 v17, 0, v17, vcc
    v_cmp_ne_u32 vcc, v48, v18
    s_nop 1
    v_cndmask_b32 v18, 0, v18, vcc
    v_cmp_ne_u32 vcc, v48, v19
    s_nop 1
    v_cndmask_b32 v19, 0, v19, vcc
    v_cmp_ne_u32 vcc, v48, v20
    s_nop 1
    v_cndmask_b32 v20, 0, v20, vcc
    v_cmp_ne_u32 vcc, v48, v21
    s_nop 1
    v_cndmask_b32 v21, 0, v21, vcc
    v_cmp_ne_u32 vcc, v48, v22
    s_nop 1
    v_cndmask_b32 v22, 0, v22, vcc
    v_cmp_ne_u32 vcc, v48, v23
    s_nop 1
    v_cndmask_b32 v23, 0, v23, vcc
    v_cmp_ne_u32 vcc, v48, v24
    s_nop 1
    v_cndmask_b32 v24, 0, v24, vcc
    v_cmp_ne_u32 vcc, v48, v25
    s_nop 1
    v_cndmask_b32 v25, 0, v25, vcc
    v_cmp_ne_u32 vcc, v48, v26
    s_nop 1
    v_cndmask_b32 v26, 0, v26, vcc
    v_cmp_ne_u32 vcc, v48, v27
    s_nop 1
    v_cndmask_b32 v27, 0, v27, vcc
    v_cmp_ne_u32 vcc, v48, v28
    s_nop 1
    v_cndmask_b32 v28, 0, v28, vcc
    v_cmp_ne_u32 vcc, v48, v29
    s_nop 1
    v_cndmask_b32 v29, 0, v29, vcc
    v_cmp_ne_u32 vcc, v48, v30
    s_nop 1
    v_cndmask_b32 v30, 0, v30, vcc
    v_cmp_ne_u32 vcc, v48, v31
    s_nop 1
    v_cndmask_b32 v31, 0, v31, vcc
    v_cmp_ne_u32 vcc, v48, v32
    s_nop 1
    v_cndmask_b32 v32, 0, v32, vcc
    v_cmp_ne_u32 vcc, v48, v33
    s_nop 1
    v_cndmask_b32 v33, 0, v33, vcc
    v_cmp_ne_u32 vcc, v48, v34
    s_nop 1
    v_cndmask_b32 v34, 0, v34, vcc
    v_cmp_ne_u32 vcc, v48, v35
    s_nop 1
    v_cndmask_b32 v35, 0, v35, vcc
    v_cmp_ne_u32 vcc, v48, v36
    s_nop 1
    v_cndmask_b32 v36, 0, v36, vcc
    v_cmp_ne_u32 vcc, v48, v37
    s_nop 1
    v_cndmask_b32 v37, 0, v37, vcc
    v_cmp_ne_u32 vcc, v48, v38
    s_nop 1
    v_cndmask_b32 v38, 0, v38, vcc
    v_cmp_ne_u32 vcc, v48, v39
    s_nop 1
    v_cndmask_b32 v39, 0, v39, vcc
    v_cmp_ne_u32 vcc, v48, v40
    s_nop 1
    v_cndmask_b32 v40, 0, v40, vcc
    v_cmp_ne_u32 vcc, v48, v41
    s_nop 1
    v_cndmask_b32 v41, 0, v41, vcc
    v_cmp_ne_u32 vcc, v48, v42
    s_nop 1
    v_cndmask_b32 v42, 0, v42, vcc
    v_cmp_ne_u32 vcc, v48, v43
    s_nop 1
    v_cndmask_b32 v43, 0, v43, vcc
    v_cmp_ne_u32 vcc, v48, v44
    s_nop 1
    v_cndmask_b32 v44, 0, v44, vcc
    v_cmp_ne_u32 vcc, v48, v45
    s_nop 1
    v_cndmask_b32 v45, 0, v45, vcc
    v_cmp_ne_u32 vcc, v48, v46
    s_nop 1
    v_cndmask_b32 v46, 0, v46, vcc
    v_cmp_ne_u32 vcc, v48, v47
    s_nop 1
    v_cndmask_b32 v47, 0, v47, vcc
    v_max3_u32 v48, v16, v17, v18
    v_max3_u32 v48, v48, v19, v20
    v_max3_u32 v48, v48, v21, v22
    v_max3_u32 v48, v48, v23, v24
    v_max3_u32 v48, v48, v25, v26
    v_max3_u32 v48, v48, v27, v28
    v_max3_u32 v48, v48, v29, v30
    v_max3_u32 v48, v48, v31, v32
    v_max3_u32 v48, v48, v33, v34
    v_max3_u32 v48, v48, v35, v36
    v_max3_u32 v48, v48, v37, v38
    v_max3_u32 v48, v48, v39, v40
    v_max3_u32 v48, v48, v41, v42
    v_max3_u32 v48, v48, v43, v44
    v_max3_u32 v48, v48, v45, v46
    v_max_u32 v48, v48, v47
    s_nop 1
    v_max_u32_dpp v48, v48, v48 quad_perm:[1,0,3,2] row_mask:0xf bank_mask:0xf
    s_nop 1
    v_max_u32_dpp v48, v48, v48 quad_perm:[2,3,0,1] row_mask:0xf bank_mask:0xf
    s_nop 1
    v_max_u32_dpp v48, v48, v48 row_half_mirror row_mask:0xf bank_mask:0xf
    s_nop 1
    v_max_u32_dpp v48, v48, v48 row_mirror row_mask:0xf bank_mask:0xf
    v_mov_b32 v49, v48
    s_nop 1
    v_permlane16_swap_b32 v49, v48
    v_max_u32 v48, v49, v48
    v_mov_b32 v49, v48
    s_nop 1
    v_permlane32_swap_b32 v49, v48
    v_max_u32 v48, v49, v48
    s_nop 0
    v_readfirstlane_b32 s51, v48
    v_cmp_ne_u32 vcc, v48, v16
    s_nop 1
    v_cndmask_b32 v16, 0, v16, vcc
    v_cmp_ne_u32 vcc, v48, v17
    s_nop 1
    v_cndmask_b32 v17, 0, v17, vcc
    v_cmp_ne_u32 vcc, v48, v18
    s_nop 1
    v_cndmask_b32 v18, 0, v18, vcc
    v_cmp_ne_u32 vcc, v48, v19
    s_nop 1
    v_cndmask_b32 v19, 0, v19, vcc
    v_cmp_ne_u32 vcc, v48, v20
    s_nop 1
    v_cndmask_b32 v20, 0, v20, vcc
    v_cmp_ne_u32 vcc, v48, v21
    s_nop 1
    v_cndmask_b32 v21, 0, v21, vcc
    v_cmp_ne_u32 vcc, v48, v22
    s_nop 1
    v_cndmask_b32 v22, 0, v22, vcc
    v_cmp_ne_u32 vcc, v48, v23
    s_nop 1
    v_cndmask_b32 v23, 0, v23, vcc
    v_cmp_ne_u32 vcc, v48, v24
    s_nop 1
    v_cndmask_b32 v24, 0, v24, vcc
    v_cmp_ne_u32 vcc, v48, v25
    s_nop 1
    v_cndmask_b32 v25, 0, v25, vcc
    v_cmp_ne_u32 vcc, v48, v26
    s_nop 1
    v_cndmask_b32 v26, 0, v26, vcc
    v_cmp_ne_u32 vcc, v48, v27
    s_nop 1
    v_cndmask_b32 v27, 0, v27, vcc
    v_cmp_ne_u32 vcc, v48, v28
    s_nop 1
    v_cndmask_b32 v28, 0, v28, vcc
    v_cmp_ne_u32 vcc, v48, v29
    s_nop 1
    v_cndmask_b32 v29, 0, v29, vcc
    v_cmp_ne_u32 vcc, v48, v30
    s_nop 1
    v_cndmask_b32 v30, 0, v30, vcc
    v_cmp_ne_u32 vcc, v48, v31
    s_nop 1
    v_cndmask_b32 v31, 0, v31, vcc
    v_cmp_ne_u32 vcc, v48, v32
    s_nop 1
    v_cndmask_b32 v32, 0, v32, vcc
    v_cmp_ne_u32 vcc, v48, v33
    s_nop 1
    v_cndmask_b32 v33, 0, v33, vcc
    v_cmp_ne_u32 vcc, v48, v34
    s_nop 1
    v_cndmask_b32 v34, 0, v34, vcc
    v_cmp_ne_u32 vcc, v48, v35
    s_nop 1
    v_cndmask_b32 v35, 0, v35, vcc
    v_cmp_ne_u32 vcc, v48, v36
    s_nop 1
    v_cndmask_b32 v36, 0, v36, vcc
    v_cmp_ne_u32 vcc, v48, v37
    s_nop 1
    v_cndmask_b32 v37, 0, v37, vcc
    v_cmp_ne_u32 vcc, v48, v38
    s_nop 1
    v_cndmask_b32 v38, 0, v38, vcc
    v_cmp_ne_u32 vcc, v48, v39
    s_nop 1
    v_cndmask_b32 v39, 0, v39, vcc
    v_cmp_ne_u32 vcc, v48, v40
    s_nop 1
    v_cndmask_b32 v40, 0, v40, vcc
    v_cmp_ne_u32 vcc, v48, v41
    s_nop 1
    v_cndmask_b32 v41, 0, v41, vcc
    v_cmp_ne_u32 vcc, v48, v42
    s_nop 1
    v_cndmask_b32 v42, 0, v42, vcc
    v_cmp_ne_u32 vcc, v48, v43
    s_nop 1
    v_cndmask_b32 v43, 0, v43, vcc
    v_cmp_ne_u32 vcc, v48, v44
    s_nop 1
    v_cndmask_b32 v44, 0, v44, vcc
    v_cmp_ne_u32 vcc, v48, v45
    s_nop 1
    v_cndmask_b32 v45, 0, v45, vcc
    v_cmp_ne_u32 vcc, v48, v46
    s_nop 1
    v_cndmask_b32 v46, 0, v46, vcc
    v_cmp_ne_u32 vcc, v48, v47
    s_nop 1
    v_cndmask_b32 v47, 0, v47, vcc
    v_max3_u32 v48, v16, v17, v18
    v_max3_u32 v48, v48, v19, v20
    v_max3_u32 v48, v48, v21, v22
    v_max3_u32 v48, v48, v23, v24
    v_max3_u32 v48, v48, v25, v26
    v_max3_u32 v48, v48, v27, v28
    v_max3_u32 v48, v48, v29, v30
    v_max3_u32 v48, v48, v31, v32
    v_max3_u32 v48, v48, v33, v34
    v_max3_u32 v48, v48, v35, v36
    v_max3_u32 v48, v48, v37, v38
    v_max3_u32 v48, v48, v39, v40
    v_max3_u32 v48, v48, v41, v42
    v_max3_u32 v48, v48, v43, v44
    v_max3_u32 v48, v48, v45, v46
    v_max_u32 v48, v48, v47
    s_nop 1
    v_max_u32_dpp v48, v48, v48 quad_perm:[1,0,3,2] row_mask:0xf bank_mask:0xf
    s_nop 1
    v_max_u32_dpp v48, v48, v48 quad_perm:[2,3,0,1] row_mask:0xf bank_mask:0xf
    s_nop 1
    v_max_u32_dpp v48, v48, v48 row_half_mirror row_mask:0xf bank_mask:0xf
    s_nop 1
    v_max_u32_dpp v48, v48, v48 row_mirror row_mask:0xf bank_mask:0xf
    v_mov_b32 v49, v48
    s_nop 1
    v_permlane16_swap_b32 v49, v48
    v_max_u32 v48, v49, v48
    v_mov_b32 v49, v48
    s_nop 1
    v_permlane32_swap_b32 v49, v48
    v_max_u32 v48, v49, v48
    s_nop 0
    v_readfirstlane_b32 s52, v48
    v_cmp_ne_u32 vcc, v48, v16
    s_nop 1
    v_cndmask_b32 v16, 0, v16, vcc
    v_cmp_ne_u32 vcc, v48, v17
    s_nop 1
    v_cndmask_b32 v17, 0, v17, vcc
    v_cmp_ne_u32 vcc, v48, v18
    s_nop 1
    v_cndmask_b32 v18, 0, v18, vcc
    v_cmp_ne_u32 vcc, v48, v19
    s_nop 1
    v_cndmask_b32 v19, 0, v19, vcc
    v_cmp_ne_u32 vcc, v48, v20
    s_nop 1
    v_cndmask_b32 v20, 0, v20, vcc
    v_cmp_ne_u32 vcc, v48, v21
    s_nop 1
    v_cndmask_b32 v21, 0, v21, vcc
    v_cmp_ne_u32 vcc, v48, v22
    s_nop 1
    v_cndmask_b32 v22, 0, v22, vcc
    v_cmp_ne_u32 vcc, v48, v23
    s_nop 1
    v_cndmask_b32 v23, 0, v23, vcc
    v_cmp_ne_u32 vcc, v48, v24
    s_nop 1
    v_cndmask_b32 v24, 0, v24, vcc
    v_cmp_ne_u32 vcc, v48, v25
    s_nop 1
    v_cndmask_b32 v25, 0, v25, vcc
    v_cmp_ne_u32 vcc, v48, v26
    s_nop 1
    v_cndmask_b32 v26, 0, v26, vcc
    v_cmp_ne_u32 vcc, v48, v27
    s_nop 1
    v_cndmask_b32 v27, 0, v27, vcc
    v_cmp_ne_u32 vcc, v48, v28
    s_nop 1
    v_cndmask_b32 v28, 0, v28, vcc
    v_cmp_ne_u32 vcc, v48, v29
    s_nop 1
    v_cndmask_b32 v29, 0, v29, vcc
    v_cmp_ne_u32 vcc, v48, v30
    s_nop 1
    v_cndmask_b32 v30, 0, v30, vcc
    v_cmp_ne_u32 vcc, v48, v31
    s_nop 1
    v_cndmask_b32 v31, 0, v31, vcc
    v_cmp_ne_u32 vcc, v48, v32
    s_nop 1
    v_cndmask_b32 v32, 0, v32, vcc
    v_cmp_ne_u32 vcc, v48, v33
    s_nop 1
    v_cndmask_b32 v33, 0, v33, vcc
    v_cmp_ne_u32 vcc, v48, v34
    s_nop 1
    v_cndmask_b32 v34, 0, v34, vcc
    v_cmp_ne_u32 vcc, v48, v35
    s_nop 1
    v_cndmask_b32 v35, 0, v35, vcc
    v_cmp_ne_u32 vcc, v48, v36
    s_nop 1
    v_cndmask_b32 v36, 0, v36, vcc
    v_cmp_ne_u32 vcc, v48, v37
    s_nop 1
    v_cndmask_b32 v37, 0, v37, vcc
    v_cmp_ne_u32 vcc, v48, v38
    s_nop 1
    v_cndmask_b32 v38, 0, v38, vcc
    v_cmp_ne_u32 vcc, v48, v39
    s_nop 1
    v_cndmask_b32 v39, 0, v39, vcc
    v_cmp_ne_u32 vcc, v48, v40
    s_nop 1
    v_cndmask_b32 v40, 0, v40, vcc
    v_cmp_ne_u32 vcc, v48, v41
    s_nop 1
    v_cndmask_b32 v41, 0, v41, vcc
    v_cmp_ne_u32 vcc, v48, v42
    s_nop 1
    v_cndmask_b32 v42, 0, v42, vcc
    v_cmp_ne_u32 vcc, v48, v43
    s_nop 1
    v_cndmask_b32 v43, 0, v43, vcc
    v_cmp_ne_u32 vcc, v48, v44
    s_nop 1
    v_cndmask_b32 v44, 0, v44, vcc
    v_cmp_ne_u32 vcc, v48, v45
    s_nop 1
    v_cndmask_b32 v45, 0, v45, vcc
    v_cmp_ne_u32 vcc, v48, v46
    s_nop 1
    v_cndmask_b32 v46, 0, v46, vcc
    v_cmp_ne_u32 vcc, v48, v47
    s_nop 1
    v_cndmask_b32 v47, 0, v47, vcc
    v_max3_u32 v48, v16, v17, v18
    v_max3_u32 v48, v48, v19, v20
    v_max3_u32 v48, v48, v21, v22
    v_max3_u32 v48, v48, v23, v24
    v_max3_u32 v48, v48, v25, v26
    v_max3_u32 v48, v48, v27, v28
    v_max3_u32 v48, v48, v29, v30
    v_max3_u32 v48, v48, v31, v32
    v_max3_u32 v48, v48, v33, v34
    v_max3_u32 v48, v48, v35, v36
    v_max3_u32 v48, v48, v37, v38
    v_max3_u32 v48, v48, v39, v40
    v_max3_u32 v48, v48, v41, v42
    v_max3_u32 v48, v48, v43, v44
    v_max3_u32 v48, v48, v45, v46
    v_max_u32 v48, v48, v47
    s_nop 1
    v_max_u32_dpp v48, v48, v48 quad_perm:[1,0,3,2] row_mask:0xf bank_mask:0xf
    s_nop 1
    v_max_u32_dpp v48, v48, v48 quad_perm:[2,3,0,1] row_mask:0xf bank_mask:0xf
    s_nop 1
    v_max_u32_dpp v48, v48, v48 row_half_mirror row_mask:0xf bank_mask:0xf
    s_nop 1
    v_max_u32_dpp v48, v48, v48 row_mirror row_mask:0xf bank_mask:0xf
    v_mov_b32 v49, v48
    s_nop 1
    v_permlane16_swap_b32 v49, v48
    v_max_u32 v48, v49, v48
    v_mov_b32 v49, v48
    s_nop 1
    v_permlane32_swap_b32 v49, v48
    v_max_u32 v48, v49, v48
    s_nop 0
    v_readfirstlane_b32 s53, v48
    v_cmp_ne_u32 vcc, v48, v16
    s_nop 1
    v_cndmask_b32 v16, 0, v16, vcc
    v_cmp_ne_u32 vcc, v48, v17
    s_nop 1
    v_cndmask_b32 v17, 0, v17, vcc
    v_cmp_ne_u32 vcc, v48, v18
    s_nop 1
    v_cndmask_b32 v18, 0, v18, vcc
    v_cmp_ne_u32 vcc, v48, v19
    s_nop 1
    v_cndmask_b32 v19, 0, v19, vcc
    v_cmp_ne_u32 vcc, v48, v20
    s_nop 1
    v_cndmask_b32 v20, 0, v20, vcc
    v_cmp_ne_u32 vcc, v48, v21
    s_nop 1
    v_cndmask_b32 v21, 0, v21, vcc
    v_cmp_ne_u32 vcc, v48, v22
    s_nop 1
    v_cndmask_b32 v22, 0, v22, vcc
    v_cmp_ne_u32 vcc, v48, v23
    s_nop 1
    v_cndmask_b32 v23, 0, v23, vcc
    v_cmp_ne_u32 vcc, v48, v24
    s_nop 1
    v_cndmask_b32 v24, 0, v24, vcc
    v_cmp_ne_u32 vcc, v48, v25
    s_nop 1
    v_cndmask_b32 v25, 0, v25, vcc
    v_cmp_ne_u32 vcc, v48, v26
    s_nop 1
    v_cndmask_b32 v26, 0, v26, vcc
    v_cmp_ne_u32 vcc, v48, v27
    s_nop 1
    v_cndmask_b32 v27, 0, v27, vcc
    v_cmp_ne_u32 vcc, v48, v28
    s_nop 1
    v_cndmask_b32 v28, 0, v28, vcc
    v_cmp_ne_u32 vcc, v48, v29
    s_nop 1
    v_cndmask_b32 v29, 0, v29, vcc
    v_cmp_ne_u32 vcc, v48, v30
    s_nop 1
    v_cndmask_b32 v30, 0, v30, vcc
    v_cmp_ne_u32 vcc, v48, v31
    s_nop 1
    v_cndmask_b32 v31, 0, v31, vcc
    v_cmp_ne_u32 vcc, v48, v32
    s_nop 1
    v_cndmask_b32 v32, 0, v32, vcc
    v_cmp_ne_u32 vcc, v48, v33
    s_nop 1
    v_cndmask_b32 v33, 0, v33, vcc
    v_cmp_ne_u32 vcc, v48, v34
    s_nop 1
    v_cndmask_b32 v34, 0, v34, vcc
    v_cmp_ne_u32 vcc, v48, v35
    s_nop 1
    v_cndmask_b32 v35, 0, v35, vcc
    v_cmp_ne_u32 vcc, v48, v36
    s_nop 1
    v_cndmask_b32 v36, 0, v36, vcc
    v_cmp_ne_u32 vcc, v48, v37
    s_nop 1
    v_cndmask_b32 v37, 0, v37, vcc
    v_cmp_ne_u32 vcc, v48, v38
    s_nop 1
    v_cndmask_b32 v38, 0, v38, vcc
    v_cmp_ne_u32 vcc, v48, v39
    s_nop 1
    v_cndmask_b32 v39, 0, v39, vcc
    v_cmp_ne_u32 vcc, v48, v40
    s_nop 1
    v_cndmask_b32 v40, 0, v40, vcc
    v_cmp_ne_u32 vcc, v48, v41
    s_nop 1
    v_cndmask_b32 v41, 0, v41, vcc
    v_cmp_ne_u32 vcc, v48, v42
    s_nop 1
    v_cndmask_b32 v42, 0, v42, vcc
    v_cmp_ne_u32 vcc, v48, v43
    s_nop 1
    v_cndmask_b32 v43, 0, v43, vcc
    v_cmp_ne_u32 vcc, v48, v44
    s_nop 1
    v_cndmask_b32 v44, 0, v44, vcc
    v_cmp_ne_u32 vcc, v48, v45
    s_nop 1
    v_cndmask_b32 v45, 0, v45, vcc
    v_cmp_ne_u32 vcc, v48, v46
    s_nop 1
    v_cndmask_b32 v46, 0, v46, vcc
    v_cmp_ne_u32 vcc, v48, v47
    s_nop 1
    v_cndmask_b32 v47, 0, v47, vcc
    v_max3_u32 v48, v16, v17, v18
    v_max3_u32 v48, v48, v19, v20
    v_max3_u32 v48, v48, v21, v22
    v_max3_u32 v48, v48, v23, v24
    v_max3_u32 v48, v48, v25, v26
    v_max3_u32 v48, v48, v27, v28
    v_max3_u32 v48, v48, v29, v30
    v_max3_u32 v48, v48, v31, v32
    v_max3_u32 v48, v48, v33, v34
    v_max3_u32 v48, v48, v35, v36
    v_max3_u32 v48, v48, v37, v38
    v_max3_u32 v48, v48, v39, v40
    v_max3_u32 v48, v48, v41, v42
    v_max3_u32 v48, v48, v43, v44
    v_max3_u32 v48, v48, v45, v46
    v_max_u32 v48, v48, v47
    s_nop 1
    v_max_u32_dpp v48, v48, v48 quad_perm:[1,0,3,2] row_mask:0xf bank_mask:0xf
    s_nop 1
    v_max_u32_dpp v48, v48, v48 quad_perm:[2,3,0,1] row_mask:0xf bank_mask:0xf
    s_nop 1
    v_max_u32_dpp v48, v48, v48 row_half_mirror row_mask:0xf bank_mask:0xf
    s_nop 1
    v_max_u32_dpp v48, v48, v48 row_mirror row_mask:0xf bank_mask:0xf
    v_mov_b32 v49, v48
    s_nop 1
    v_permlane16_swap_b32 v49, v48
    v_max_u32 v48, v49, v48
    v_mov_b32 v49, v48
    s_nop 1
    v_permlane32_swap_b32 v49, v48
    v_max_u32 v48, v49, v48
    s_nop 0
    v_readfirstlane_b32 s54, v48
    v_cmp_ne_u32 vcc, v48, v16
    s_nop 1
    v_cndmask_b32 v16, 0, v16, vcc
    v_cmp_ne_u32 vcc, v48, v17
    s_nop 1
    v_cndmask_b32 v17, 0, v17, vcc
    v_cmp_ne_u32 vcc, v48, v18
    s_nop 1
    v_cndmask_b32 v18, 0, v18, vcc
    v_cmp_ne_u32 vcc, v48, v19
    s_nop 1
    v_cndmask_b32 v19, 0, v19, vcc
    v_cmp_ne_u32 vcc, v48, v20
    s_nop 1
    v_cndmask_b32 v20, 0, v20, vcc
    v_cmp_ne_u32 vcc, v48, v21
    s_nop 1
    v_cndmask_b32 v21, 0, v21, vcc
    v_cmp_ne_u32 vcc, v48, v22
    s_nop 1
    v_cndmask_b32 v22, 0, v22, vcc
    v_cmp_ne_u32 vcc, v48, v23
    s_nop 1
    v_cndmask_b32 v23, 0, v23, vcc
    v_cmp_ne_u32 vcc, v48, v24
    s_nop 1
    v_cndmask_b32 v24, 0, v24, vcc
    v_cmp_ne_u32 vcc, v48, v25
    s_nop 1
    v_cndmask_b32 v25, 0, v25, vcc
    v_cmp_ne_u32 vcc, v48, v26
    s_nop 1
    v_cndmask_b32 v26, 0, v26, vcc
    v_cmp_ne_u32 vcc, v48, v27
    s_nop 1
    v_cndmask_b32 v27, 0, v27, vcc
    v_cmp_ne_u32 vcc, v48, v28
    s_nop 1
    v_cndmask_b32 v28, 0, v28, vcc
    v_cmp_ne_u32 vcc, v48, v29
    s_nop 1
    v_cndmask_b32 v29, 0, v29, vcc
    v_cmp_ne_u32 vcc, v48, v30
    s_nop 1
    v_cndmask_b32 v30, 0, v30, vcc
    v_cmp_ne_u32 vcc, v48, v31
    s_nop 1
    v_cndmask_b32 v31, 0, v31, vcc
    v_cmp_ne_u32 vcc, v48, v32
    s_nop 1
    v_cndmask_b32 v32, 0, v32, vcc
    v_cmp_ne_u32 vcc, v48, v33
    s_nop 1
    v_cndmask_b32 v33, 0, v33, vcc
    v_cmp_ne_u32 vcc, v48, v34
    s_nop 1
    v_cndmask_b32 v34, 0, v34, vcc
    v_cmp_ne_u32 vcc, v48, v35
    s_nop 1
    v_cndmask_b32 v35, 0, v35, vcc
    v_cmp_ne_u32 vcc, v48, v36
    s_nop 1
    v_cndmask_b32 v36, 0, v36, vcc
    v_cmp_ne_u32 vcc, v48, v37
    s_nop 1
    v_cndmask_b32 v37, 0, v37, vcc
    v_cmp_ne_u32 vcc, v48, v38
    s_nop 1
    v_cndmask_b32 v38, 0, v38, vcc
    v_cmp_ne_u32 vcc, v48, v39
    s_nop 1
    v_cndmask_b32 v39, 0, v39, vcc
    v_cmp_ne_u32 vcc, v48, v40
    s_nop 1
    v_cndmask_b32 v40, 0, v40, vcc
    v_cmp_ne_u32 vcc, v48, v41
    s_nop 1
    v_cndmask_b32 v41, 0, v41, vcc
    v_cmp_ne_u32 vcc, v48, v42
    s_nop 1
    v_cndmask_b32 v42, 0, v42, vcc
    v_cmp_ne_u32 vcc, v48, v43
    s_nop 1
    v_cndmask_b32 v43, 0, v43, vcc
    v_cmp_ne_u32 vcc, v48, v44
    s_nop 1
    v_cndmask_b32 v44, 0, v44, vcc
    v_cmp_ne_u32 vcc, v48, v45
    s_nop 1
    v_cndmask_b32 v45, 0, v45, vcc
    v_cmp_ne_u32 vcc, v48, v46
    s_nop 1
    v_cndmask_b32 v46, 0, v46, vcc
    v_cmp_ne_u32 vcc, v48, v47
    s_nop 1
    v_cndmask_b32 v47, 0, v47, vcc
    v_max3_u32 v48, v16, v17, v18
    v_max3_u32 v48, v48, v19, v20
    v_max3_u32 v48, v48, v21, v22
    v_max3_u32 v48, v48, v23, v24
    v_max3_u32 v48, v48, v25, v26
    v_max3_u32 v48, v48, v27, v28
    v_max3_u32 v48, v48, v29, v30
    v_max3_u32 v48, v48, v31, v32
    v_max3_u32 v48, v48, v33, v34
    v_max3_u32 v48, v48, v35, v36
    v_max3_u32 v48, v48, v37, v38
    v_max3_u32 v48, v48, v39, v40
    v_max3_u32 v48, v48, v41, v42
    v_max3_u32 v48, v48, v43, v44
    v_max3_u32 v48, v48, v45, v46
    v_max_u32 v48, v48, v47
    s_nop 1
    v_max_u32_dpp v48, v48, v48 quad_perm:[1,0,3,2] row_mask:0xf bank_mask:0xf
    s_nop 1
    v_max_u32_dpp v48, v48, v48 quad_perm:[2,3,0,1] row_mask:0xf bank_mask:0xf
    s_nop 1
    v_max_u32_dpp v48, v48, v48 row_half_mirror row_mask:0xf bank_mask:0xf
    s_nop 1
    v_max_u32_dpp v48, v48, v48 row_mirror row_mask:0xf bank_mask:0xf
    v_mov_b32 v49, v48
    s_nop 1
    v_permlane16_swap_b32 v49, v48
    v_max_u32 v48, v49, v48
    v_mov_b32 v49, v48
    s_nop 1
    v_permlane32_swap_b32 v49, v48
    v_max_u32 v48, v49, v48
    s_nop 0
    v_readfirstlane_b32 s55, v48
    v_mov_b32 v5, s48
    v_and_b32 v10, 7, v2
    v_cmp_eq_u32 vcc, 1, v10
    v_mov_b32 v11, s49
    s_nop 0
    v_cndmask_b32 v5, v5, v11, vcc
    v_cmp_eq_u32 vcc, 2, v10
    v_mov_b32 v11, s50
    s_nop 0
    v_cndmask_b32 v5, v5, v11, vcc
    v_cmp_eq_u32 vcc, 3, v10
    v_mov_b32 v11, s51
    s_nop 0
    v_cndmask_b32 v5, v5, v11, vcc
    v_cmp_eq_u32 vcc, 4, v10
    v_mov_b32 v11, s52
    s_nop 0
    v_cndmask_b32 v5, v5, v11, vcc
    v_cmp_eq_u32 vcc, 5, v10
    v_mov_b32 v11, s53
    s_nop 0
    v_cndmask_b32 v5, v5, v11, vcc
    v_cmp_eq_u32 vcc, 6, v10
    v_mov_b32 v11, s54
    s_nop 0
    v_cndmask_b32 v5, v5, v11, vcc
    v_cmp_eq_u32 vcc, 7, v10
    v_mov_b32 v11, s55
    s_nop 0
    v_cndmask_b32 v5, v5, v11, vcc
    v_and_b32 v5, 0xffff, v5
    v_sub_u32 v5, 2047, v5
    v_mul_u32_u24 v5, 1152, v5
    v_lshl_add_u32 v5, v3, 4, v5
    buffer_load_dwordx4 v[32:35], v5, s[12:15], 0 offen offset:0
    buffer_load_dwordx4 v[36:39], v5, s[12:15], 0 offen offset:64
    buffer_load_dwordx4 v[40:43], v5, s[12:15], 0 offen offset:128
    buffer_load_dwordx4 v[44:47], v5, s[12:15], 0 offen offset:192
    buffer_load_dwordx4 v[48:51], v5, s[12:15], 0 offen offset:256
    buffer_load_dwordx4 v[52:55], v5, s[12:15], 0 offen offset:320
    buffer_load_dwordx4 v[56:59], v5, s[12:15], 0 offen offset:384
    buffer_load_dwordx4 v[60:63], v5, s[12:15], 0 offen offset:448
    buffer_load_dwordx4 v[64:67], v5, s[12:15], 0 offen offset:512
    buffer_load_dwordx4 v[68:71], v5, s[12:15], 0 offen offset:576
    buffer_load_dwordx4 v[72:75], v5, s[12:15], 0 offen offset:640
    buffer_load_dwordx4 v[76:79], v5, s[12:15], 0 offen offset:704
    buffer_load_dwordx4 v[80:83], v5, s[12:15], 0 offen offset:768
    buffer_load_dwordx4 v[84:87], v5, s[12:15], 0 offen offset:832
    buffer_load_dwordx4 v[88:91], v5, s[12:15], 0 offen offset:896
    buffer_load_dwordx4 v[92:95], v5, s[12:15], 0 offen offset:960
    buffer_load_dwordx4 v[96:99], v5, s[12:15], 0 offen offset:1024
    buffer_load_dwordx4 v[100:103], v5, s[12:15], 0 offen offset:1088
    s_waitcnt vmcnt(0)
    v_mfma_f32_16x16x32_bf16 v[16:19], a[0:3], v[32:35], 0
    v_mfma_f32_16x16x32_bf16 v[24:27], v[112:115], v[32:35], 0
    v_mfma_f32_16x16x32_bf16 v[20:23], a[4:7], v[32:35], 0
    v_mfma_f32_16x16x32_bf16 v[28:31], v[116:119], v[32:35], 0
    v_mfma_f32_16x16x32_bf16 v[16:19], a[8:11], v[36:39], v[16:19]
    v_mfma_f32_16x16x32_bf16 v[24:27], v[120:123], v[36:39], v[24:27]
    v_mfma_f32_16x16x32_bf16 v[20:23], a[12:15], v[36:39], v[20:23]
    v_mfma_f32_16x16x32_bf16 v[28:31], v[124:127], v[36:39], v[28:31]
    v_mfma_f32_16x16x32_bf16 v[16:19], a[16:19], v[40:43], v[16:19]
    v_mfma_f32_16x16x32_bf16 v[24:27], v[128:131], v[40:43], v[24:27]
    v_mfma_f32_16x16x32_bf16 v[20:23], a[20:23], v[40:43], v[20:23]
    v_mfma_f32_16x16x32_bf16 v[28:31], v[132:135], v[40:43], v[28:31]
    v_mfma_f32_16x16x32_bf16 v[16:19], a[24:27], v[44:47], v[16:19]
    v_mfma_f32_16x16x32_bf16 v[24:27], v[136:139], v[44:47], v[24:27]
    v_mfma_f32_16x16x32_bf16 v[20:23], a[28:31], v[44:47], v[20:23]
    v_mfma_f32_16x16x32_bf16 v[28:31], v[140:143], v[44:47], v[28:31]
    v_mfma_f32_16x16x32_bf16 v[16:19], a[32:35], v[48:51], v[16:19]
    v_mfma_f32_16x16x32_bf16 v[24:27], v[144:147], v[48:51], v[24:27]
    v_mfma_f32_16x16x32_bf16 v[20:23], a[36:39], v[48:51], v[20:23]
    v_mfma_f32_16x16x32_bf16 v[28:31], v[148:151], v[48:51], v[28:31]
    v_mfma_f32_16x16x32_bf16 v[16:19], a[40:43], v[52:55], v[16:19]
    v_mfma_f32_16x16x32_bf16 v[24:27], v[152:155], v[52:55], v[24:27]
    v_mfma_f32_16x16x32_bf16 v[20:23], a[44:47], v[52:55], v[20:23]
    v_mfma_f32_16x16x32_bf16 v[28:31], v[156:159], v[52:55], v[28:31]
    v_mfma_f32_16x16x32_bf16 v[16:19], a[48:51], v[56:59], v[16:19]
    v_mfma_f32_16x16x32_bf16 v[24:27], v[160:163], v[56:59], v[24:27]
    v_mfma_f32_16x16x32_bf16 v[20:23], a[52:55], v[56:59], v[20:23]
    v_mfma_f32_16x16x32_bf16 v[28:31], v[164:167], v[56:59], v[28:31]
    v_mfma_f32_16x16x32_bf16 v[16:19], a[56:59], v[60:63], v[16:19]
    v_mfma_f32_16x16x32_bf16 v[24:27], v[168:171], v[60:63], v[24:27]
    v_mfma_f32_16x16x32_bf16 v[20:23], a[60:63], v[60:63], v[20:23]
    v_mfma_f32_16x16x32_bf16 v[28:31], v[172:175], v[60:63], v[28:31]
    v_mfma_f32_16x16x32_bf16 v[16:19], a[64:67], v[64:67], v[16:19]
    v_mfma_f32_16x16x32_bf16 v[24:27], v[176:179], v[64:67], v[24:27]
    v_mfma_f32_16x16x32_bf16 v[20:23], a[68:71], v[64:67], v[20:23]
    v_mfma_f32_16x16x32_bf16 v[28:31], v[180:183], v[64:67], v[28:31]
    v_mfma_f32_16x16x32_bf16 v[16:19], a[72:75], v[68:71], v[16:19]
    v_mfma_f32_16x16x32_bf16 v[24:27], v[184:187], v[68:71], v[24:27]
    v_mfma_f32_16x16x32_bf16 v[20:23], a[76:79], v[68:71], v[20:23]
    v_mfma_f32_16x16x32_bf16 v[28:31], v[188:191], v[68:71], v[28:31]
    v_mfma_f32_16x16x32_bf16 v[16:19], a[80:83], v[72:75], v[16:19]
    v_mfma_f32_16x16x32_bf16 v[24:27], v[192:195], v[72:75], v[24:27]
    v_mfma_f32_16x16x32_bf16 v[20:23], a[84:87], v[72:75], v[20:23]
    v_mfma_f32_16x16x32_bf16 v[28:31], v[196:199], v[72:75], v[28:31]
    v_mfma_f32_16x16x32_bf16 v[16:19], a[88:91], v[76:79], v[16:19]
    v_mfma_f32_16x16x32_bf16 v[24:27], v[200:203], v[76:79], v[24:27]
    v_mfma_f32_16x16x32_bf16 v[20:23], a[92:95], v[76:79], v[20:23]
    v_mfma_f32_16x16x32_bf16 v[28:31], v[204:207], v[76:79], v[28:31]
    v_mfma_f32_16x16x32_bf16 v[16:19], a[96:99], v[80:83], v[16:19]
    v_mfma_f32_16x16x32_bf16 v[24:27], v[208:211], v[80:83], v[24:27]
    v_mfma_f32_16x16x32_bf16 v[20:23], a[100:103], v[80:83], v[20:23]
    v_mfma_f32_16x16x32_bf16 v[28:31], v[212:215], v[80:83], v[28:31]
    v_mfma_f32_16x16x32_bf16 v[16:19], a[104:107], v[84:87], v[16:19]
    v_mfma_f32_16x16x32_bf16 v[24:27], v[216:219], v[84:87], v[24:27]
    v_mfma_f32_16x16x32_bf16 v[20:23], a[108:111], v[84:87], v[20:23]
    v_mfma_f32_16x16x32_bf16 v[28:31], v[220:223], v[84:87], v[28:31]
    v_mfma_f32_16x16x32_bf16 v[16:19], a[112:115], v[88:91], v[16:19]
    v_mfma_f32_16x16x32_bf16 v[24:27], v[224:227], v[88:91], v[24:27]
    v_mfma_f32_16x16x32_bf16 v[20:23], a[116:119], v[88:91], v[20:23]
    v_mfma_f32_16x16x32_bf16 v[28:31], v[228:231], v[88:91], v[28:31]
    v_mfma_f32_16x16x32_bf16 v[16:19], a[120:123], v[92:95], v[16:19]
    v_mfma_f32_16x16x32_bf16 v[24:27], v[232:235], v[92:95], v[24:27]
    v_mfma_f32_16x16x32_bf16 v[20:23], a[124:127], v[92:95], v[20:23]
    v_mfma_f32_16x16x32_bf16 v[28:31], v[236:239], v[92:95], v[28:31]
    v_mfma_f32_16x16x32_bf16 v[16:19], a[128:131], v[96:99], v[16:19]
    v_mfma_f32_16x16x32_bf16 v[24:27], v[240:243], v[96:99], v[24:27]
    v_mfma_f32_16x16x32_bf16 v[20:23], a[132:135], v[96:99], v[20:23]
    v_mfma_f32_16x16x32_bf16 v[28:31], v[244:247], v[96:99], v[28:31]
    v_mfma_f32_16x16x32_bf16 v[16:19], a[136:139], v[100:103], v[16:19]
    v_mfma_f32_16x16x32_bf16 v[24:27], v[248:251], v[100:103], v[24:27]
    v_mfma_f32_16x16x32_bf16 v[20:23], a[140:143], v[100:103], v[20:23]
    v_mfma_f32_16x16x32_bf16 v[28:31], v[252:255], v[100:103], v[28:31]
    s_mov_b32 s42, 0xbfb8aa3b
    s_nop 3
    v_cvt_pk_bf16_f32 v16, v16, v16
    v_and_b32 v16, 0xffff0000, v16
    v_cvt_pk_bf16_f32 v24, v24, v24
    v_and_b32 v24, 0xffff0000, v24
    v_mov_b32 v8, v16
    v_mul_f32 v8, s42, v8
    v_exp_f32 v8, v8
    s_nop 0
    v_add_f32 v8, 1.0, v8
    v_rcp_f32 v8, v8
    s_nop 0
    v_mul_f32 v16, v16, v8
    v_cvt_pk_bf16_f32 v16, v16, v16
    v_and_b32 v16, 0xffff0000, v16
    v_mul_f32 v16, v16, v24
    v_cvt_pk_bf16_f32 v17, v17, v17
    v_and_b32 v17, 0xffff0000, v17
    v_cvt_pk_bf16_f32 v25, v25, v25
    v_and_b32 v25, 0xffff0000, v25
    v_mov_b32 v8, v17
    v_mul_f32 v8, s42, v8
    v_exp_f32 v8, v8
    s_nop 0
    v_add_f32 v8, 1.0, v8
    v_rcp_f32 v8, v8
    s_nop 0
    v_mul_f32 v17, v17, v8
    v_cvt_pk_bf16_f32 v17, v17, v17
    v_and_b32 v17, 0xffff0000, v17
    v_mul_f32 v17, v17, v25
    v_cvt_pk_bf16_f32 v18, v18, v18
    v_and_b32 v18, 0xffff0000, v18
    v_cvt_pk_bf16_f32 v26, v26, v26
    v_and_b32 v26, 0xffff0000, v26
    v_mov_b32 v8, v18
    v_mul_f32 v8, s42, v8
    v_exp_f32 v8, v8
    s_nop 0
    v_add_f32 v8, 1.0, v8
    v_rcp_f32 v8, v8
    s_nop 0
    v_mul_f32 v18, v18, v8
    v_cvt_pk_bf16_f32 v18, v18, v18
    v_and_b32 v18, 0xffff0000, v18
    v_mul_f32 v18, v18, v26
    v_cvt_pk_bf16_f32 v19, v19, v19
    v_and_b32 v19, 0xffff0000, v19
    v_cvt_pk_bf16_f32 v27, v27, v27
    v_and_b32 v27, 0xffff0000, v27
    v_mov_b32 v8, v19
    v_mul_f32 v8, s42, v8
    v_exp_f32 v8, v8
    s_nop 0
    v_add_f32 v8, 1.0, v8
    v_rcp_f32 v8, v8
    s_nop 0
    v_mul_f32 v19, v19, v8
    v_cvt_pk_bf16_f32 v19, v19, v19
    v_and_b32 v19, 0xffff0000, v19
    v_mul_f32 v19, v19, v27
    v_cvt_pk_bf16_f32 v20, v20, v20
    v_and_b32 v20, 0xffff0000, v20
    v_cvt_pk_bf16_f32 v28, v28, v28
    v_and_b32 v28, 0xffff0000, v28
    v_mov_b32 v8, v20
    v_mul_f32 v8, s42, v8
    v_exp_f32 v8, v8
    s_nop 0
    v_add_f32 v8, 1.0, v8
    v_rcp_f32 v8, v8
    s_nop 0
    v_mul_f32 v20, v20, v8
    v_cvt_pk_bf16_f32 v20, v20, v20
    v_and_b32 v20, 0xffff0000, v20
    v_mul_f32 v20, v20, v28
    v_cvt_pk_bf16_f32 v21, v21, v21
    v_and_b32 v21, 0xffff0000, v21
    v_cvt_pk_bf16_f32 v29, v29, v29
    v_and_b32 v29, 0xffff0000, v29
    v_mov_b32 v8, v21
    v_mul_f32 v8, s42, v8
    v_exp_f32 v8, v8
    s_nop 0
    v_add_f32 v8, 1.0, v8
    v_rcp_f32 v8, v8
    s_nop 0
    v_mul_f32 v21, v21, v8
    v_cvt_pk_bf16_f32 v21, v21, v21
    v_and_b32 v21, 0xffff0000, v21
    v_mul_f32 v21, v21, v29
    v_cvt_pk_bf16_f32 v22, v22, v22
    v_and_b32 v22, 0xffff0000, v22
    v_cvt_pk_bf16_f32 v30, v30, v30
    v_and_b32 v30, 0xffff0000, v30
    v_mov_b32 v8, v22
    v_mul_f32 v8, s42, v8
    v_exp_f32 v8, v8
    s_nop 0
    v_add_f32 v8, 1.0, v8
    v_rcp_f32 v8, v8
    s_nop 0
    v_mul_f32 v22, v22, v8
    v_cvt_pk_bf16_f32 v22, v22, v22
    v_and_b32 v22, 0xffff0000, v22
    v_mul_f32 v22, v22, v30
    v_cvt_pk_bf16_f32 v23, v23, v23
    v_and_b32 v23, 0xffff0000, v23
    v_cvt_pk_bf16_f32 v31, v31, v31
    v_and_b32 v31, 0xffff0000, v31
    v_mov_b32 v8, v23
    v_mul_f32 v8, s42, v8
    v_exp_f32 v8, v8
    s_nop 0
    v_add_f32 v8, 1.0, v8
    v_rcp_f32 v8, v8
    s_nop 0
    v_mul_f32 v23, v23, v8
    v_cvt_pk_bf16_f32 v23, v23, v23
    v_and_b32 v23, 0xffff0000, v23
    v_mul_f32 v23, v23, v31
    v_cvt_pk_bf16_f32 v8, v16, v17
    v_cvt_pk_bf16_f32 v9, v18, v19
    v_cvt_pk_bf16_f32 v10, v20, v21
    v_cvt_pk_bf16_f32 v11, v22, v23
    v_add_u32 v6, 147456, v4
    ds_write_b128 v6, v[8:11]
    s_waitcnt lgkmcnt(0)
    s_barrier
    v_lshlrev_b32 v6, 4, v1
    v_add_u32 v6, 147456, v6
    ds_read_b128 v[16:19], v6 offset:0
    ds_read_b128 v[20:23], v6 offset:1024
    ds_read_b128 v[24:27], v6 offset:2048
    ds_read_b128 v[28:31], v6 offset:3072
    v_lshrrev_b32 v7, 2, v2
    v_lshl_add_u32 v7, v3, 3, v7
    v_mul_u32_u24 v7, 1152, v7
    v_and_b32 v8, 3, v2
    v_lshl_add_u32 v7, v8, 3, v7
    s_mul_i32 s40, s36, 288
    v_add_u32 v7, s40, v7
    v_add_u32 v12, 36864, v7
    v_add_u32 v13, 73728, v7
    v_add_u32 v14, 110592, v7
    ds_read_b64_tr_b16 v[112:113], v7 offset:0
    ds_read_b64_tr_b16 v[114:115], v7 offset:4608
    ds_read_b64_tr_b16 v[116:117], v12 offset:0
    ds_read_b64_tr_b16 v[118:119], v12 offset:4608
    ds_read_b64_tr_b16 v[120:121], v13 offset:0
    ds_read_b64_tr_b16 v[122:123], v13 offset:4608
    ds_read_b64_tr_b16 v[124:125], v14 offset:0
    ds_read_b64_tr_b16 v[126:127], v14 offset:4608
    ds_read_b64_tr_b16 v[128:129], v7 offset:32
    ds_read_b64_tr_b16 v[130:131], v7 offset:4640
    ds_read_b64_tr_b16 v[132:133], v12 offset:32
    ds_read_b64_tr_b16 v[134:135], v12 offset:4640
    ds_read_b64_tr_b16 v[136:137], v13 offset:32
    ds_read_b64_tr_b16 v[138:139], v13 offset:4640
    ds_read_b64_tr_b16 v[140:141], v14 offset:32
    ds_read_b64_tr_b16 v[142:143], v14 offset:4640
    ds_read_b64_tr_b16 v[144:145], v7 offset:64
    ds_read_b64_tr_b16 v[146:147], v7 offset:4672
    ds_read_b64_tr_b16 v[148:149], v12 offset:64
    ds_read_b64_tr_b16 v[150:151], v12 offset:4672
    ds_read_b64_tr_b16 v[152:153], v13 offset:64
    ds_read_b64_tr_b16 v[154:155], v13 offset:4672
    ds_read_b64_tr_b16 v[156:157], v14 offset:64
    ds_read_b64_tr_b16 v[158:159], v14 offset:4672
    ds_read_b64_tr_b16 v[160:161], v7 offset:96
    ds_read_b64_tr_b16 v[162:163], v7 offset:4704
    ds_read_b64_tr_b16 v[164:165], v12 offset:96
    ds_read_b64_tr_b16 v[166:167], v12 offset:4704
    ds_read_b64_tr_b16 v[168:169], v13 offset:96
    ds_read_b64_tr_b16 v[170:171], v13 offset:4704
    ds_read_b64_tr_b16 v[172:173], v14 offset:96
    ds_read_b64_tr_b16 v[174:175], v14 offset:4704
    ds_read_b64_tr_b16 v[176:177], v7 offset:128
    ds_read_b64_tr_b16 v[178:179], v7 offset:4736
    ds_read_b64_tr_b16 v[180:181], v12 offset:128
    ds_read_b64_tr_b16 v[182:183], v12 offset:4736
    ds_read_b64_tr_b16 v[184:185], v13 offset:128
    ds_read_b64_tr_b16 v[186:187], v13 offset:4736
    ds_read_b64_tr_b16 v[188:189], v14 offset:128
    ds_read_b64_tr_b16 v[190:191], v14 offset:4736
    ds_read_b64_tr_b16 v[192:193], v7 offset:160
    ds_read_b64_tr_b16 v[194:195], v7 offset:4768
    ds_read_b64_tr_b16 v[196:197], v12 offset:160
    ds_read_b64_tr_b16 v[198:199], v12 offset:4768
    ds_read_b64_tr_b16 v[200:201], v13 offset:160
    ds_read_b64_tr_b16 v[202:203], v13 offset:4768
    ds_read_b64_tr_b16 v[204:205], v14 offset:160
    ds_read_b64_tr_b16 v[206:207], v14 offset:4768
    ds_read_b64_tr_b16 v[208:209], v7 offset:192
    ds_read_b64_tr_b16 v[210:211], v7 offset:4800
    ds_read_b64_tr_b16 v[212:213], v12 offset:192
    ds_read_b64_tr_b16 v[214:215], v12 offset:4800
    ds_read_b64_tr_b16 v[216:217], v13 offset:192
    ds_read_b64_tr_b16 v[218:219], v13 offset:4800
    ds_read_b64_tr_b16 v[220:221], v14 offset:192
    ds_read_b64_tr_b16 v[222:223], v14 offset:4800
    ds_read_b64_tr_b16 v[224:225], v7 offset:224
    ds_read_b64_tr_b16 v[226:227], v7 offset:4832
    ds_read_b64_tr_b16 v[228:229], v12 offset:224
    ds_read_b64_tr_b16 v[230:231], v12 offset:4832
    ds_read_b64_tr_b16 v[232:233], v13 offset:224
    ds_read_b64_tr_b16 v[234:235], v13 offset:4832
    ds_read_b64_tr_b16 v[236:237], v14 offset:224
    ds_read_b64_tr_b16 v[238:239], v14 offset:4832
    ds_read_b64_tr_b16 v[240:241], v7 offset:256
    ds_read_b64_tr_b16 v[242:243], v7 offset:4864
    ds_read_b64_tr_b16 v[244:245], v12 offset:256
    ds_read_b64_tr_b16 v[246:247], v12 offset:4864
    ds_read_b64_tr_b16 v[248:249], v13 offset:256
    ds_read_b64_tr_b16 v[250:251], v13 offset:4864
    ds_read_b64_tr_b16 v[252:253], v14 offset:256
    ds_read_b64_tr_b16 v[254:255], v14 offset:4864
    s_waitcnt lgkmcnt(0)
    v_mfma_f32_16x16x32_bf16 v[32:35], v[112:115], v[16:19], 0
    v_mfma_f32_16x16x32_bf16 v[32:35], v[116:119], v[20:23], v[32:35]
    v_mfma_f32_16x16x32_bf16 v[32:35], v[120:123], v[24:27], v[32:35]
    v_mfma_f32_16x16x32_bf16 v[32:35], v[124:127], v[28:31], v[32:35]
    v_mfma_f32_16x16x32_bf16 v[36:39], v[128:131], v[16:19], 0
    v_mfma_f32_16x16x32_bf16 v[36:39], v[132:135], v[20:23], v[36:39]
    v_mfma_f32_16x16x32_bf16 v[36:39], v[136:139], v[24:27], v[36:39]
    v_mfma_f32_16x16x32_bf16 v[36:39], v[140:143], v[28:31], v[36:39]
    v_mfma_f32_16x16x32_bf16 v[40:43], v[144:147], v[16:19], 0
    v_mfma_f32_16x16x32_bf16 v[40:43], v[148:151], v[20:23], v[40:43]
    v_mfma_f32_16x16x32_bf16 v[40:43], v[152:155], v[24:27], v[40:43]
    v_mfma_f32_16x16x32_bf16 v[40:43], v[156:159], v[28:31], v[40:43]
    v_mfma_f32_16x16x32_bf16 v[44:47], v[160:163], v[16:19], 0
    v_mfma_f32_16x16x32_bf16 v[44:47], v[164:167], v[20:23], v[44:47]
    v_mfma_f32_16x16x32_bf16 v[44:47], v[168:171], v[24:27], v[44:47]
    v_mfma_f32_16x16x32_bf16 v[44:47], v[172:175], v[28:31], v[44:47]
    v_mfma_f32_16x16x32_bf16 v[48:51], v[176:179], v[16:19], 0
    v_mfma_f32_16x16x32_bf16 v[48:51], v[180:183], v[20:23], v[48:51]
    v_mfma_f32_16x16x32_bf16 v[48:51], v[184:187], v[24:27], v[48:51]
    v_mfma_f32_16x16x32_bf16 v[48:51], v[188:191], v[28:31], v[48:51]
    v_mfma_f32_16x16x32_bf16 v[52:55], v[192:195], v[16:19], 0
    v_mfma_f32_16x16x32_bf16 v[52:55], v[196:199], v[20:23], v[52:55]
    v_mfma_f32_16x16x32_bf16 v[52:55], v[200:203], v[24:27], v[52:55]
    v_mfma_f32_16x16x32_bf16 v[52:55], v[204:207], v[28:31], v[52:55]
    v_mfma_f32_16x16x32_bf16 v[56:59], v[208:211], v[16:19], 0
    v_mfma_f32_16x16x32_bf16 v[56:59], v[212:215], v[20:23], v[56:59]
    v_mfma_f32_16x16x32_bf16 v[56:59], v[216:219], v[24:27], v[56:59]
    v_mfma_f32_16x16x32_bf16 v[56:59], v[220:223], v[28:31], v[56:59]
    v_mfma_f32_16x16x32_bf16 v[60:63], v[224:227], v[16:19], 0
    v_mfma_f32_16x16x32_bf16 v[60:63], v[228:231], v[20:23], v[60:63]
    v_mfma_f32_16x16x32_bf16 v[60:63], v[232:235], v[24:27], v[60:63]
    v_mfma_f32_16x16x32_bf16 v[60:63], v[236:239], v[28:31], v[60:63]
    v_mfma_f32_16x16x32_bf16 v[64:67], v[240:243], v[16:19], 0
    v_mfma_f32_16x16x32_bf16 v[64:67], v[244:247], v[20:23], v[64:67]
    v_mfma_f32_16x16x32_bf16 v[64:67], v[248:251], v[24:27], v[64:67]
    v_mfma_f32_16x16x32_bf16 v[64:67], v[252:255], v[28:31], v[64:67]
    v_mul_u32_u24 v6, 2304, v2
    v_lshl_add_u32 v6, v3, 4, v6
    s_mul_i32 s40, s37, 18432
    s_mul_i32 s41, s36, 576
    s_add_u32 s40, s40, s41
    s_add_u32 s40, s40, 60882944
    v_cmp_gt_u32 vcc, 8, v2
    s_nop 0
    s_mov_b64 exec, vcc
    buffer_store_dwordx4 v[32:35], v6, s[8:11], s40 offen offset:0 sc1
    buffer_store_dwordx4 v[36:39], v6, s[8:11], s40 offen offset:64 sc1
    buffer_store_dwordx4 v[40:43], v6, s[8:11], s40 offen offset:128 sc1
    buffer_store_dwordx4 v[44:47], v6, s[8:11], s40 offen offset:192 sc1
    buffer_store_dwordx4 v[48:51], v6, s[8:11], s40 offen offset:256 sc1
    buffer_store_dwordx4 v[52:55], v6, s[8:11], s40 offen offset:320 sc1
    buffer_store_dwordx4 v[56:59], v6, s[8:11], s40 offen offset:384 sc1
    buffer_store_dwordx4 v[60:63], v6, s[8:11], s40 offen offset:448 sc1
    buffer_store_dwordx4 v[64:67], v6, s[8:11], s40 offen offset:512 sc1
    s_mov_b64 exec, -1
    s_waitcnt vmcnt(0)
    s_barrier
    s_cmp_lg_u32 s36, 0
    s_cbranch_scc1 OL_28
    s_mov_b64 exec, 1
    v_mov_b32 v8, 1
    buffer_atomic_add v8, off, s[32:35], 0 offset:136
    s_mov_b64 exec, -1
OL_28:
W_B3:
    s_sub_u32 s37, s3, 110
    s_cmp_ge_u32 s37, 8
    s_cbranch_scc1 W_WO
    s_mov_b32 s68, 0
WT_29:
    buffer_load_dword v8, off, s[32:35], 0 offset:136 sc1
    s_waitcnt vmcnt(0)
    v_readfirstlane_b32 s70, v8
    s_nop 0
    s_cmp_ge_u32 s70, 36
    s_cbranch_scc1 WTX_30
    s_sleep 8
    s_add_u32 s68, s68, 1
    s_cmp_lt_u32 s68, 0x80000
    s_cbranch_scc1 WT_29
    s_branch L_exit
WTX_30:
    s_load_dwordx2 s[4:5], s[0:1], 0
    s_load_dwordx2 s[28:29], s[0:1], 120
    v_lshrrev_b32 v1, 6, v0
    s_nop 0
    v_readfirstlane_b32 s36, v1
    v_and_b32 v1, 63, v0
    v_and_b32 v2, 15, v0
    v_bfe_u32 v3, v0, 4, 2
    v_lshlrev_b32 v4, 4, v0
    s_waitcnt lgkmcnt(0)
    s_mov_b32 s12, s4
    s_and_b32 s13, s5, 0xffff
    s_mov_b32 s14, 0x240000
    s_mov_b32 s15, 0x20000
    s_mov_b32 s8, s28
    s_and_b32 s9, s29, 0xffff
    s_mov_b32 s10, 0x10000000
    s_mov_b32 s11, 0x20000
    s_mul_i32 s46, s37, 2304
    s_add_u32 s46, s46, 60882944
    v_min_u32 v5, 143, v0
    v_lshlrev_b32 v6, 4, v5
    s_add_u32 s40, s46, 0
    buffer_load_dwordx4 v[64:67], v6, s[8:11], s40 offen sc1
    s_add_u32 s40, s46, 18432
    buffer_load_dwordx4 v[68:71], v6, s[8:11], s40 offen sc1
    s_add_u32 s40, s46, 36864
    buffer_load_dwordx4 v[72:75], v6, s[8:11], s40 offen sc1
    s_add_u32 s40, s46, 55296
    buffer_load_dwordx4 v[76:79], v6, s[8:11], s40 offen sc1
    s_add_u32 s40, s46, 73728
    buffer_load_dwordx4 v[80:83], v6, s[8:11], s40 offen sc1
    s_add_u32 s40, s46, 92160
    buffer_load_dwordx4 v[84:87], v6, s[8:11], s40 offen sc1
    s_add_u32 s40, s46, 110592
    buffer_load_dwordx4 v[88:91], v6, s[8:11], s40 offen sc1
    s_add_u32 s40, s46, 129024
    buffer_load_dwordx4 v[92:95], v6, s[8:11], s40 offen sc1
    s_add_u32 s40, s46, 147456
    buffer_load_dwordx4 v[96:99], v6, s[8:11], s40 offen sc1
    s_add_u32 s40, s46, 165888
    buffer_load_dwordx4 v[100:103], v6, s[8:11], s40 offen sc1
    s_add_u32 s40, s46, 184320
    buffer_load_dwordx4 v[104:107], v6, s[8:11], s40 offen sc1
    s_add_u32 s40, s46, 202752
    buffer_load_dwordx4 v[108:111], v6, s[8:11], s40 offen sc1
    s_add_u32 s40, s46, 221184
    buffer_load_dwordx4 v[112:115], v6, s[8:11], s40 offen sc1
    s_add_u32 s40, s46, 239616
    buffer_load_dwordx4 v[116:119], v6, s[8:11], s40 offen sc1
    s_add_u32 s40, s46, 258048
    buffer_load_dwordx4 v[120:123], v6, s[8:11], s40 offen sc1
    s_add_u32 s40, s46, 276480
    buffer_load_dwordx4 v[124:127], v6, s[8:11], s40 offen sc1
    s_add_u32 s40, s46, 294912
    buffer_load_dwordx4 v[128:131], v6, s[8:11], s40 offen sc1
    s_add_u32 s40, s46, 313344
    buffer_load_dwordx4 v[132:135], v6, s[8:11], s40 offen sc1
    s_add_u32 s40, s46, 331776
    buffer_load_dwordx4 v[136:139], v6, s[8:11], s40 offen sc1
    s_add_u32 s40, s46, 350208
    buffer_load_dwordx4 v[140:143], v6, s[8:11], s40 offen sc1
    s_add_u32 s40, s46, 368640
    buffer_load_dwordx4 v[144:147], v6, s[8:11], s40 offen sc1
    s_add_u32 s40, s46, 387072
    buffer_load_dwordx4 v[148:151], v6, s[8:11], s40 offen sc1
    s_add_u32 s40, s46, 405504
    buffer_load_dwordx4 v[152:155], v6, s[8:11], s40 offen sc1
    s_add_u32 s40, s46, 423936
    buffer_load_dwordx4 v[156:159], v6, s[8:11], s40 offen sc1
    s_add_u32 s40, s46, 442368
    buffer_load_dwordx4 v[160:163], v6, s[8:11], s40 offen sc1
    s_add_u32 s40, s46, 460800
    buffer_load_dwordx4 v[164:167], v6, s[8:11], s40 offen sc1
    s_add_u32 s40, s46, 479232
    buffer_load_dwordx4 v[168:171], v6, s[8:11], s40 offen sc1
    s_add_u32 s40, s46, 497664
    buffer_load_dwordx4 v[172:175], v6, s[8:11], s40 offen sc1
    s_add_u32 s40, s46, 516096
    buffer_load_dwordx4 v[176:179], v6, s[8:11], s40 offen sc1
    s_add_u32 s40, s46, 534528
    buffer_load_dwordx4 v[180:183], v6, s[8:11], s40 offen sc1
    s_add_u32 s40, s46, 552960
    buffer_load_dwordx4 v[184:187], v6, s[8:11], s40 offen sc1
    s_add_u32 s40, s46, 571392
    buffer_load_dwordx4 v[188:191], v6, s[8:11], s40 offen sc1
    s_add_u32 s40, s46, 589824
    buffer_load_dwordx4 v[192:195], v6, s[8:11], s40 offen sc1
    s_add_u32 s40, s46, 608256
    buffer_load_dwordx4 v[196:199], v6, s[8:11], s40 offen sc1
    s_add_u32 s40, s46, 626688
    buffer_load_dwordx4 v[200:203], v6, s[8:11], s40 offen sc1
    s_add_u32 s40, s46, 645120
    buffer_load_dwordx4 v[204:207], v6, s[8:11], s40 offen sc1
    v_lshlrev_b32 v8, 4, v1
    s_mov_b32 s40, 60817408
    s_mov_b32 s41, 60821504
    buffer_load_dwordx4 v[16:19], v8, s[8:11], s40 offen offset:0 sc1
    buffer_load_dwordx4 v[20:23], v8, s[8:11], s40 offen offset:1024 sc1
    buffer_load_dwordx4 v[24:27], v8, s[8:11], s40 offen offset:2048 sc1
    buffer_load_dwordx4 v[28:31], v8, s[8:11], s40 offen offset:3072 sc1
    buffer_load_dwordx4 v[32:35], v8, s[8:11], s41 offen offset:0 sc1
    buffer_load_dwordx4 v[36:39], v8, s[8:11], s41 offen offset:1024 sc1
    buffer_load_dwordx4 v[40:43], v8, s[8:11], s41 offen offset:2048 sc1
    buffer_load_dwordx4 v[44:47], v8, s[8:11], s41 offen offset:3072 sc1
    v_lshlrev_b32 v9, 2, v1
    v_sub_u32 v9, 2047, v9
    s_waitcnt vmcnt(0)
    v_ashrrev_i32 v10, 31, v16
    v_or_b32 v10, 0x80000000, v10
    v_xor_b32 v16, v16, v10
    v_and_b32 v16, 0xffff0000, v16
    v_subrev_u32 v10, 0, v9
    v_or_b32 v16, v16, v10
    v_ashrrev_i32 v10, 31, v17
    v_or_b32 v10, 0x80000000, v10
    v_xor_b32 v17, v17, v10
    v_and_b32 v17, 0xffff0000, v17
    v_subrev_u32 v10, 1, v9
    v_or_b32 v17, v17, v10
    v_ashrrev_i32 v10, 31, v18
    v_or_b32 v10, 0x80000000, v10
    v_xor_b32 v18, v18, v10
    v_and_b32 v18, 0xffff0000, v18
    v_subrev_u32 v10, 2, v9
    v_or_b32 v18, v18, v10
    v_ashrrev_i32 v10, 31, v19
    v_or_b32 v10, 0x80000000, v10
    v_xor_b32 v19, v19, v10
    v_and_b32 v19, 0xffff0000, v19
    v_subrev_u32 v10, 3, v9
    v_or_b32 v19, v19, v10
    v_ashrrev_i32 v10, 31, v20
    v_or_b32 v10, 0x80000000, v10
    v_xor_b32 v20, v20, v10
    v_and_b32 v20, 0xffff0000, v20
    v_subrev_u32 v10, 256, v9
    v_or_b32 v20, v20, v10
    v_ashrrev_i32 v10, 31, v21
    v_or_b32 v10, 0x80000000, v10
    v_xor_b32 v21, v21, v10
    v_and_b32 v21, 0xffff0000, v21
    v_subrev_u32 v10, 257, v9
    v_or_b32 v21, v21, v10
    v_ashrrev_i32 v10, 31, v22
    v_or_b32 v10, 0x80000000, v10
    v_xor_b32 v22, v22, v10
    v_and_b32 v22, 0xffff0000, v22
    v_subrev_u32 v10, 258, v9
    v_or_b32 v22, v22, v10
    v_ashrrev_i32 v10, 31, v23
    v_or_b32 v10, 0x80000000, v10
    v_xor_b32 v23, v23, v10
    v_and_b32 v23, 0xffff0000, v23
    v_subrev_u32 v10, 259, v9
    v_or_b32 v23, v23, v10
    v_ashrrev_i32 v10, 31, v24
    v_or_b32 v10, 0x80000000, v10
    v_xor_b32 v24, v24, v10
    v_and_b32 v24, 0xffff0000, v24
    v_subrev_u32 v10, 512, v9
    v_or_b32 v24, v24, v10
    v_ashrrev_i32 v10, 31, v25
    v_or_b32 v10, 0x80000000, v10
    v_xor_b32 v25, v25, v10
    v_and_b32 v25, 0xffff0000, v25
    v_subrev_u32 v10, 513, v9
    v_or_b32 v25, v25, v10
    v_ashrrev_i32 v10, 31, v26
    v_or_b32 v10, 0x80000000, v10
    v_xor_b32 v26, v26, v10
    v_and_b32 v26, 0xffff0000, v26
    v_subrev_u32 v10, 514, v9
    v_or_b32 v26, v26, v10
    v_ashrrev_i32 v10, 31, v27
    v_or_b32 v10, 0x80000000, v10
    v_xor_b32 v27, v27, v10
    v_and_b32 v27, 0xffff0000, v27
    v_subrev_u32 v10, 515, v9
    v_or_b32 v27, v27, v10
    v_ashrrev_i32 v10, 31, v28
    v_or_b32 v10, 0x80000000, v10
    v_xor_b32 v28, v28, v10
    v_and_b32 v28, 0xffff0000, v28
    v_subrev_u32 v10, 768, v9
    v_or_b32 v28, v28, v10
    v_ashrrev_i32 v10, 31, v29
    v_or_b32 v10, 0x80000000, v10
    v_xor_b32 v29, v29, v10
    v_and_b32 v29, 0xffff0000, v29
    v_subrev_u32 v10, 769, v9
    v_or_b32 v29, v29, v10
    v_ashrrev_i32 v10, 31, v30
    v_or_b32 v10, 0x80000000, v10
    v_xor_b32 v30, v30, v10
    v_and_b32 v30, 0xffff0000, v30
    v_subrev_u32 v10, 770, v9
    v_or_b32 v30, v30, v10
    v_ashrrev_i32 v10, 31, v31
    v_or_b32 v10, 0x80000000, v10
    v_xor_b32 v31, v31, v10
    v_and_b32 v31, 0xffff0000, v31
    v_subrev_u32 v10, 771, v9
    v_or_b32 v31, v31, v10
    v_ashrrev_i32 v10, 31, v32
    v_or_b32 v10, 0x80000000, v10
    v_xor_b32 v32, v32, v10
    v_and_b32 v32, 0xffff0000, v32
    v_subrev_u32 v10, 1024, v9
    v_or_b32 v32, v32, v10
    v_ashrrev_i32 v10, 31, v33
    v_or_b32 v10, 0x80000000, v10
    v_xor_b32 v33, v33, v10
    v_and_b32 v33, 0xffff0000, v33
    v_subrev_u32 v10, 1025, v9
    v_or_b32 v33, v33, v10
    v_ashrrev_i32 v10, 31, v34
    v_or_b32 v10, 0x80000000, v10
    v_xor_b32 v34, v34, v10
    v_and_b32 v34, 0xffff0000, v34
    v_subrev_u32 v10, 1026, v9
    v_or_b32 v34, v34, v10
    v_ashrrev_i32 v10, 31, v35
    v_or_b32 v10, 0x80000000, v10
    v_xor_b32 v35, v35, v10
    v_and_b32 v35, 0xffff0000, v35
    v_subrev_u32 v10, 1027, v9
    v_or_b32 v35, v35, v10
    v_ashrrev_i32 v10, 31, v36
    v_or_b32 v10, 0x80000000, v10
    v_xor_b32 v36, v36, v10
    v_and_b32 v36, 0xffff0000, v36
    v_subrev_u32 v10, 1280, v9
    v_or_b32 v36, v36, v10
    v_ashrrev_i32 v10, 31, v37
    v_or_b32 v10, 0x80000000, v10
    v_xor_b32 v37, v37, v10
    v_and_b32 v37, 0xffff0000, v37
    v_subrev_u32 v10, 1281, v9
    v_or_b32 v37, v37, v10
    v_ashrrev_i32 v10, 31, v38
    v_or_b32 v10, 0x80000000, v10
    v_xor_b32 v38, v38, v10
    v_and_b32 v38, 0xffff0000, v38
    v_subrev_u32 v10, 1282, v9
    v_or_b32 v38, v38, v10
    v_ashrrev_i32 v10, 31, v39
    v_or_b32 v10, 0x80000000, v10
    v_xor_b32 v39, v39, v10
    v_and_b32 v39, 0xffff0000, v39
    v_subrev_u32 v10, 1283, v9
    v_or_b32 v39, v39, v10
    v_ashrrev_i32 v10, 31, v40
    v_or_b32 v10, 0x80000000, v10
    v_xor_b32 v40, v40, v10
    v_and_b32 v40, 0xffff0000, v40
    v_subrev_u32 v10, 1536, v9
    v_or_b32 v40, v40, v10
    v_ashrrev_i32 v10, 31, v41
    v_or_b32 v10, 0x80000000, v10
    v_xor_b32 v41, v41, v10
    v_and_b32 v41, 0xffff0000, v41
    v_subrev_u32 v10, 1537, v9
    v_or_b32 v41, v41, v10
    v_ashrrev_i32 v10, 31, v42
    v_or_b32 v10, 0x80000000, v10
    v_xor_b32 v42, v42, v10
    v_and_b32 v42, 0xffff0000, v42
    v_subrev_u32 v10, 1538, v9
    v_or_b32 v42, v42, v10
    v_ashrrev_i32 v10, 31, v43
    v_or_b32 v10, 0x80000000, v10
    v_xor_b32 v43, v43, v10
    v_and_b32 v43, 0xffff0000, v43
    v_subrev_u32 v10, 1539, v9
    v_or_b32 v43, v43, v10
    v_ashrrev_i32 v10, 31, v44
    v_or_b32 v10, 0x80000000, v10
    v_xor_b32 v44, v44, v10
    v_and_b32 v44, 0xffff0000, v44
    v_subrev_u32 v10, 1792, v9
    v_or_b32 v44, v44, v10
    v_ashrrev_i32 v10, 31, v45
    v_or_b32 v10, 0x80000000, v10
    v_xor_b32 v45, v45, v10
    v_and_b32 v45, 0xffff0000, v45
    v_subrev_u32 v10, 1793, v9
    v_or_b32 v45, v45, v10
    v_ashrrev_i32 v10, 31, v46
    v_or_b32 v10, 0x80000000, v10
    v_xor_b32 v46, v46, v10
    v_and_b32 v46, 0xffff0000, v46
    v_subrev_u32 v10, 1794, v9
    v_or_b32 v46, v46, v10
    v_ashrrev_i32 v10, 31, v47
    v_or_b32 v10, 0x80000000, v10
    v_xor_b32 v47, v47, v10
    v_and_b32 v47, 0xffff0000, v47
    v_subrev_u32 v10, 1795, v9
    v_or_b32 v47, v47, v10
    v_max3_u32 v48, v16, v17, v18
    v_max3_u32 v48, v48, v19, v20
    v_max3_u32 v48, v48, v21, v22
    v_max3_u32 v48, v48, v23, v24
    v_max3_u32 v48, v48, v25, v26
    v_max3_u32 v48, v48, v27, v28
    v_max3_u32 v48, v48, v29, v30
    v_max3_u32 v48, v48, v31, v32
    v_max3_u32 v48, v48, v33, v34
    v_max3_u32 v48, v48, v35, v36
    v_max3_u32 v48, v48, v37, v38
    v_max3_u32 v48, v48, v39, v40
    v_max3_u32 v48, v48, v41, v42
    v_max3_u32 v48, v48, v43, v44
    v_max3_u32 v48, v48, v45, v46
    v_max_u32 v48, v48, v47
    s_nop 1
    v_max_u32_dpp v48, v48, v48 quad_perm:[1,0,3,2] row_mask:0xf bank_mask:0xf
    s_nop 1
    v_max_u32_dpp v48, v48, v48 quad_perm:[2,3,0,1] row_mask:0xf bank_mask:0xf
    s_nop 1
    v_max_u32_dpp v48, v48, v48 row_half_mirror row_mask:0xf bank_mask:0xf
    s_nop 1
    v_max_u32_dpp v48, v48, v48 row_mirror row_mask:0xf bank_mask:0xf
    v_mov_b32 v49, v48
    s_nop 1
    v_permlane16_swap_b32 v49, v48
    v_max_u32 v48, v49, v48
    v_mov_b32 v49, v48
    s_nop 1
    v_permlane32_swap_b32 v49, v48
    v_max_u32 v48, v49, v48
    s_nop 0
    v_readfirstlane_b32 s48, v48
    v_cmp_ne_u32 vcc, v48, v16
    s_nop 1
    v_cndmask_b32 v16, 0, v16, vcc
    v_cmp_ne_u32 vcc, v48, v17
    s_nop 1
    v_cndmask_b32 v17, 0, v17, vcc
    v_cmp_ne_u32 vcc, v48, v18
    s_nop 1
    v_cndmask_b32 v18, 0, v18, vcc
    v_cmp_ne_u32 vcc, v48, v19
    s_nop 1
    v_cndmask_b32 v19, 0, v19, vcc
    v_cmp_ne_u32 vcc, v48, v20
    s_nop 1
    v_cndmask_b32 v20, 0, v20, vcc
    v_cmp_ne_u32 vcc, v48, v21
    s_nop 1
    v_cndmask_b32 v21, 0, v21, vcc
    v_cmp_ne_u32 vcc, v48, v22
    s_nop 1
    v_cndmask_b32 v22, 0, v22, vcc
    v_cmp_ne_u32 vcc, v48, v23
    s_nop 1
    v_cndmask_b32 v23, 0, v23, vcc
    v_cmp_ne_u32 vcc, v48, v24
    s_nop 1
    v_cndmask_b32 v24, 0, v24, vcc
    v_cmp_ne_u32 vcc, v48, v25
    s_nop 1
    v_cndmask_b32 v25, 0, v25, vcc
    v_cmp_ne_u32 vcc, v48, v26
    s_nop 1
    v_cndmask_b32 v26, 0, v26, vcc
    v_cmp_ne_u32 vcc, v48, v27
    s_nop 1
    v_cndmask_b32 v27, 0, v27, vcc
    v_cmp_ne_u32 vcc, v48, v28
    s_nop 1
    v_cndmask_b32 v28, 0, v28, vcc
    v_cmp_ne_u32 vcc, v48, v29
    s_nop 1
    v_cndmask_b32 v29, 0, v29, vcc
    v_cmp_ne_u32 vcc, v48, v30
    s_nop 1
    v_cndmask_b32 v30, 0, v30, vcc
    v_cmp_ne_u32 vcc, v48, v31
    s_nop 1
    v_cndmask_b32 v31, 0, v31, vcc
    v_cmp_ne_u32 vcc, v48, v32
    s_nop 1
    v_cndmask_b32 v32, 0, v32, vcc
    v_cmp_ne_u32 vcc, v48, v33
    s_nop 1
    v_cndmask_b32 v33, 0, v33, vcc
    v_cmp_ne_u32 vcc, v48, v34
    s_nop 1
    v_cndmask_b32 v34, 0, v34, vcc
    v_cmp_ne_u32 vcc, v48, v35
    s_nop 1
    v_cndmask_b32 v35, 0, v35, vcc
    v_cmp_ne_u32 vcc, v48, v36
    s_nop 1
    v_cndmask_b32 v36, 0, v36, vcc
    v_cmp_ne_u32 vcc, v48, v37
    s_nop 1
    v_cndmask_b32 v37, 0, v37, vcc
    v_cmp_ne_u32 vcc, v48, v38
    s_nop 1
    v_cndmask_b32 v38, 0, v38, vcc
    v_cmp_ne_u32 vcc, v48, v39
    s_nop 1
    v_cndmask_b32 v39, 0, v39, vcc
    v_cmp_ne_u32 vcc, v48, v40
    s_nop 1
    v_cndmask_b32 v40, 0, v40, vcc
    v_cmp_ne_u32 vcc, v48, v41
    s_nop 1
    v_cndmask_b32 v41, 0, v41, vcc
    v_cmp_ne_u32 vcc, v48, v42
    s_nop 1
    v_cndmask_b32 v42, 0, v42, vcc
    v_cmp_ne_u32 vcc, v48, v43
    s_nop 1
    v_cndmask_b32 v43, 0, v43, vcc
    v_cmp_ne_u32 vcc, v48, v44
    s_nop 1
    v_cndmask_b32 v44, 0, v44, vcc
    v_cmp_ne_u32 vcc, v48, v45
    s_nop 1
    v_cndmask_b32 v45, 0, v45, vcc
    v_cmp_ne_u32 vcc, v48, v46
    s_nop 1
    v_cndmask_b32 v46, 0, v46, vcc
    v_cmp_ne_u32 vcc, v48, v47
    s_nop 1
    v_cndmask_b32 v47, 0, v47, vcc
    v_max3_u32 v48, v16, v17, v18
    v_max3_u32 v48, v48, v19, v20
    v_max3_u32 v48, v48, v21, v22
    v_max3_u32 v48, v48, v23, v24
    v_max3_u32 v48, v48, v25, v26
    v_max3_u32 v48, v48, v27, v28
    v_max3_u32 v48, v48, v29, v30
    v_max3_u32 v48, v48, v31, v32
    v_max3_u32 v48, v48, v33, v34
    v_max3_u32 v48, v48, v35, v36
    v_max3_u32 v48, v48, v37, v38
    v_max3_u32 v48, v48, v39, v40
    v_max3_u32 v48, v48, v41, v42
    v_max3_u32 v48, v48, v43, v44
    v_max3_u32 v48, v48, v45, v46
    v_max_u32 v48, v48, v47
    s_nop 1
    v_max_u32_dpp v48, v48, v48 quad_perm:[1,0,3,2] row_mask:0xf bank_mask:0xf
    s_nop 1
    v_max_u32_dpp v48, v48, v48 quad_perm:[2,3,0,1] row_mask:0xf bank_mask:0xf
    s_nop 1
    v_max_u32_dpp v48, v48, v48 row_half_mirror row_mask:0xf bank_mask:0xf
    s_nop 1
    v_max_u32_dpp v48, v48, v48 row_mirror row_mask:0xf bank_mask:0xf
    v_mov_b32 v49, v48
    s_nop 1
    v_permlane16_swap_b32 v49, v48
    v_max_u32 v48, v49, v48
    v_mov_b32 v49, v48
    s_nop 1
    v_permlane32_swap_b32 v49, v48
    v_max_u32 v48, v49, v48
    s_nop 0
    v_readfirstlane_b32 s49, v48
    v_cmp_ne_u32 vcc, v48, v16
    s_nop 1
    v_cndmask_b32 v16, 0, v16, vcc
    v_cmp_ne_u32 vcc, v48, v17
    s_nop 1
    v_cndmask_b32 v17, 0, v17, vcc
    v_cmp_ne_u32 vcc, v48, v18
    s_nop 1
    v_cndmask_b32 v18, 0, v18, vcc
    v_cmp_ne_u32 vcc, v48, v19
    s_nop 1
    v_cndmask_b32 v19, 0, v19, vcc
    v_cmp_ne_u32 vcc, v48, v20
    s_nop 1
    v_cndmask_b32 v20, 0, v20, vcc
    v_cmp_ne_u32 vcc, v48, v21
    s_nop 1
    v_cndmask_b32 v21, 0, v21, vcc
    v_cmp_ne_u32 vcc, v48, v22
    s_nop 1
    v_cndmask_b32 v22, 0, v22, vcc
    v_cmp_ne_u32 vcc, v48, v23
    s_nop 1
    v_cndmask_b32 v23, 0, v23, vcc
    v_cmp_ne_u32 vcc, v48, v24
    s_nop 1
    v_cndmask_b32 v24, 0, v24, vcc
    v_cmp_ne_u32 vcc, v48, v25
    s_nop 1
    v_cndmask_b32 v25, 0, v25, vcc
    v_cmp_ne_u32 vcc, v48, v26
    s_nop 1
    v_cndmask_b32 v26, 0, v26, vcc
    v_cmp_ne_u32 vcc, v48, v27
    s_nop 1
    v_cndmask_b32 v27, 0, v27, vcc
    v_cmp_ne_u32 vcc, v48, v28
    s_nop 1
    v_cndmask_b32 v28, 0, v28, vcc
    v_cmp_ne_u32 vcc, v48, v29
    s_nop 1
    v_cndmask_b32 v29, 0, v29, vcc
    v_cmp_ne_u32 vcc, v48, v30
    s_nop 1
    v_cndmask_b32 v30, 0, v30, vcc
    v_cmp_ne_u32 vcc, v48, v31
    s_nop 1
    v_cndmask_b32 v31, 0, v31, vcc
    v_cmp_ne_u32 vcc, v48, v32
    s_nop 1
    v_cndmask_b32 v32, 0, v32, vcc
    v_cmp_ne_u32 vcc, v48, v33
    s_nop 1
    v_cndmask_b32 v33, 0, v33, vcc
    v_cmp_ne_u32 vcc, v48, v34
    s_nop 1
    v_cndmask_b32 v34, 0, v34, vcc
    v_cmp_ne_u32 vcc, v48, v35
    s_nop 1
    v_cndmask_b32 v35, 0, v35, vcc
    v_cmp_ne_u32 vcc, v48, v36
    s_nop 1
    v_cndmask_b32 v36, 0, v36, vcc
    v_cmp_ne_u32 vcc, v48, v37
    s_nop 1
    v_cndmask_b32 v37, 0, v37, vcc
    v_cmp_ne_u32 vcc, v48, v38
    s_nop 1
    v_cndmask_b32 v38, 0, v38, vcc
    v_cmp_ne_u32 vcc, v48, v39
    s_nop 1
    v_cndmask_b32 v39, 0, v39, vcc
    v_cmp_ne_u32 vcc, v48, v40
    s_nop 1
    v_cndmask_b32 v40, 0, v40, vcc
    v_cmp_ne_u32 vcc, v48, v41
    s_nop 1
    v_cndmask_b32 v41, 0, v41, vcc
    v_cmp_ne_u32 vcc, v48, v42
    s_nop 1
    v_cndmask_b32 v42, 0, v42, vcc
    v_cmp_ne_u32 vcc, v48, v43
    s_nop 1
    v_cndmask_b32 v43, 0, v43, vcc
    v_cmp_ne_u32 vcc, v48, v44
    s_nop 1
    v_cndmask_b32 v44, 0, v44, vcc
    v_cmp_ne_u32 vcc, v48, v45
    s_nop 1
    v_cndmask_b32 v45, 0, v45, vcc
    v_cmp_ne_u32 vcc, v48, v46
    s_nop 1
    v_cndmask_b32 v46, 0, v46, vcc
    v_cmp_ne_u32 vcc, v48, v47
    s_nop 1
    v_cndmask_b32 v47, 0, v47, vcc
    v_max3_u32 v48, v16, v17, v18
    v_max3_u32 v48, v48, v19, v20
    v_max3_u32 v48, v48, v21, v22
    v_max3_u32 v48, v48, v23, v24
    v_max3_u32 v48, v48, v25, v26
    v_max3_u32 v48, v48, v27, v28
    v_max3_u32 v48, v48, v29, v30
    v_max3_u32 v48, v48, v31, v32
    v_max3_u32 v48, v48, v33, v34
    v_max3_u32 v48, v48, v35, v36
    v_max3_u32 v48, v48, v37, v38
    v_max3_u32 v48, v48, v39, v40
    v_max3_u32 v48, v48, v41, v42
    v_max3_u32 v48, v48, v43, v44
    v_max3_u32 v48, v48, v45, v46
    v_max_u32 v48, v48, v47
    s_nop 1
    v_max_u32_dpp v48, v48, v48 quad_perm:[1,0,3,2] row_mask:0xf bank_mask:0xf
    s_nop 1
    v_max_u32_dpp v48, v48, v48 quad_perm:[2,3,0,1] row_mask:0xf bank_mask:0xf
    s_nop 1
    v_max_u32_dpp v48, v48, v48 row_half_mirror row_mask:0xf bank_mask:0xf
    s_nop 1
    v_max_u32_dpp v48, v48, v48 row_mirror row_mask:0xf bank_mask:0xf
    v_mov_b32 v49, v48
    s_nop 1
    v_permlane16_swap_b32 v49, v48
    v_max_u32 v48, v49, v48
    v_mov_b32 v49, v48
    s_nop 1
    v_permlane32_swap_b32 v49, v48
    v_max_u32 v48, v49, v48
    s_nop 0
    v_readfirstlane_b32 s50, v48
    v_cmp_ne_u32 vcc, v48, v16
    s_nop 1
    v_cndmask_b32 v16, 0, v16, vcc
    v_cmp_ne_u32 vcc, v48, v17
    s_nop 1
    v_cndmask_b32 v17, 0, v17, vcc
    v_cmp_ne_u32 vcc, v48, v18
    s_nop 1
    v_cndmask_b32 v18, 0, v18, vcc
    v_cmp_ne_u32 vcc, v48, v19
    s_nop 1
    v_cndmask_b32 v19, 0, v19, vcc
    v_cmp_ne_u32 vcc, v48, v20
    s_nop 1
    v_cndmask_b32 v20, 0, v20, vcc
    v_cmp_ne_u32 vcc, v48, v21
    s_nop 1
    v_cndmask_b32 v21, 0, v21, vcc
    v_cmp_ne_u32 vcc, v48, v22
    s_nop 1
    v_cndmask_b32 v22, 0, v22, vcc
    v_cmp_ne_u32 vcc, v48, v23
    s_nop 1
    v_cndmask_b32 v23, 0, v23, vcc
    v_cmp_ne_u32 vcc, v48, v24
    s_nop 1
    v_cndmask_b32 v24, 0, v24, vcc
    v_cmp_ne_u32 vcc, v48, v25
    s_nop 1
    v_cndmask_b32 v25, 0, v25, vcc
    v_cmp_ne_u32 vcc, v48, v26
    s_nop 1
    v_cndmask_b32 v26, 0, v26, vcc
    v_cmp_ne_u32 vcc, v48, v27
    s_nop 1
    v_cndmask_b32 v27, 0, v27, vcc
    v_cmp_ne_u32 vcc, v48, v28
    s_nop 1
    v_cndmask_b32 v28, 0, v28, vcc
    v_cmp_ne_u32 vcc, v48, v29
    s_nop 1
    v_cndmask_b32 v29, 0, v29, vcc
    v_cmp_ne_u32 vcc, v48, v30
    s_nop 1
    v_cndmask_b32 v30, 0, v30, vcc
    v_cmp_ne_u32 vcc, v48, v31
    s_nop 1
    v_cndmask_b32 v31, 0, v31, vcc
    v_cmp_ne_u32 vcc, v48, v32
    s_nop 1
    v_cndmask_b32 v32, 0, v32, vcc
    v_cmp_ne_u32 vcc, v48, v33
    s_nop 1
    v_cndmask_b32 v33, 0, v33, vcc
    v_cmp_ne_u32 vcc, v48, v34
    s_nop 1
    v_cndmask_b32 v34, 0, v34, vcc
    v_cmp_ne_u32 vcc, v48, v35
    s_nop 1
    v_cndmask_b32 v35, 0, v35, vcc
    v_cmp_ne_u32 vcc, v48, v36
    s_nop 1
    v_cndmask_b32 v36, 0, v36, vcc
    v_cmp_ne_u32 vcc, v48, v37
    s_nop 1
    v_cndmask_b32 v37, 0, v37, vcc
    v_cmp_ne_u32 vcc, v48, v38
    s_nop 1
    v_cndmask_b32 v38, 0, v38, vcc
    v_cmp_ne_u32 vcc, v48, v39
    s_nop 1
    v_cndmask_b32 v39, 0, v39, vcc
    v_cmp_ne_u32 vcc, v48, v40
    s_nop 1
    v_cndmask_b32 v40, 0, v40, vcc
    v_cmp_ne_u32 vcc, v48, v41
    s_nop 1
    v_cndmask_b32 v41, 0, v41, vcc
    v_cmp_ne_u32 vcc, v48, v42
    s_nop 1
    v_cndmask_b32 v42, 0, v42, vcc
    v_cmp_ne_u32 vcc, v48, v43
    s_nop 1
    v_cndmask_b32 v43, 0, v43, vcc
    v_cmp_ne_u32 vcc, v48, v44
    s_nop 1
    v_cndmask_b32 v44, 0, v44, vcc
    v_cmp_ne_u32 vcc, v48, v45
    s_nop 1
    v_cndmask_b32 v45, 0, v45, vcc
    v_cmp_ne_u32 vcc, v48, v46
    s_nop 1
    v_cndmask_b32 v46, 0, v46, vcc
    v_cmp_ne_u32 vcc, v48, v47
    s_nop 1
    v_cndmask_b32 v47, 0, v47, vcc
    v_max3_u32 v48, v16, v17, v18
    v_max3_u32 v48, v48, v19, v20
    v_max3_u32 v48, v48, v21, v22
    v_max3_u32 v48, v48, v23, v24
    v_max3_u32 v48, v48, v25, v26
    v_max3_u32 v48, v48, v27, v28
    v_max3_u32 v48, v48, v29, v30
    v_max3_u32 v48, v48, v31, v32
    v_max3_u32 v48, v48, v33, v34
    v_max3_u32 v48, v48, v35, v36
    v_max3_u32 v48, v48, v37, v38
    v_max3_u32 v48, v48, v39, v40
    v_max3_u32 v48, v48, v41, v42
    v_max3_u32 v48, v48, v43, v44
    v_max3_u32 v48, v48, v45, v46
    v_max_u32 v48, v48, v47
    s_nop 1
    v_max_u32_dpp v48, v48, v48 quad_perm:[1,0,3,2] row_mask:0xf bank_mask:0xf
    s_nop 1
    v_max_u32_dpp v48, v48, v48 quad_perm:[2,3,0,1] row_mask:0xf bank_mask:0xf
    s_nop 1
    v_max_u32_dpp v48, v48, v48 row_half_mirror row_mask:0xf bank_mask:0xf
    s_nop 1
    v_max_u32_dpp v48, v48, v48 row_mirror row_mask:0xf bank_mask:0xf
    v_mov_b32 v49, v48
    s_nop 1
    v_permlane16_swap_b32 v49, v48
    v_max_u32 v48, v49, v48
    v_mov_b32 v49, v48
    s_nop 1
    v_permlane32_swap_b32 v49, v48
    v_max_u32 v48, v49, v48
    s_nop 0
    v_readfirstlane_b32 s51, v48
    v_cmp_ne_u32 vcc, v48, v16
    s_nop 1
    v_cndmask_b32 v16, 0, v16, vcc
    v_cmp_ne_u32 vcc, v48, v17
    s_nop 1
    v_cndmask_b32 v17, 0, v17, vcc
    v_cmp_ne_u32 vcc, v48, v18
    s_nop 1
    v_cndmask_b32 v18, 0, v18, vcc
    v_cmp_ne_u32 vcc, v48, v19
    s_nop 1
    v_cndmask_b32 v19, 0, v19, vcc
    v_cmp_ne_u32 vcc, v48, v20
    s_nop 1
    v_cndmask_b32 v20, 0, v20, vcc
    v_cmp_ne_u32 vcc, v48, v21
    s_nop 1
    v_cndmask_b32 v21, 0, v21, vcc
    v_cmp_ne_u32 vcc, v48, v22
    s_nop 1
    v_cndmask_b32 v22, 0, v22, vcc
    v_cmp_ne_u32 vcc, v48, v23
    s_nop 1
    v_cndmask_b32 v23, 0, v23, vcc
    v_cmp_ne_u32 vcc, v48, v24
    s_nop 1
    v_cndmask_b32 v24, 0, v24, vcc
    v_cmp_ne_u32 vcc, v48, v25
    s_nop 1
    v_cndmask_b32 v25, 0, v25, vcc
    v_cmp_ne_u32 vcc, v48, v26
    s_nop 1
    v_cndmask_b32 v26, 0, v26, vcc
    v_cmp_ne_u32 vcc, v48, v27
    s_nop 1
    v_cndmask_b32 v27, 0, v27, vcc
    v_cmp_ne_u32 vcc, v48, v28
    s_nop 1
    v_cndmask_b32 v28, 0, v28, vcc
    v_cmp_ne_u32 vcc, v48, v29
    s_nop 1
    v_cndmask_b32 v29, 0, v29, vcc
    v_cmp_ne_u32 vcc, v48, v30
    s_nop 1
    v_cndmask_b32 v30, 0, v30, vcc
    v_cmp_ne_u32 vcc, v48, v31
    s_nop 1
    v_cndmask_b32 v31, 0, v31, vcc
    v_cmp_ne_u32 vcc, v48, v32
    s_nop 1
    v_cndmask_b32 v32, 0, v32, vcc
    v_cmp_ne_u32 vcc, v48, v33
    s_nop 1
    v_cndmask_b32 v33, 0, v33, vcc
    v_cmp_ne_u32 vcc, v48, v34
    s_nop 1
    v_cndmask_b32 v34, 0, v34, vcc
    v_cmp_ne_u32 vcc, v48, v35
    s_nop 1
    v_cndmask_b32 v35, 0, v35, vcc
    v_cmp_ne_u32 vcc, v48, v36
    s_nop 1
    v_cndmask_b32 v36, 0, v36, vcc
    v_cmp_ne_u32 vcc, v48, v37
    s_nop 1
    v_cndmask_b32 v37, 0, v37, vcc
    v_cmp_ne_u32 vcc, v48, v38
    s_nop 1
    v_cndmask_b32 v38, 0, v38, vcc
    v_cmp_ne_u32 vcc, v48, v39
    s_nop 1
    v_cndmask_b32 v39, 0, v39, vcc
    v_cmp_ne_u32 vcc, v48, v40
    s_nop 1
    v_cndmask_b32 v40, 0, v40, vcc
    v_cmp_ne_u32 vcc, v48, v41
    s_nop 1
    v_cndmask_b32 v41, 0, v41, vcc
    v_cmp_ne_u32 vcc, v48, v42
    s_nop 1
    v_cndmask_b32 v42, 0, v42, vcc
    v_cmp_ne_u32 vcc, v48, v43
    s_nop 1
    v_cndmask_b32 v43, 0, v43, vcc
    v_cmp_ne_u32 vcc, v48, v44
    s_nop 1
    v_cndmask_b32 v44, 0, v44, vcc
    v_cmp_ne_u32 vcc, v48, v45
    s_nop 1
    v_cndmask_b32 v45, 0, v45, vcc
    v_cmp_ne_u32 vcc, v48, v46
    s_nop 1
    v_cndmask_b32 v46, 0, v46, vcc
    v_cmp_ne_u32 vcc, v48, v47
    s_nop 1
    v_cndmask_b32 v47, 0, v47, vcc
    v_max3_u32 v48, v16, v17, v18
    v_max3_u32 v48, v48, v19, v20
    v_max3_u32 v48, v48, v21, v22
    v_max3_u32 v48, v48, v23, v24
    v_max3_u32 v48, v48, v25, v26
    v_max3_u32 v48, v48, v27, v28
    v_max3_u32 v48, v48, v29, v30
    v_max3_u32 v48, v48, v31, v32
    v_max3_u32 v48, v48, v33, v34
    v_max3_u32 v48, v48, v35, v36
    v_max3_u32 v48, v48, v37, v38
    v_max3_u32 v48, v48, v39, v40
    v_max3_u32 v48, v48, v41, v42
    v_max3_u32 v48, v48, v43, v44
    v_max3_u32 v48, v48, v45, v46
    v_max_u32 v48, v48, v47
    s_nop 1
    v_max_u32_dpp v48, v48, v48 quad_perm:[1,0,3,2] row_mask:0xf bank_mask:0xf
    s_nop 1
    v_max_u32_dpp v48, v48, v48 quad_perm:[2,3,0,1] row_mask:0xf bank_mask:0xf
    s_nop 1
    v_max_u32_dpp v48, v48, v48 row_half_mirror row_mask:0xf bank_mask:0xf
    s_nop 1
    v_max_u32_dpp v48, v48, v48 row_mirror row_mask:0xf bank_mask:0xf
    v_mov_b32 v49, v48
    s_nop 1
    v_permlane16_swap_b32 v49, v48
    v_max_u32 v48, v49, v48
    v_mov_b32 v49, v48
    s_nop 1
    v_permlane32_swap_b32 v49, v48
    v_max_u32 v48, v49, v48
    s_nop 0
    v_readfirstlane_b32 s52, v48
    v_cmp_ne_u32 vcc, v48, v16
    s_nop 1
    v_cndmask_b32 v16, 0, v16, vcc
    v_cmp_ne_u32 vcc, v48, v17
    s_nop 1
    v_cndmask_b32 v17, 0, v17, vcc
    v_cmp_ne_u32 vcc, v48, v18
    s_nop 1
    v_cndmask_b32 v18, 0, v18, vcc
    v_cmp_ne_u32 vcc, v48, v19
    s_nop 1
    v_cndmask_b32 v19, 0, v19, vcc
    v_cmp_ne_u32 vcc, v48, v20
    s_nop 1
    v_cndmask_b32 v20, 0, v20, vcc
    v_cmp_ne_u32 vcc, v48, v21
    s_nop 1
    v_cndmask_b32 v21, 0, v21, vcc
    v_cmp_ne_u32 vcc, v48, v22
    s_nop 1
    v_cndmask_b32 v22, 0, v22, vcc
    v_cmp_ne_u32 vcc, v48, v23
    s_nop 1
    v_cndmask_b32 v23, 0, v23, vcc
    v_cmp_ne_u32 vcc, v48, v24
    s_nop 1
    v_cndmask_b32 v24, 0, v24, vcc
    v_cmp_ne_u32 vcc, v48, v25
    s_nop 1
    v_cndmask_b32 v25, 0, v25, vcc
    v_cmp_ne_u32 vcc, v48, v26
    s_nop 1
    v_cndmask_b32 v26, 0, v26, vcc
    v_cmp_ne_u32 vcc, v48, v27
    s_nop 1
    v_cndmask_b32 v27, 0, v27, vcc
    v_cmp_ne_u32 vcc, v48, v28
    s_nop 1
    v_cndmask_b32 v28, 0, v28, vcc
    v_cmp_ne_u32 vcc, v48, v29
    s_nop 1
    v_cndmask_b32 v29, 0, v29, vcc
    v_cmp_ne_u32 vcc, v48, v30
    s_nop 1
    v_cndmask_b32 v30, 0, v30, vcc
    v_cmp_ne_u32 vcc, v48, v31
    s_nop 1
    v_cndmask_b32 v31, 0, v31, vcc
    v_cmp_ne_u32 vcc, v48, v32
    s_nop 1
    v_cndmask_b32 v32, 0, v32, vcc
    v_cmp_ne_u32 vcc, v48, v33
    s_nop 1
    v_cndmask_b32 v33, 0, v33, vcc
    v_cmp_ne_u32 vcc, v48, v34
    s_nop 1
    v_cndmask_b32 v34, 0, v34, vcc
    v_cmp_ne_u32 vcc, v48, v35
    s_nop 1
    v_cndmask_b32 v35, 0, v35, vcc
    v_cmp_ne_u32 vcc, v48, v36
    s_nop 1
    v_cndmask_b32 v36, 0, v36, vcc
    v_cmp_ne_u32 vcc, v48, v37
    s_nop 1
    v_cndmask_b32 v37, 0, v37, vcc
    v_cmp_ne_u32 vcc, v48, v38
    s_nop 1
    v_cndmask_b32 v38, 0, v38, vcc
    v_cmp_ne_u32 vcc, v48, v39
    s_nop 1
    v_cndmask_b32 v39, 0, v39, vcc
    v_cmp_ne_u32 vcc, v48, v40
    s_nop 1
    v_cndmask_b32 v40, 0, v40, vcc
    v_cmp_ne_u32 vcc, v48, v41
    s_nop 1
    v_cndmask_b32 v41, 0, v41, vcc
    v_cmp_ne_u32 vcc, v48, v42
    s_nop 1
    v_cndmask_b32 v42, 0, v42, vcc
    v_cmp_ne_u32 vcc, v48, v43
    s_nop 1
    v_cndmask_b32 v43, 0, v43, vcc
    v_cmp_ne_u32 vcc, v48, v44
    s_nop 1
    v_cndmask_b32 v44, 0, v44, vcc
    v_cmp_ne_u32 vcc, v48, v45
    s_nop 1
    v_cndmask_b32 v45, 0, v45, vcc
    v_cmp_ne_u32 vcc, v48, v46
    s_nop 1
    v_cndmask_b32 v46, 0, v46, vcc
    v_cmp_ne_u32 vcc, v48, v47
    s_nop 1
    v_cndmask_b32 v47, 0, v47, vcc
    v_max3_u32 v48, v16, v17, v18
    v_max3_u32 v48, v48, v19, v20
    v_max3_u32 v48, v48, v21, v22
    v_max3_u32 v48, v48, v23, v24
    v_max3_u32 v48, v48, v25, v26
    v_max3_u32 v48, v48, v27, v28
    v_max3_u32 v48, v48, v29, v30
    v_max3_u32 v48, v48, v31, v32
    v_max3_u32 v48, v48, v33, v34
    v_max3_u32 v48, v48, v35, v36
    v_max3_u32 v48, v48, v37, v38
    v_max3_u32 v48, v48, v39, v40
    v_max3_u32 v48, v48, v41, v42
    v_max3_u32 v48, v48, v43, v44
    v_max3_u32 v48, v48, v45, v46
    v_max_u32 v48, v48, v47
    s_nop 1
    v_max_u32_dpp v48, v48, v48 quad_perm:[1,0,3,2] row_mask:0xf bank_mask:0xf
    s_nop 1
    v_max_u32_dpp v48, v48, v48 quad_perm:[2,3,0,1] row_mask:0xf bank_mask:0xf
    s_nop 1
    v_max_u32_dpp v48, v48, v48 row_half_mirror row_mask:0xf bank_mask:0xf
    s_nop 1
    v_max_u32_dpp v48, v48, v48 row_mirror row_mask:0xf bank_mask:0xf
    v_mov_b32 v49, v48
    s_nop 1
    v_permlane16_swap_b32 v49, v48
    v_max_u32 v48, v49, v48
    v_mov_b32 v49, v48
    s_nop 1
    v_permlane32_swap_b32 v49, v48
    v_max_u32 v48, v49, v48
    s_nop 0
    v_readfirstlane_b32 s53, v48
    v_cmp_ne_u32 vcc, v48, v16
    s_nop 1
    v_cndmask_b32 v16, 0, v16, vcc
    v_cmp_ne_u32 vcc, v48, v17
    s_nop 1
    v_cndmask_b32 v17, 0, v17, vcc
    v_cmp_ne_u32 vcc, v48, v18
    s_nop 1
    v_cndmask_b32 v18, 0, v18, vcc
    v_cmp_ne_u32 vcc, v48, v19
    s_nop 1
    v_cndmask_b32 v19, 0, v19, vcc
    v_cmp_ne_u32 vcc, v48, v20
    s_nop 1
    v_cndmask_b32 v20, 0, v20, vcc
    v_cmp_ne_u32 vcc, v48, v21
    s_nop 1
    v_cndmask_b32 v21, 0, v21, vcc
    v_cmp_ne_u32 vcc, v48, v22
    s_nop 1
    v_cndmask_b32 v22, 0, v22, vcc
    v_cmp_ne_u32 vcc, v48, v23
    s_nop 1
    v_cndmask_b32 v23, 0, v23, vcc
    v_cmp_ne_u32 vcc, v48, v24
    s_nop 1
    v_cndmask_b32 v24, 0, v24, vcc
    v_cmp_ne_u32 vcc, v48, v25
    s_nop 1
    v_cndmask_b32 v25, 0, v25, vcc
    v_cmp_ne_u32 vcc, v48, v26
    s_nop 1
    v_cndmask_b32 v26, 0, v26, vcc
    v_cmp_ne_u32 vcc, v48, v27
    s_nop 1
    v_cndmask_b32 v27, 0, v27, vcc
    v_cmp_ne_u32 vcc, v48, v28
    s_nop 1
    v_cndmask_b32 v28, 0, v28, vcc
    v_cmp_ne_u32 vcc, v48, v29
    s_nop 1
    v_cndmask_b32 v29, 0, v29, vcc
    v_cmp_ne_u32 vcc, v48, v30
    s_nop 1
    v_cndmask_b32 v30, 0, v30, vcc
    v_cmp_ne_u32 vcc, v48, v31
    s_nop 1
    v_cndmask_b32 v31, 0, v31, vcc
    v_cmp_ne_u32 vcc, v48, v32
    s_nop 1
    v_cndmask_b32 v32, 0, v32, vcc
    v_cmp_ne_u32 vcc, v48, v33
    s_nop 1
    v_cndmask_b32 v33, 0, v33, vcc
    v_cmp_ne_u32 vcc, v48, v34
    s_nop 1
    v_cndmask_b32 v34, 0, v34, vcc
    v_cmp_ne_u32 vcc, v48, v35
    s_nop 1
    v_cndmask_b32 v35, 0, v35, vcc
    v_cmp_ne_u32 vcc, v48, v36
    s_nop 1
    v_cndmask_b32 v36, 0, v36, vcc
    v_cmp_ne_u32 vcc, v48, v37
    s_nop 1
    v_cndmask_b32 v37, 0, v37, vcc
    v_cmp_ne_u32 vcc, v48, v38
    s_nop 1
    v_cndmask_b32 v38, 0, v38, vcc
    v_cmp_ne_u32 vcc, v48, v39
    s_nop 1
    v_cndmask_b32 v39, 0, v39, vcc
    v_cmp_ne_u32 vcc, v48, v40
    s_nop 1
    v_cndmask_b32 v40, 0, v40, vcc
    v_cmp_ne_u32 vcc, v48, v41
    s_nop 1
    v_cndmask_b32 v41, 0, v41, vcc
    v_cmp_ne_u32 vcc, v48, v42
    s_nop 1
    v_cndmask_b32 v42, 0, v42, vcc
    v_cmp_ne_u32 vcc, v48, v43
    s_nop 1
    v_cndmask_b32 v43, 0, v43, vcc
    v_cmp_ne_u32 vcc, v48, v44
    s_nop 1
    v_cndmask_b32 v44, 0, v44, vcc
    v_cmp_ne_u32 vcc, v48, v45
    s_nop 1
    v_cndmask_b32 v45, 0, v45, vcc
    v_cmp_ne_u32 vcc, v48, v46
    s_nop 1
    v_cndmask_b32 v46, 0, v46, vcc
    v_cmp_ne_u32 vcc, v48, v47
    s_nop 1
    v_cndmask_b32 v47, 0, v47, vcc
    v_max3_u32 v48, v16, v17, v18
    v_max3_u32 v48, v48, v19, v20
    v_max3_u32 v48, v48, v21, v22
    v_max3_u32 v48, v48, v23, v24
    v_max3_u32 v48, v48, v25, v26
    v_max3_u32 v48, v48, v27, v28
    v_max3_u32 v48, v48, v29, v30
    v_max3_u32 v48, v48, v31, v32
    v_max3_u32 v48, v48, v33, v34
    v_max3_u32 v48, v48, v35, v36
    v_max3_u32 v48, v48, v37, v38
    v_max3_u32 v48, v48, v39, v40
    v_max3_u32 v48, v48, v41, v42
    v_max3_u32 v48, v48, v43, v44
    v_max3_u32 v48, v48, v45, v46
    v_max_u32 v48, v48, v47
    s_nop 1
    v_max_u32_dpp v48, v48, v48 quad_perm:[1,0,3,2] row_mask:0xf bank_mask:0xf
    s_nop 1
    v_max_u32_dpp v48, v48, v48 quad_perm:[2,3,0,1] row_mask:0xf bank_mask:0xf
    s_nop 1
    v_max_u32_dpp v48, v48, v48 row_half_mirror row_mask:0xf bank_mask:0xf
    s_nop 1
    v_max_u32_dpp v48, v48, v48 row_mirror row_mask:0xf bank_mask:0xf
    v_mov_b32 v49, v48
    s_nop 1
    v_permlane16_swap_b32 v49, v48
    v_max_u32 v48, v49, v48
    v_mov_b32 v49, v48
    s_nop 1
    v_permlane32_swap_b32 v49, v48
    v_max_u32 v48, v49, v48
    s_nop 0
    v_readfirstlane_b32 s54, v48
    v_cmp_ne_u32 vcc, v48, v16
    s_nop 1
    v_cndmask_b32 v16, 0, v16, vcc
    v_cmp_ne_u32 vcc, v48, v17
    s_nop 1
    v_cndmask_b32 v17, 0, v17, vcc
    v_cmp_ne_u32 vcc, v48, v18
    s_nop 1
    v_cndmask_b32 v18, 0, v18, vcc
    v_cmp_ne_u32 vcc, v48, v19
    s_nop 1
    v_cndmask_b32 v19, 0, v19, vcc
    v_cmp_ne_u32 vcc, v48, v20
    s_nop 1
    v_cndmask_b32 v20, 0, v20, vcc
    v_cmp_ne_u32 vcc, v48, v21
    s_nop 1
    v_cndmask_b32 v21, 0, v21, vcc
    v_cmp_ne_u32 vcc, v48, v22
    s_nop 1
    v_cndmask_b32 v22, 0, v22, vcc
    v_cmp_ne_u32 vcc, v48, v23
    s_nop 1
    v_cndmask_b32 v23, 0, v23, vcc
    v_cmp_ne_u32 vcc, v48, v24
    s_nop 1
    v_cndmask_b32 v24, 0, v24, vcc
    v_cmp_ne_u32 vcc, v48, v25
    s_nop 1
    v_cndmask_b32 v25, 0, v25, vcc
    v_cmp_ne_u32 vcc, v48, v26
    s_nop 1
    v_cndmask_b32 v26, 0, v26, vcc
    v_cmp_ne_u32 vcc, v48, v27
    s_nop 1
    v_cndmask_b32 v27, 0, v27, vcc
    v_cmp_ne_u32 vcc, v48, v28
    s_nop 1
    v_cndmask_b32 v28, 0, v28, vcc
    v_cmp_ne_u32 vcc, v48, v29
    s_nop 1
    v_cndmask_b32 v29, 0, v29, vcc
    v_cmp_ne_u32 vcc, v48, v30
    s_nop 1
    v_cndmask_b32 v30, 0, v30, vcc
    v_cmp_ne_u32 vcc, v48, v31
    s_nop 1
    v_cndmask_b32 v31, 0, v31, vcc
    v_cmp_ne_u32 vcc, v48, v32
    s_nop 1
    v_cndmask_b32 v32, 0, v32, vcc
    v_cmp_ne_u32 vcc, v48, v33
    s_nop 1
    v_cndmask_b32 v33, 0, v33, vcc
    v_cmp_ne_u32 vcc, v48, v34
    s_nop 1
    v_cndmask_b32 v34, 0, v34, vcc
    v_cmp_ne_u32 vcc, v48, v35
    s_nop 1
    v_cndmask_b32 v35, 0, v35, vcc
    v_cmp_ne_u32 vcc, v48, v36
    s_nop 1
    v_cndmask_b32 v36, 0, v36, vcc
    v_cmp_ne_u32 vcc, v48, v37
    s_nop 1
    v_cndmask_b32 v37, 0, v37, vcc
    v_cmp_ne_u32 vcc, v48, v38
    s_nop 1
    v_cndmask_b32 v38, 0, v38, vcc
    v_cmp_ne_u32 vcc, v48, v39
    s_nop 1
    v_cndmask_b32 v39, 0, v39, vcc
    v_cmp_ne_u32 vcc, v48, v40
    s_nop 1
    v_cndmask_b32 v40, 0, v40, vcc
    v_cmp_ne_u32 vcc, v48, v41
    s_nop 1
    v_cndmask_b32 v41, 0, v41, vcc
    v_cmp_ne_u32 vcc, v48, v42
    s_nop 1
    v_cndmask_b32 v42, 0, v42, vcc
    v_cmp_ne_u32 vcc, v48, v43
    s_nop 1
    v_cndmask_b32 v43, 0, v43, vcc
    v_cmp_ne_u32 vcc, v48, v44
    s_nop 1
    v_cndmask_b32 v44, 0, v44, vcc
    v_cmp_ne_u32 vcc, v48, v45
    s_nop 1
    v_cndmask_b32 v45, 0, v45, vcc
    v_cmp_ne_u32 vcc, v48, v46
    s_nop 1
    v_cndmask_b32 v46, 0, v46, vcc
    v_cmp_ne_u32 vcc, v48, v47
    s_nop 1
    v_cndmask_b32 v47, 0, v47, vcc
    v_max3_u32 v48, v16, v17, v18
    v_max3_u32 v48, v48, v19, v20
    v_max3_u32 v48, v48, v21, v22
    v_max3_u32 v48, v48, v23, v24
    v_max3_u32 v48, v48, v25, v26
    v_max3_u32 v48, v48, v27, v28
    v_max3_u32 v48, v48, v29, v30
    v_max3_u32 v48, v48, v31, v32
    v_max3_u32 v48, v48, v33, v34
    v_max3_u32 v48, v48, v35, v36
    v_max3_u32 v48, v48, v37, v38
    v_max3_u32 v48, v48, v39, v40
    v_max3_u32 v48, v48, v41, v42
    v_max3_u32 v48, v48, v43, v44
    v_max3_u32 v48, v48, v45, v46
    v_max_u32 v48, v48, v47
    s_nop 1
    v_max_u32_dpp v48, v48, v48 quad_perm:[1,0,3,2] row_mask:0xf bank_mask:0xf
    s_nop 1
    v_max_u32_dpp v48, v48, v48 quad_perm:[2,3,0,1] row_mask:0xf bank_mask:0xf
    s_nop 1
    v_max_u32_dpp v48, v48, v48 row_half_mirror row_mask:0xf bank_mask:0xf
    s_nop 1
    v_max_u32_dpp v48, v48, v48 row_mirror row_mask:0xf bank_mask:0xf
    v_mov_b32 v49, v48
    s_nop 1
    v_permlane16_swap_b32 v49, v48
    v_max_u32 v48, v49, v48
    v_mov_b32 v49, v48
    s_nop 1
    v_permlane32_swap_b32 v49, v48
    v_max_u32 v48, v49, v48
    s_nop 0
    v_readfirstlane_b32 s55, v48
    s_mov_b32 s47, s48
    s_cmp_eq_u32 s37, 1
    s_cselect_b32 s47, s49, s47
    s_cmp_eq_u32 s37, 2
    s_cselect_b32 s47, s50, s47
    s_cmp_eq_u32 s37, 3
    s_cselect_b32 s47, s51, s47
    s_cmp_eq_u32 s37, 4
    s_cselect_b32 s47, s52, s47
    s_cmp_eq_u32 s37, 5
    s_cselect_b32 s47, s53, s47
    s_cmp_eq_u32 s37, 6
    s_cselect_b32 s47, s54, s47
    s_cmp_eq_u32 s37, 7
    s_cselect_b32 s47, s55, s47
    s_and_b32 s40, s47, 0xffff
    s_sub_u32 s43, 2047, s40
    s_mul_i32 s40, s43, 1152
    v_lshlrev_b32 v7, 3, v5
    buffer_load_dwordx2 v[8:9], v7, s[12:15], s40 offen
    s_lshl_b32 s41, s43, 2
    s_add_u32 s41, s41, 60817408
    v_mov_b32 v10, 0
    buffer_load_dword v10, v10, s[8:11], s41 offen sc1
    v_add_f32 v64, v64, v68
    v_add_f32 v65, v65, v69
    v_add_f32 v66, v66, v70
    v_add_f32 v67, v67, v71
    v_add_f32 v64, v64, v72
    v_add_f32 v65, v65, v73
    v_add_f32 v66, v66, v74
    v_add_f32 v67, v67, v75
    v_add_f32 v64, v64, v76
    v_add_f32 v65, v65, v77
    v_add_f32 v66, v66, v78
    v_add_f32 v67, v67, v79
    v_add_f32 v64, v64, v80
    v_add_f32 v65, v65, v81
    v_add_f32 v66, v66, v82
    v_add_f32 v67, v67, v83
    v_add_f32 v64, v64, v84
    v_add_f32 v65, v65, v85
    v_add_f32 v66, v66, v86
    v_add_f32 v67, v67, v87
    v_add_f32 v64, v64, v88
    v_add_f32 v65, v65, v89
    v_add_f32 v66, v66, v90
    v_add_f32 v67, v67, v91
    v_add_f32 v64, v64, v92
    v_add_f32 v65, v65, v93
    v_add_f32 v66, v66, v94
    v_add_f32 v67, v67, v95
    v_add_f32 v64, v64, v96
    v_add_f32 v65, v65, v97
    v_add_f32 v66, v66, v98
    v_add_f32 v67, v67, v99
    v_add_f32 v64, v64, v100
    v_add_f32 v65, v65, v101
    v_add_f32 v66, v66, v102
    v_add_f32 v67, v67, v103
    v_add_f32 v64, v64, v104
    v_add_f32 v65, v65, v105
    v_add_f32 v66, v66, v106
    v_add_f32 v67, v67, v107
    v_add_f32 v64, v64, v108
    v_add_f32 v65, v65, v109
    v_add_f32 v66, v66, v110
    v_add_f32 v67, v67, v111
    v_add_f32 v64, v64, v112
    v_add_f32 v65, v65, v113
    v_add_f32 v66, v66, v114
    v_add_f32 v67, v67, v115
    v_add_f32 v64, v64, v116
    v_add_f32 v65, v65, v117
    v_add_f32 v66, v66, v118
    v_add_f32 v67, v67, v119
    v_add_f32 v64, v64, v120
    v_add_f32 v65, v65, v121
    v_add_f32 v66, v66, v122
    v_add_f32 v67, v67, v123
    v_add_f32 v64, v64, v124
    v_add_f32 v65, v65, v125
    v_add_f32 v66, v66, v126
    v_add_f32 v67, v67, v127
    v_add_f32 v64, v64, v128
    v_add_f32 v65, v65, v129
    v_add_f32 v66, v66, v130
    v_add_f32 v67, v67, v131
    v_add_f32 v64, v64, v132
    v_add_f32 v65, v65, v133
    v_add_f32 v66, v66, v134
    v_add_f32 v67, v67, v135
    v_add_f32 v64, v64, v136
    v_add_f32 v65, v65, v137
    v_add_f32 v66, v66, v138
    v_add_f32 v67, v67, v139
    v_add_f32 v64, v64, v140
    v_add_f32 v65, v65, v141
    v_add_f32 v66, v66, v142
    v_add_f32 v67, v67, v143
    v_add_f32 v64, v64, v144
    v_add_f32 v65, v65, v145
    v_add_f32 v66, v66, v146
    v_add_f32 v67, v67, v147
    v_add_f32 v64, v64, v148
    v_add_f32 v65, v65, v149
    v_add_f32 v66, v66, v150
    v_add_f32 v67, v67, v151
    v_add_f32 v64, v64, v152
    v_add_f32 v65, v65, v153
    v_add_f32 v66, v66, v154
    v_add_f32 v67, v67, v155
    v_add_f32 v64, v64, v156
    v_add_f32 v65, v65, v157
    v_add_f32 v66, v66, v158
    v_add_f32 v67, v67, v159
    v_add_f32 v64, v64, v160
    v_add_f32 v65, v65, v161
    v_add_f32 v66, v66, v162
    v_add_f32 v67, v67, v163
    v_add_f32 v64, v64, v164
    v_add_f32 v65, v65, v165
    v_add_f32 v66, v66, v166
    v_add_f32 v67, v67, v167
    v_add_f32 v64, v64, v168
    v_add_f32 v65, v65, v169
    v_add_f32 v66, v66, v170
    v_add_f32 v67, v67, v171
    v_add_f32 v64, v64, v172
    v_add_f32 v65, v65, v173
    v_add_f32 v66, v66, v174
    v_add_f32 v67, v67, v175
    v_add_f32 v64, v64, v176
    v_add_f32 v65, v65, v177
    v_add_f32 v66, v66, v178
    v_add_f32 v67, v67, v179
    v_add_f32 v64, v64, v180
    v_add_f32 v65, v65, v181
    v_add_f32 v66, v66, v182
    v_add_f32 v67, v67, v183
    v_add_f32 v64, v64, v184
    v_add_f32 v65, v65, v185
    v_add_f32 v66, v66, v186
    v_add_f32 v67, v67, v187
    v_add_f32 v64, v64, v188
    v_add_f32 v65, v65, v189
    v_add_f32 v66, v66, v190
    v_add_f32 v67, v67, v191
    v_add_f32 v64, v64, v192
    v_add_f32 v65, v65, v193
    v_add_f32 v66, v66, v194
    v_add_f32 v67, v67, v195
    v_add_f32 v64, v64, v196
    v_add_f32 v65, v65, v197
    v_add_f32 v66, v66, v198
    v_add_f32 v67, v67, v199
    v_add_f32 v64, v64, v200
    v_add_f32 v65, v65, v201
    v_add_f32 v66, v66, v202
    v_add_f32 v67, v67, v203
    v_add_f32 v64, v64, v204
    v_add_f32 v65, v65, v205
    v_add_f32 v66, v66, v206
    v_add_f32 v67, v67, v207
    s_waitcnt vmcnt(0)
    s_mov_b32 s42, 0xbfb8aa3b
    v_mul_f32 v10, s42, v10
    v_exp_f32 v10, v10
    s_nop 0
    v_add_f32 v10, 1.0, v10
    v_rcp_f32 v10, v10
    s_nop 0
    v_cvt_pk_bf16_f32 v10, v10, v10
    v_and_b32 v10, 0xffff0000, v10
    v_lshlrev_b32 v12, 16, v8
    v_and_b32 v13, 0xffff0000, v8
    v_lshlrev_b32 v14, 16, v9
    v_and_b32 v15, 0xffff0000, v9
    v_cvt_pk_bf16_f32 v64, v64, v64
    v_and_b32 v64, 0xffff0000, v64
    v_mul_f32 v64, v64, v10
    v_cvt_pk_bf16_f32 v64, v64, v64
    v_and_b32 v64, 0xffff0000, v64
    v_add_f32 v64, v64, v12
    v_cvt_pk_bf16_f32 v65, v65, v65
    v_and_b32 v65, 0xffff0000, v65
    v_mul_f32 v65, v65, v10
    v_cvt_pk_bf16_f32 v65, v65, v65
    v_and_b32 v65, 0xffff0000, v65
    v_add_f32 v65, v65, v13
    v_cvt_pk_bf16_f32 v66, v66, v66
    v_and_b32 v66, 0xffff0000, v66
    v_mul_f32 v66, v66, v10
    v_cvt_pk_bf16_f32 v66, v66, v66
    v_and_b32 v66, 0xffff0000, v66
    v_add_f32 v66, v66, v14
    v_cvt_pk_bf16_f32 v67, v67, v67
    v_and_b32 v67, 0xffff0000, v67
    v_mul_f32 v67, v67, v10
    v_cvt_pk_bf16_f32 v67, v67, v67
    v_and_b32 v67, 0xffff0000, v67
    v_add_f32 v67, v67, v15
    v_cvt_pk_bf16_f32 v8, v64, v65
    v_cvt_pk_bf16_f32 v9, v66, v67
    s_mul_i32 s40, s37, 1152
    s_add_u32 s40, s40, 61866048
    buffer_store_dwordx2 v[8:9], v7, s[8:11], s40 offen sc1
    v_mov_b32 v10, s43
    v_mov_b32 v11, 0
    s_lshl_b32 s40, s37, 2
    s_add_u32 s40, s40, 61865984
    buffer_store_dword v10, v11, s[8:11], s40 offen sc1
    s_waitcnt vmcnt(0)
    s_barrier
    s_cmp_lg_u32 s36, 0
    s_cbranch_scc1 OL_31
    s_mov_b64 exec, 1
    v_mov_b32 v8, 1
    buffer_atomic_add v8, off, s[32:35], 0 offset:140
    s_mov_b64 exec, -1
OL_31:
W_WO:
    s_sub_u32 s5, s3, 64
    s_mul_i32 s4, s5, 3641
    s_lshr_b32 s38, s4, 16
    s_mul_i32 s4, s38, 18
    s_sub_u32 s37, s5, s4
    s_mov_b32 s39, 3
    s_mov_b32 s77, 64
    s_add_u32 s76, s38, 29
W_WO2:
    s_load_dwordx2 s[4:5], s[0:1], 0
    s_load_dwordx2 s[6:7], s[0:1], 40
    s_load_dwordx2 s[28:29], s[0:1], 120
    s_load_dwordx2 s[30:31], s[0:1], 104
    v_lshrrev_b32 v1, 6, v0
    s_nop 0
    v_readfirstlane_b32 s36, v1
    v_and_b32 v1, 63, v0
    v_and_b32 v2, 15, v0
    v_bfe_u32 v3, v0, 4, 2
    v_lshlrev_b32 v4, 4, v0
    s_waitcnt lgkmcnt(0)
    s_mov_b32 s12, s4
    s_and_b32 s13, s5, 0xffff
    s_mov_b32 s14, 0x240000
    s_mov_b32 s15, 0x20000
    s_mov_b32 s16, s6
    s_and_b32 s17, s7, 0xffff
    s_mov_b32 s18, 0x480000
    s_mov_b32 s19, 0x20000
    s_mov_b32 s8, s28
    s_and_b32 s9, s29, 0xffff
    s_mov_b32 s10, 0x10000000
    s_mov_b32 s11, 0x20000
    s_mov_b32 s24, s30
    s_and_b32 s25, s31, 0xffff
    s_mov_b32 s26, 0x240000
    s_mov_b32 s27, 0x20000
    v_lshrrev_b32 v8, 2, v1
    v_mul_u32_u24 v8, 1152, v8
    v_and_b32 v9, 3, v1
    v_lshl_add_u32 v8, v9, 4, v8
    s_mul_i32 s42, s36, 1179648
    s_lshl_b32 s40, s37, 6
    s_add_u32 s42, s42, s40
    s_lshl_b32 s43, s36, 15
    v_lshrrev_b32 v9, 2, v2
    v_lshl_add_u32 v9, v3, 3, v9
    v_lshlrev_b32 v9, 6, v9
    v_and_b32 v10, 3, v2
    v_lshl_or_b32 v9, v10, 4, v9
    v_add_u32 v9, s43, v9
    s_add_u32 m0, s43, 0
    s_add_u32 s40, s42, 0
    buffer_load_dwordx4 v8, s[16:19], s40 offen lds
    s_add_u32 m0, s43, 1024
    s_add_u32 s40, s42, 18432
    buffer_load_dwordx4 v8, s[16:19], s40 offen lds
    s_add_u32 m0, s43, 2048
    s_add_u32 s40, s42, 36864
    buffer_load_dwordx4 v8, s[16:19], s40 offen lds
    s_add_u32 m0, s43, 3072
    s_add_u32 s40, s42, 55296
    buffer_load_dwordx4 v8, s[16:19], s40 offen lds
    s_add_u32 m0, s43, 4096
    s_add_u32 s40, s42, 73728
    buffer_load_dwordx4 v8, s[16:19], s40 offen lds
    s_add_u32 m0, s43, 5120
    s_add_u32 s40, s42, 92160
    buffer_load_dwordx4 v8, s[16:19], s40 offen lds
    s_add_u32 m0, s43, 6144
    s_add_u32 s40, s42, 110592
    buffer_load_dwordx4 v8, s[16:19], s40 offen lds
    s_add_u32 m0, s43, 7168
    s_add_u32 s40, s42, 129024
    buffer_load_dwordx4 v8, s[16:19], s40 offen lds
    s_add_u32 m0, s43, 8192
    s_add_u32 s40, s42, 147456
    buffer_load_dwordx4 v8, s[16:19], s40 offen lds
    s_add_u32 m0, s43, 9216
    s_add_u32 s40, s42, 165888
    buffer_load_dwordx4 v8, s[16:19], s40 offen lds
    s_add_u32 m0, s43, 10240
    s_add_u32 s40, s42, 184320
    buffer_load_dwordx4 v8, s[16:19], s40 offen lds
    s_add_u32 m0, s43, 11264
    s_add_u32 s40, s42, 202752
    buffer_load_dwordx4 v8, s[16:19], s40 offen lds
    s_add_u32 m0, s43, 12288
    s_add_u32 s40, s42, 221184
    buffer_load_dwordx4 v8, s[16:19], s40 offen lds
    s_add_u32 m0, s43, 13312
    s_add_u32 s40, s42, 239616
    buffer_load_dwordx4 v8, s[16:19], s40 offen lds
    s_add_u32 m0, s43, 14336
    s_add_u32 s40, s42, 258048
    buffer_load_dwordx4 v8, s[16:19], s40 offen lds
    s_add_u32 m0, s43, 15360
    s_add_u32 s40, s42, 276480
    buffer_load_dwordx4 v8, s[16:19], s40 offen lds
    s_add_u32 m0, s43, 16384
    s_add_u32 s40, s42, 294912
    buffer_load_dwordx4 v8, s[16:19], s40 offen lds
    s_add_u32 m0, s43, 17408
    s_add_u32 s40, s42, 313344
    buffer_load_dwordx4 v8, s[16:19], s40 offen lds
    s_add_u32 m0, s43, 18432
    s_add_u32 s40, s42, 331776
    buffer_load_dwordx4 v8, s[16:19], s40 offen lds
    s_add_u32 m0, s43, 19456
    s_add_u32 s40, s42, 350208
    buffer_load_dwordx4 v8, s[16:19], s40 offen lds
    s_add_u32 m0, s43, 20480
    s_add_u32 s40, s42, 368640
    buffer_load_dwordx4 v8, s[16:19], s40 offen lds
    s_add_u32 m0, s43, 21504
    s_add_u32 s40, s42, 387072
    buffer_load_dwordx4 v8, s[16:19], s40 offen lds
    s_add_u32 m0, s43, 22528
    s_add_u32 s40, s42, 405504
    buffer_load_dwordx4 v8, s[16:19], s40 offen lds
    s_add_u32 m0, s43, 23552
    s_add_u32 s40, s42, 423936
    buffer_load_dwordx4 v8, s[16:19], s40 offen lds
    s_add_u32 m0, s43, 24576
    s_add_u32 s40, s42, 442368
    buffer_load_dwordx4 v8, s[16:19], s40 offen lds
    s_add_u32 m0, s43, 25600
    s_add_u32 s40, s42, 460800
    buffer_load_dwordx4 v8, s[16:19], s40 offen lds
    s_add_u32 m0, s43, 26624
    s_add_u32 s40, s42, 479232
    buffer_load_dwordx4 v8, s[16:19], s40 offen lds
    s_add_u32 m0, s43, 27648
    s_add_u32 s40, s42, 497664
    buffer_load_dwordx4 v8, s[16:19], s40 offen lds
    s_add_u32 m0, s43, 28672
    s_add_u32 s40, s42, 516096
    buffer_load_dwordx4 v8, s[16:19], s40 offen lds
    s_add_u32 m0, s43, 29696
    s_add_u32 s40, s42, 534528
    buffer_load_dwordx4 v8, s[16:19], s40 offen lds
    s_add_u32 m0, s43, 30720
    s_add_u32 s40, s42, 552960
    buffer_load_dwordx4 v8, s[16:19], s40 offen lds
    s_add_u32 m0, s43, 31744
    s_add_u32 s40, s42, 571392
    buffer_load_dwordx4 v8, s[16:19], s40 offen lds
    s_waitcnt vmcnt(0)
    ds_read_b64_tr_b16 a[0:1], v9 offset:0
    ds_read_b64_tr_b16 a[2:3], v9 offset:256
    ds_read_b64_tr_b16 a[4:5], v9 offset:8
    ds_read_b64_tr_b16 a[6:7], v9 offset:264
    ds_read_b64_tr_b16 a[8:9], v9 offset:2048
    ds_read_b64_tr_b16 a[10:11], v9 offset:2304
    ds_read_b64_tr_b16 a[12:13], v9 offset:2056
    ds_read_b64_tr_b16 a[14:15], v9 offset:2312
    ds_read_b64_tr_b16 a[16:17], v9 offset:4096
    ds_read_b64_tr_b16 a[18:19], v9 offset:4352
    ds_read_b64_tr_b16 a[20:21], v9 offset:4104
    ds_read_b64_tr_b16 a[22:23], v9 offset:4360
    ds_read_b64_tr_b16 a[24:25], v9 offset:6144
    ds_read_b64_tr_b16 a[26:27], v9 offset:6400
    ds_read_b64_tr_b16 a[28:29], v9 offset:6152
    ds_read_b64_tr_b16 a[30:31], v9 offset:6408
    ds_read_b64_tr_b16 a[32:33], v9 offset:8192
    ds_read_b64_tr_b16 a[34:35], v9 offset:8448
    ds_read_b64_tr_b16 a[36:37], v9 offset:8200
    ds_read_b64_tr_b16 a[38:39], v9 offset:8456
    ds_read_b64_tr_b16 a[40:41], v9 offset:10240
    ds_read_b64_tr_b16 a[42:43], v9 offset:10496
    ds_read_b64_tr_b16 a[44:45], v9 offset:10248
    ds_read_b64_tr_b16 a[46:47], v9 offset:10504
    ds_read_b64_tr_b16 a[48:49], v9 offset:12288
    ds_read_b64_tr_b16 a[50:51], v9 offset:12544
    ds_read_b64_tr_b16 a[52:53], v9 offset:12296
    ds_read_b64_tr_b16 a[54:55], v9 offset:12552
    ds_read_b64_tr_b16 a[56:57], v9 offset:14336
    ds_read_b64_tr_b16 a[58:59], v9 offset:14592
    ds_read_b64_tr_b16 a[60:61], v9 offset:14344
    ds_read_b64_tr_b16 a[62:63], v9 offset:14600
    ds_read_b64_tr_b16 a[64:65], v9 offset:16384
    ds_read_b64_tr_b16 a[66:67], v9 offset:16640
    ds_read_b64_tr_b16 a[68:69], v9 offset:16392
    ds_read_b64_tr_b16 a[70:71], v9 offset:16648
    ds_read_b64_tr_b16 a[72:73], v9 offset:18432
    ds_read_b64_tr_b16 a[74:75], v9 offset:18688
    ds_read_b64_tr_b16 a[76:77], v9 offset:18440
    ds_read_b64_tr_b16 a[78:79], v9 offset:18696
    ds_read_b64_tr_b16 a[80:81], v9 offset:20480
    ds_read_b64_tr_b16 a[82:83], v9 offset:20736
    ds_read_b64_tr_b16 a[84:85], v9 offset:20488
    ds_read_b64_tr_b16 a[86:87], v9 offset:20744
    ds_read_b64_tr_b16 a[88:89], v9 offset:22528
    ds_read_b64_tr_b16 a[90:91], v9 offset:22784
    ds_read_b64_tr_b16 a[92:93], v9 offset:22536
    ds_read_b64_tr_b16 a[94:95], v9 offset:22792
    ds_read_b64_tr_b16 a[96:97], v9 offset:24576
    ds_read_b64_tr_b16 a[98:99], v9 offset:24832
    ds_read_b64_tr_b16 a[100:101], v9 offset:24584
    ds_read_b64_tr_b16 a[102:103], v9 offset:24840
    ds_read_b64_tr_b16 a[104:105], v9 offset:26624
    ds_read_b64_tr_b16 a[106:107], v9 offset:26880
    ds_read_b64_tr_b16 a[108:109], v9 offset:26632
    ds_read_b64_tr_b16 a[110:111], v9 offset:26888
    ds_read_b64_tr_b16 a[112:113], v9 offset:28672
    ds_read_b64_tr_b16 a[114:115], v9 offset:28928
    ds_read_b64_tr_b16 a[116:117], v9 offset:28680
    ds_read_b64_tr_b16 a[118:119], v9 offset:28936
    ds_read_b64_tr_b16 a[120:121], v9 offset:30720
    ds_read_b64_tr_b16 a[122:123], v9 offset:30976
    ds_read_b64_tr_b16 a[124:125], v9 offset:30728
    ds_read_b64_tr_b16 a[126:127], v9 offset:30984
    s_waitcnt lgkmcnt(0)
    s_add_u32 m0, s43, 0
    s_add_u32 s40, s42, 589824
    buffer_load_dwordx4 v8, s[16:19], s40 offen lds
    s_add_u32 m0, s43, 1024
    s_add_u32 s40, s42, 608256
    buffer_load_dwordx4 v8, s[16:19], s40 offen lds
    s_add_u32 m0, s43, 2048
    s_add_u32 s40, s42, 626688
    buffer_load_dwordx4 v8, s[16:19], s40 offen lds
    s_add_u32 m0, s43, 3072
    s_add_u32 s40, s42, 645120
    buffer_load_dwordx4 v8, s[16:19], s40 offen lds
    s_add_u32 m0, s43, 4096
    s_add_u32 s40, s42, 663552
    buffer_load_dwordx4 v8, s[16:19], s40 offen lds
    s_add_u32 m0, s43, 5120
    s_add_u32 s40, s42, 681984
    buffer_load_dwordx4 v8, s[16:19], s40 offen lds
    s_add_u32 m0, s43, 6144
    s_add_u32 s40, s42, 700416
    buffer_load_dwordx4 v8, s[16:19], s40 offen lds
    s_add_u32 m0, s43, 7168
    s_add_u32 s40, s42, 718848
    buffer_load_dwordx4 v8, s[16:19], s40 offen lds
    s_add_u32 m0, s43, 8192
    s_add_u32 s40, s42, 737280
    buffer_load_dwordx4 v8, s[16:19], s40 offen lds
    s_add_u32 m0, s43, 9216
    s_add_u32 s40, s42, 755712
    buffer_load_dwordx4 v8, s[16:19], s40 offen lds
    s_add_u32 m0, s43, 10240
    s_add_u32 s40, s42, 774144
    buffer_load_dwordx4 v8, s[16:19], s40 offen lds
    s_add_u32 m0, s43, 11264
    s_add_u32 s40, s42, 792576
    buffer_load_dwordx4 v8, s[16:19], s40 offen lds
    s_add_u32 m0, s43, 12288
    s_add_u32 s40, s42, 811008
    buffer_load_dwordx4 v8, s[16:19], s40 offen lds
    s_add_u32 m0, s43, 13312
    s_add_u32 s40, s42, 829440
    buffer_load_dwordx4 v8, s[16:19], s40 offen lds
    s_add_u32 m0, s43, 14336
    s_add_u32 s40, s42, 847872
    buffer_load_dwordx4 v8, s[16:19], s40 offen lds
    s_add_u32 m0, s43, 15360
    s_add_u32 s40, s42, 866304
    buffer_load_dwordx4 v8, s[16:19], s40 offen lds
    s_add_u32 m0, s43, 16384
    s_add_u32 s40, s42, 884736
    buffer_load_dwordx4 v8, s[16:19], s40 offen lds
    s_add_u32 m0, s43, 17408
    s_add_u32 s40, s42, 903168
    buffer_load_dwordx4 v8, s[16:19], s40 offen lds
    s_add_u32 m0, s43, 18432
    s_add_u32 s40, s42, 921600
    buffer_load_dwordx4 v8, s[16:19], s40 offen lds
    s_add_u32 m0, s43, 19456
    s_add_u32 s40, s42, 940032
    buffer_load_dwordx4 v8, s[16:19], s40 offen lds
    s_add_u32 m0, s43, 20480
    s_add_u32 s40, s42, 958464
    buffer_load_dwordx4 v8, s[16:19], s40 offen lds
    s_add_u32 m0, s43, 21504
    s_add_u32 s40, s42, 976896
    buffer_load_dwordx4 v8, s[16:19], s40 offen lds
    s_add_u32 m0, s43, 22528
    s_add_u32 s40, s42, 995328
    buffer_load_dwordx4 v8, s[16:19], s40 offen lds
    s_add_u32 m0, s43, 23552
    s_add_u32 s40, s42, 1013760
    buffer_load_dwordx4 v8, s[16:19], s40 offen lds
    s_add_u32 m0, s43, 24576
    s_add_u32 s40, s42, 1032192
    buffer_load_dwordx4 v8, s[16:19], s40 offen lds
    s_add_u32 m0, s43, 25600
    s_add_u32 s40, s42, 1050624
    buffer_load_dwordx4 v8, s[16:19], s40 offen lds
    s_add_u32 m0, s43, 26624
    s_add_u32 s40, s42, 1069056
    buffer_load_dwordx4 v8, s[16:19], s40 offen lds
    s_add_u32 m0, s43, 27648
    s_add_u32 s40, s42, 1087488
    buffer_load_dwordx4 v8, s[16:19], s40 offen lds
    s_add_u32 m0, s43, 28672
    s_add_u32 s40, s42, 1105920
    buffer_load_dwordx4 v8, s[16:19], s40 offen lds
    s_add_u32 m0, s43, 29696
    s_add_u32 s40, s42, 1124352
    buffer_load_dwordx4 v8, s[16:19], s40 offen lds
    s_add_u32 m0, s43, 30720
    s_add_u32 s40, s42, 1142784
    buffer_load_dwordx4 v8, s[16:19], s40 offen lds
    s_add_u32 m0, s43, 31744
    s_add_u32 s40, s42, 1161216
    buffer_load_dwordx4 v8, s[16:19], s40 offen lds
    s_waitcnt vmcnt(0)
    ds_read_b64_tr_b16 a[128:129], v9 offset:0
    ds_read_b64_tr_b16 a[130:131], v9 offset:256
    ds_read_b64_tr_b16 a[132:133], v9 offset:8
    ds_read_b64_tr_b16 a[134:135], v9 offset:264
    ds_read_b64_tr_b16 a[136:137], v9 offset:2048
    ds_read_b64_tr_b16 a[138:139], v9 offset:2304
    ds_read_b64_tr_b16 a[140:141], v9 offset:2056
    ds_read_b64_tr_b16 a[142:143], v9 offset:2312
    ds_read_b64_tr_b16 a[144:145], v9 offset:4096
    ds_read_b64_tr_b16 a[146:147], v9 offset:4352
    ds_read_b64_tr_b16 a[148:149], v9 offset:4104
    ds_read_b64_tr_b16 a[150:151], v9 offset:4360
    ds_read_b64_tr_b16 a[152:153], v9 offset:6144
    ds_read_b64_tr_b16 a[154:155], v9 offset:6400
    ds_read_b64_tr_b16 a[156:157], v9 offset:6152
    ds_read_b64_tr_b16 a[158:159], v9 offset:6408
    ds_read_b64_tr_b16 a[160:161], v9 offset:8192
    ds_read_b64_tr_b16 a[162:163], v9 offset:8448
    ds_read_b64_tr_b16 a[164:165], v9 offset:8200
    ds_read_b64_tr_b16 a[166:167], v9 offset:8456
    ds_read_b64_tr_b16 a[168:169], v9 offset:10240
    ds_read_b64_tr_b16 a[170:171], v9 offset:10496
    ds_read_b64_tr_b16 a[172:173], v9 offset:10248
    ds_read_b64_tr_b16 a[174:175], v9 offset:10504
    ds_read_b64_tr_b16 a[176:177], v9 offset:12288
    ds_read_b64_tr_b16 a[178:179], v9 offset:12544
    ds_read_b64_tr_b16 a[180:181], v9 offset:12296
    ds_read_b64_tr_b16 a[182:183], v9 offset:12552
    ds_read_b64_tr_b16 a[184:185], v9 offset:14336
    ds_read_b64_tr_b16 a[186:187], v9 offset:14592
    ds_read_b64_tr_b16 a[188:189], v9 offset:14344
    ds_read_b64_tr_b16 a[190:191], v9 offset:14600
    ds_read_b64_tr_b16 a[192:193], v9 offset:16384
    ds_read_b64_tr_b16 a[194:195], v9 offset:16640
    ds_read_b64_tr_b16 a[196:197], v9 offset:16392
    ds_read_b64_tr_b16 a[198:199], v9 offset:16648
    ds_read_b64_tr_b16 a[200:201], v9 offset:18432
    ds_read_b64_tr_b16 a[202:203], v9 offset:18688
    ds_read_b64_tr_b16 a[204:205], v9 offset:18440
    ds_read_b64_tr_b16 a[206:207], v9 offset:18696
    ds_read_b64_tr_b16 a[208:209], v9 offset:20480
    ds_read_b64_tr_b16 a[210:211], v9 offset:20736
    ds_read_b64_tr_b16 a[212:213], v9 offset:20488
    ds_read_b64_tr_b16 a[214:215], v9 offset:20744
    ds_read_b64_tr_b16 a[216:217], v9 offset:22528
    ds_read_b64_tr_b16 a[218:219], v9 offset:22784
    ds_read_b64_tr_b16 a[220:221], v9 offset:22536
    ds_read_b64_tr_b16 a[222:223], v9 offset:22792
    ds_read_b64_tr_b16 a[224:225], v9 offset:24576
    ds_read_b64_tr_b16 a[226:227], v9 offset:24832
    ds_read_b64_tr_b16 a[228:229], v9 offset:24584
    ds_read_b64_tr_b16 a[230:231], v9 offset:24840
    ds_read_b64_tr_b16 a[232:233], v9 offset:26624
    ds_read_b64_tr_b16 a[234:235], v9 offset:26880
    ds_read_b64_tr_b16 a[236:237], v9 offset:26632
    ds_read_b64_tr_b16 a[238:239], v9 offset:26888
    ds_read_b64_tr_b16 a[240:241], v9 offset:28672
    ds_read_b64_tr_b16 a[242:243], v9 offset:28928
    ds_read_b64_tr_b16 a[244:245], v9 offset:28680
    ds_read_b64_tr_b16 a[246:247], v9 offset:28936
    ds_read_b64_tr_b16 a[248:249], v9 offset:30720
    ds_read_b64_tr_b16 a[250:251], v9 offset:30976
    ds_read_b64_tr_b16 a[252:253], v9 offset:30728
    ds_read_b64_tr_b16 a[254:255], v9 offset:30984
    s_waitcnt lgkmcnt(0)
    s_barrier
    v_lshlrev_b32 v5, 4, v1
    s_lshl_b32 s40, s36, 12
    v_add_u32 v6, s40, v5
    s_and_b32 s40, s36, 1
    s_lshr_b32 s41, s36, 1
    s_lshl_b32 s42, s40, 1
    s_add_u32 s42, s42, s41
    s_lshl_b32 s42, s42, 10
    v_add_u32 v7, s42, v5
    s_lshl_b32 s42, s40, 4
    v_add_u32 v9, s42, v2
    s_lshl_b32 s42, s37, 6
    s_lshl_b32 s43, s41, 3
    s_add_u32 s42, s42, s43
    v_lshlrev_b32 v10, 4, v3
    v_add_u32 v10, s42, v10
    v_mul_u32_u24 v8, 1152, v9
    v_add_u32 v8, v8, v10
    s_mov_b32 s68, 0
WT_32:
    buffer_load_dword v11, off, s[32:35], 0 offset:8 sc1
    s_waitcnt vmcnt(0)
    v_readfirstlane_b32 s70, v11
    s_nop 0
    s_cmp_ge_u32 s70, 1
    s_cbranch_scc1 WTX_33
    s_sleep 2
    s_add_u32 s68, s68, 1
    s_cmp_lt_u32 s68, 0x80000
    s_cbranch_scc1 WT_32
    s_branch L_exit
WTX_33:
    s_mov_b32 s68, 0
WT_34:
    buffer_load_dword v11, off, s[32:35], 0 offset:140 sc1
    s_waitcnt vmcnt(0)
    v_readfirstlane_b32 s70, v11
    s_nop 0
    s_cmp_ge_u32 s70, 8
    s_cbranch_scc1 WTX_35
    s_sleep 16
    s_add_u32 s68, s68, 1
    s_cmp_lt_u32 s68, 0x80000
    s_cbranch_scc1 WT_34
    s_branch L_exit
WTX_35:
    v_lshlrev_b32 v11, 2, v1
    s_mov_b32 s40, 61865984
    buffer_load_dword v11, v11, s[8:11], s40 offen sc1
    s_waitcnt vmcnt(0)
    v_readlane_b32 s48, v11, 0
    v_readlane_b32 s49, v11, 1
    v_readlane_b32 s50, v11, 2
    v_readlane_b32 s51, v11, 3
    v_readlane_b32 s52, v11, 4
    v_readlane_b32 s53, v11, 5
    v_readlane_b32 s54, v11, 6
    v_readlane_b32 s55, v11, 7
WO_loop:
    s_lshl_b32 s40, s38, 18
    s_lshl_b32 s41, s36, 16
    s_add_u32 s46, s40, s41
    s_add_u32 s46, s46, 33554432
    s_lshl_b32 s40, s38, 5
    v_add_u32 v12, s40, v9
    v_lshlrev_b32 v13, 2, v12
    s_mov_b32 s41, 60825600
    buffer_load_dword v13, v13, s[8:11], s41 offen sc1
    s_mul_i32 s47, s38, 36864
    buffer_load_dwordx2 v[14:15], v8, s[12:15], s47 offen
    v_mov_b32 v32, -1
    v_cmp_eq_u32 vcc, s48, v12
    v_mov_b32 v33, 0
    s_nop 0
    v_cndmask_b32 v32, v32, v33, vcc
    v_cmp_eq_u32 vcc, s49, v12
    v_mov_b32 v33, 1152
    s_nop 0
    v_cndmask_b32 v32, v32, v33, vcc
    v_cmp_eq_u32 vcc, s50, v12
    v_mov_b32 v33, 2304
    s_nop 0
    v_cndmask_b32 v32, v32, v33, vcc
    v_cmp_eq_u32 vcc, s51, v12
    v_mov_b32 v33, 3456
    s_nop 0
    v_cndmask_b32 v32, v32, v33, vcc
    v_cmp_eq_u32 vcc, s52, v12
    v_mov_b32 v33, 4608
    s_nop 0
    v_cndmask_b32 v32, v32, v33, vcc
    v_cmp_eq_u32 vcc, s53, v12
    v_mov_b32 v33, 5760
    s_nop 0
    v_cndmask_b32 v32, v32, v33, vcc
    v_cmp_eq_u32 vcc, s54, v12
    v_mov_b32 v33, 6912
    s_nop 0
    v_cndmask_b32 v32, v32, v33, vcc
    v_cmp_eq_u32 vcc, s55, v12
    v_mov_b32 v33, 8064
    s_nop 0
    v_cndmask_b32 v32, v32, v33, vcc
    v_cmp_ne_u32 s[56:57], -1, v32
    v_add_u32 v33, v32, v10
    s_nop 0
    v_cndmask_b32 v33, v10, v33, s[56:57]
    s_mov_b32 s41, 61866048
    buffer_load_dwordx2 v[34:35], v33, s[8:11], s41 offen sc1
    s_lshl_b32 s72, s38, 2
    s_add_u32 s72, s72, 61939712
    s_cmp_lg_u32 s36, 0
    s_cbranch_scc1 WTX_37
    s_mov_b32 s68, 0
    v_and_b32 v37, 31, v1
    v_lshlrev_b32 v37, 8, v37
WT_36:
    buffer_load_dword v36, v37, s[8:11], s72 offen sc1
    s_waitcnt vmcnt(0)
    v_cmp_eq_u32 vcc, 0, v36
    s_cbranch_vccz WTX_37
    s_sleep 3
    s_add_u32 s68, s68, 1
    s_cmp_lt_u32 s68, 0x80000
    s_cbranch_scc1 WT_36
    s_branch L_exit
WTX_37:
    s_barrier
    s_add_u32 s40, s46, 0
    buffer_load_dwordx4 v[64:67], v5, s[8:11], s40 offen offset:0 sc1
    s_add_u32 s40, s46, 4096
    buffer_load_dwordx4 v[68:71], v5, s[8:11], s40 offen offset:0 sc1
    s_add_u32 s40, s46, 0
    buffer_load_dwordx4 v[72:75], v5, s[8:11], s40 offen offset:1024 sc1
    s_add_u32 s40, s46, 4096
    buffer_load_dwordx4 v[76:79], v5, s[8:11], s40 offen offset:1024 sc1
    s_add_u32 s40, s46, 0
    buffer_load_dwordx4 v[80:83], v5, s[8:11], s40 offen offset:2048 sc1
    s_add_u32 s40, s46, 4096
    buffer_load_dwordx4 v[84:87], v5, s[8:11], s40 offen offset:2048 sc1
    s_add_u32 s40, s46, 0
    buffer_load_dwordx4 v[88:91], v5, s[8:11], s40 offen offset:3072 sc1
    s_add_u32 s40, s46, 4096
    buffer_load_dwordx4 v[92:95], v5, s[8:11], s40 offen offset:3072 sc1
    s_add_u32 s40, s46, 8192
    buffer_load_dwordx4 v[96:99], v5, s[8:11], s40 offen offset:0 sc1
    s_add_u32 s40, s46, 12288
    buffer_load_dwordx4 v[100:103], v5, s[8:11], s40 offen offset:0 sc1
    s_add_u32 s40, s46, 8192
    buffer_load_dwordx4 v[104:107], v5, s[8:11], s40 offen offset:1024 sc1
    s_add_u32 s40, s46, 12288
    buffer_load_dwordx4 v[108:111], v5, s[8:11], s40 offen offset:1024 sc1
    s_add_u32 s40, s46, 8192
    buffer_load_dwordx4 v[112:115], v5, s[8:11], s40 offen offset:2048 sc1
    s_add_u32 s40, s46, 12288
    buffer_load_dwordx4 v[116:119], v5, s[8:11], s40 offen offset:2048 sc1
    s_add_u32 s40, s46, 8192
    buffer_load_dwordx4 v[120:123], v5, s[8:11], s40 offen offset:3072 sc1
    s_add_u32 s40, s46, 12288
    buffer_load_dwordx4 v[124:127], v5, s[8:11], s40 offen offset:3072 sc1
    s_add_u32 s40, s46, 16384
    buffer_load_dwordx4 v[128:131], v5, s[8:11], s40 offen offset:0 sc1
    s_add_u32 s40, s46, 20480
    buffer_load_dwordx4 v[132:135], v5, s[8:11], s40 offen offset:0 sc1
    s_add_u32 s40, s46, 16384
    buffer_load_dwordx4 v[136:139], v5, s[8:11], s40 offen offset:1024 sc1
    s_add_u32 s40, s46, 20480
    buffer_load_dwordx4 v[140:143], v5, s[8:11], s40 offen offset:1024 sc1
    s_add_u32 s40, s46, 16384
    buffer_load_dwordx4 v[144:147], v5, s[8:11], s40 offen offset:2048 sc1
    s_add_u32 s40, s46, 20480
    buffer_load_dwordx4 v[148:151], v5, s[8:11], s40 offen offset:2048 sc1
    s_add_u32 s40, s46, 16384
    buffer_load_dwordx4 v[152:155], v5, s[8:11], s40 offen offset:3072 sc1
    s_add_u32 s40, s46, 20480
    buffer_load_dwordx4 v[156:159], v5, s[8:11], s40 offen offset:3072 sc1
    s_add_u32 s40, s46, 24576
    buffer_load_dwordx4 v[160:163], v5, s[8:11], s40 offen offset:0 sc1
    s_add_u32 s40, s46, 28672
    buffer_load_dwordx4 v[164:167], v5, s[8:11], s40 offen offset:0 sc1
    s_add_u32 s40, s46, 24576
    buffer_load_dwordx4 v[168:171], v5, s[8:11], s40 offen offset:1024 sc1
    s_add_u32 s40, s46, 28672
    buffer_load_dwordx4 v[172:175], v5, s[8:11], s40 offen offset:1024 sc1
    s_add_u32 s40, s46, 24576
    buffer_load_dwordx4 v[176:179], v5, s[8:11], s40 offen offset:2048 sc1
    s_add_u32 s40, s46, 28672
    buffer_load_dwordx4 v[180:183], v5, s[8:11], s40 offen offset:2048 sc1
    s_add_u32 s40, s46, 24576
    buffer_load_dwordx4 v[184:187], v5, s[8:11], s40 offen offset:3072 sc1
    s_add_u32 s40, s46, 28672
    buffer_load_dwordx4 v[188:191], v5, s[8:11], s40 offen offset:3072 sc1
    s_add_u32 s40, s46, 32768
    buffer_load_dwordx4 v[192:195], v5, s[8:11], s40 offen offset:0 sc1
    s_add_u32 s40, s46, 36864
    buffer_load_dwordx4 v[196:199], v5, s[8:11], s40 offen offset:0 sc1
    s_add_u32 s40, s46, 32768
    buffer_load_dwordx4 v[200:203], v5, s[8:11], s40 offen offset:1024 sc1
    s_add_u32 s40, s46, 36864
    buffer_load_dwordx4 v[204:207], v5, s[8:11], s40 offen offset:1024 sc1
    s_add_u32 s40, s46, 32768
    buffer_load_dwordx4 v[208:211], v5, s[8:11], s40 offen offset:2048 sc1
    s_add_u32 s40, s46, 36864
    buffer_load_dwordx4 v[212:215], v5, s[8:11], s40 offen offset:2048 sc1
    s_add_u32 s40, s46, 32768
    buffer_load_dwordx4 v[216:219], v5, s[8:11], s40 offen offset:3072 sc1
    s_add_u32 s40, s46, 36864
    buffer_load_dwordx4 v[220:223], v5, s[8:11], s40 offen offset:3072 sc1
    s_add_u32 s40, s46, 40960
    buffer_load_dwordx4 v[224:227], v5, s[8:11], s40 offen offset:0 sc1
    s_add_u32 s40, s46, 45056
    buffer_load_dwordx4 v[228:231], v5, s[8:11], s40 offen offset:0 sc1
    s_add_u32 s40, s46, 40960
    buffer_load_dwordx4 v[232:235], v5, s[8:11], s40 offen offset:1024 sc1
    s_add_u32 s40, s46, 45056
    buffer_load_dwordx4 v[236:239], v5, s[8:11], s40 offen offset:1024 sc1
    s_add_u32 s40, s46, 40960
    buffer_load_dwordx4 v[240:243], v5, s[8:11], s40 offen offset:2048 sc1
    s_add_u32 s40, s46, 45056
    buffer_load_dwordx4 v[244:247], v5, s[8:11], s40 offen offset:2048 sc1
    s_add_u32 s40, s46, 40960
    buffer_load_dwordx4 v[248:251], v5, s[8:11], s40 offen offset:3072 sc1
    s_add_u32 s40, s46, 45056
    buffer_load_dwordx4 v[252:255], v5, s[8:11], s40 offen offset:3072 sc1
    s_waitcnt vmcnt(47)
    v_mfma_f32_16x16x32_bf16 v[16:19], a[0:3], v[64:67], 0
    v_mfma_f32_16x16x32_bf16 v[20:23], a[4:7], v[64:67], 0
    s_add_u32 s40, s46, 49152
    buffer_load_dwordx4 v[64:67], v5, s[8:11], s40 offen offset:0 sc1
    s_waitcnt vmcnt(47)
    v_mfma_f32_16x16x32_bf16 v[24:27], a[0:3], v[68:71], 0
    v_mfma_f32_16x16x32_bf16 v[28:31], a[4:7], v[68:71], 0
    s_add_u32 s40, s46, 53248
    buffer_load_dwordx4 v[68:71], v5, s[8:11], s40 offen offset:0 sc1
    s_waitcnt vmcnt(47)
    v_mfma_f32_16x16x32_bf16 v[16:19], a[8:11], v[72:75], v[16:19]
    v_mfma_f32_16x16x32_bf16 v[20:23], a[12:15], v[72:75], v[20:23]
    s_add_u32 s40, s46, 49152
    buffer_load_dwordx4 v[72:75], v5, s[8:11], s40 offen offset:1024 sc1
    s_waitcnt vmcnt(47)
    v_mfma_f32_16x16x32_bf16 v[24:27], a[8:11], v[76:79], v[24:27]
    v_mfma_f32_16x16x32_bf16 v[28:31], a[12:15], v[76:79], v[28:31]
    s_add_u32 s40, s46, 53248
    buffer_load_dwordx4 v[76:79], v5, s[8:11], s40 offen offset:1024 sc1
    s_waitcnt vmcnt(47)
    v_mfma_f32_16x16x32_bf16 v[16:19], a[16:19], v[80:83], v[16:19]
    v_mfma_f32_16x16x32_bf16 v[20:23], a[20:23], v[80:83], v[20:23]
    s_add_u32 s40, s46, 49152
    buffer_load_dwordx4 v[80:83], v5, s[8:11], s40 offen offset:2048 sc1
    s_waitcnt vmcnt(47)
    v_mfma_f32_16x16x32_bf16 v[24:27], a[16:19], v[84:87], v[24:27]
    v_mfma_f32_16x16x32_bf16 v[28:31], a[20:23], v[84:87], v[28:31]
    s_add_u32 s40, s46, 53248
    buffer_load_dwordx4 v[84:87], v5, s[8:11], s40 offen offset:2048 sc1
    s_waitcnt vmcnt(47)
    v_mfma_f32_16x16x32_bf16 v[16:19], a[24:27], v[88:91], v[16:19]
    v_mfma_f32_16x16x32_bf16 v[20:23], a[28:31], v[88:91], v[20:23]
    s_add_u32 s40, s46, 49152
    buffer_load_dwordx4 v[88:91], v5, s[8:11], s40 offen offset:3072 sc1
    s_waitcnt vmcnt(47)
    v_mfma_f32_16x16x32_bf16 v[24:27], a[24:27], v[92:95], v[24:27]
    v_mfma_f32_16x16x32_bf16 v[28:31], a[28:31], v[92:95], v[28:31]
    s_add_u32 s40, s46, 53248
    buffer_load_dwordx4 v[92:95], v5, s[8:11], s40 offen offset:3072 sc1
    s_waitcnt vmcnt(47)
    v_mfma_f32_16x16x32_bf16 v[16:19], a[32:35], v[96:99], v[16:19]
    v_mfma_f32_16x16x32_bf16 v[20:23], a[36:39], v[96:99], v[20:23]
    s_add_u32 s40, s46, 57344
    buffer_load_dwordx4 v[96:99], v5, s[8:11], s40 offen offset:0 sc1
    s_waitcnt vmcnt(47)
    v_mfma_f32_16x16x32_bf16 v[24:27], a[32:35], v[100:103], v[24:27]
    v_mfma_f32_16x16x32_bf16 v[28:31], a[36:39], v[100:103], v[28:31]
    s_add_u32 s40, s46, 61440
    buffer_load_dwordx4 v[100:103], v5, s[8:11], s40 offen offset:0 sc1
    s_waitcnt vmcnt(47)
    v_mfma_f32_16x16x32_bf16 v[16:19], a[40:43], v[104:107], v[16:19]
    v_mfma_f32_16x16x32_bf16 v[20:23], a[44:47], v[104:107], v[20:23]
    s_add_u32 s40, s46, 57344
    buffer_load_dwordx4 v[104:107], v5, s[8:11], s40 offen offset:1024 sc1
    s_waitcnt vmcnt(47)
    v_mfma_f32_16x16x32_bf16 v[24:27], a[40:43], v[108:111], v[24:27]
    v_mfma_f32_16x16x32_bf16 v[28:31], a[44:47], v[108:111], v[28:31]
    s_add_u32 s40, s46, 61440
    buffer_load_dwordx4 v[108:111], v5, s[8:11], s40 offen offset:1024 sc1
    s_waitcnt vmcnt(47)
    v_mfma_f32_16x16x32_bf16 v[16:19], a[48:51], v[112:115], v[16:19]
    v_mfma_f32_16x16x32_bf16 v[20:23], a[52:55], v[112:115], v[20:23]
    s_add_u32 s40, s46, 57344
    buffer_load_dwordx4 v[112:115], v5, s[8:11], s40 offen offset:2048 sc1
    s_waitcnt vmcnt(47)
    v_mfma_f32_16x16x32_bf16 v[24:27], a[48:51], v[116:119], v[24:27]
    v_mfma_f32_16x16x32_bf16 v[28:31], a[52:55], v[116:119], v[28:31]
    s_add_u32 s40, s46, 61440
    buffer_load_dwordx4 v[116:119], v5, s[8:11], s40 offen offset:2048 sc1
    s_waitcnt vmcnt(47)
    v_mfma_f32_16x16x32_bf16 v[16:19], a[56:59], v[120:123], v[16:19]
    v_mfma_f32_16x16x32_bf16 v[20:23], a[60:63], v[120:123], v[20:23]
    s_add_u32 s40, s46, 57344
    buffer_load_dwordx4 v[120:123], v5, s[8:11], s40 offen offset:3072 sc1
    s_waitcnt vmcnt(47)
    v_mfma_f32_16x16x32_bf16 v[24:27], a[56:59], v[124:127], v[24:27]
    v_mfma_f32_16x16x32_bf16 v[28:31], a[60:63], v[124:127], v[28:31]
    s_add_u32 s40, s46, 61440
    buffer_load_dwordx4 v[124:127], v5, s[8:11], s40 offen offset:3072 sc1
    s_waitcnt vmcnt(47)
    v_mfma_f32_16x16x32_bf16 v[16:19], a[64:67], v[128:131], v[16:19]
    v_mfma_f32_16x16x32_bf16 v[20:23], a[68:71], v[128:131], v[20:23]
    s_waitcnt vmcnt(46)
    v_mfma_f32_16x16x32_bf16 v[24:27], a[64:67], v[132:135], v[24:27]
    v_mfma_f32_16x16x32_bf16 v[28:31], a[68:71], v[132:135], v[28:31]
    s_waitcnt vmcnt(45)
    v_mfma_f32_16x16x32_bf16 v[16:19], a[72:75], v[136:139], v[16:19]
    v_mfma_f32_16x16x32_bf16 v[20:23], a[76:79], v[136:139], v[20:23]
    s_waitcnt vmcnt(44)
    v_mfma_f32_16x16x32_bf16 v[24:27], a[72:75], v[140:143], v[24:27]
    v_mfma_f32_16x16x32_bf16 v[28:31], a[76:79], v[140:143], v[28:31]
    s_waitcnt vmcnt(43)
    v_mfma_f32_16x16x32_bf16 v[16:19], a[80:83], v[144:147], v[16:19]
    v_mfma_f32_16x16x32_bf16 v[20:23], a[84:87], v[144:147], v[20:23]
    s_waitcnt vmcnt(42)
    v_mfma_f32_16x16x32_bf16 v[24:27], a[80:83], v[148:151], v[24:27]
    v_mfma_f32_16x16x32_bf16 v[28:31], a[84:87], v[148:151], v[28:31]
    s_waitcnt vmcnt(41)
    v_mfma_f32_16x16x32_bf16 v[16:19], a[88:91], v[152:155], v[16:19]
    v_mfma_f32_16x16x32_bf16 v[20:23], a[92:95], v[152:155], v[20:23]
    s_waitcnt vmcnt(40)
    v_mfma_f32_16x16x32_bf16 v[24:27], a[88:91], v[156:159], v[24:27]
    v_mfma_f32_16x16x32_bf16 v[28:31], a[92:95], v[156:159], v[28:31]
    s_waitcnt vmcnt(39)
    v_mfma_f32_16x16x32_bf16 v[16:19], a[96:99], v[160:163], v[16:19]
    v_mfma_f32_16x16x32_bf16 v[20:23], a[100:103], v[160:163], v[20:23]
    s_waitcnt vmcnt(38)
    v_mfma_f32_16x16x32_bf16 v[24:27], a[96:99], v[164:167], v[24:27]
    v_mfma_f32_16x16x32_bf16 v[28:31], a[100:103], v[164:167], v[28:31]
    s_waitcnt vmcnt(37)
    v_mfma_f32_16x16x32_bf16 v[16:19], a[104:107], v[168:171], v[16:19]
    v_mfma_f32_16x16x32_bf16 v[20:23], a[108:111], v[168:171], v[20:23]
    s_waitcnt vmcnt(36)
    v_mfma_f32_16x16x32_bf16 v[24:27], a[104:107], v[172:175], v[24:27]
    v_mfma_f32_16x16x32_bf16 v[28:31], a[108:111], v[172:175], v[28:31]
    s_waitcnt vmcnt(35)
    v_mfma_f32_16x16x32_bf16 v[16:19], a[112:115], v[176:179], v[16:19]
    v_mfma_f32_16x16x32_bf16 v[20:23], a[116:119], v[176:179], v[20:23]
    s_waitcnt vmcnt(34)
    v_mfma_f32_16x16x32_bf16 v[24:27], a[112:115], v[180:183], v[24:27]
    v_mfma_f32_16x16x32_bf16 v[28:31], a[116:119], v[180:183], v[28:31]
    s_waitcnt vmcnt(33)
    v_mfma_f32_16x16x32_bf16 v[16:19], a[120:123], v[184:187], v[16:19]
    v_mfma_f32_16x16x32_bf16 v[20:23], a[124:127], v[184:187], v[20:23]
    s_waitcnt vmcnt(32)
    v_mfma_f32_16x16x32_bf16 v[24:27], a[120:123], v[188:191], v[24:27]
    v_mfma_f32_16x16x32_bf16 v[28:31], a[124:127], v[188:191], v[28:31]
    s_waitcnt vmcnt(31)
    v_mfma_f32_16x16x32_bf16 v[16:19], a[128:131], v[192:195], v[16:19]
    v_mfma_f32_16x16x32_bf16 v[20:23], a[132:135], v[192:195], v[20:23]
    s_waitcnt vmcnt(30)
    v_mfma_f32_16x16x32_bf16 v[24:27], a[128:131], v[196:199], v[24:27]
    v_mfma_f32_16x16x32_bf16 v[28:31], a[132:135], v[196:199], v[28:31]
    s_waitcnt vmcnt(29)
    v_mfma_f32_16x16x32_bf16 v[16:19], a[136:139], v[200:203], v[16:19]
    v_mfma_f32_16x16x32_bf16 v[20:23], a[140:143], v[200:203], v[20:23]
    s_waitcnt vmcnt(28)
    v_mfma_f32_16x16x32_bf16 v[24:27], a[136:139], v[204:207], v[24:27]
    v_mfma_f32_16x16x32_bf16 v[28:31], a[140:143], v[204:207], v[28:31]
    s_waitcnt vmcnt(27)
    v_mfma_f32_16x16x32_bf16 v[16:19], a[144:147], v[208:211], v[16:19]
    v_mfma_f32_16x16x32_bf16 v[20:23], a[148:151], v[208:211], v[20:23]
    s_waitcnt vmcnt(26)
    v_mfma_f32_16x16x32_bf16 v[24:27], a[144:147], v[212:215], v[24:27]
    v_mfma_f32_16x16x32_bf16 v[28:31], a[148:151], v[212:215], v[28:31]
    s_waitcnt vmcnt(25)
    v_mfma_f32_16x16x32_bf16 v[16:19], a[152:155], v[216:219], v[16:19]
    v_mfma_f32_16x16x32_bf16 v[20:23], a[156:159], v[216:219], v[20:23]
    s_waitcnt vmcnt(24)
    v_mfma_f32_16x16x32_bf16 v[24:27], a[152:155], v[220:223], v[24:27]
    v_mfma_f32_16x16x32_bf16 v[28:31], a[156:159], v[220:223], v[28:31]
    s_waitcnt vmcnt(23)
    v_mfma_f32_16x16x32_bf16 v[16:19], a[160:163], v[224:227], v[16:19]
    v_mfma_f32_16x16x32_bf16 v[20:23], a[164:167], v[224:227], v[20:23]
    s_waitcnt vmcnt(22)
    v_mfma_f32_16x16x32_bf16 v[24:27], a[160:163], v[228:231], v[24:27]
    v_mfma_f32_16x16x32_bf16 v[28:31], a[164:167], v[228:231], v[28:31]
    s_waitcnt vmcnt(21)
    v_mfma_f32_16x16x32_bf16 v[16:19], a[168:171], v[232:235], v[16:19]
    v_mfma_f32_16x16x32_bf16 v[20:23], a[172:175], v[232:235], v[20:23]
    s_waitcnt vmcnt(20)
    v_mfma_f32_16x16x32_bf16 v[24:27], a[168:171], v[236:239], v[24:27]
    v_mfma_f32_16x16x32_bf16 v[28:31], a[172:175], v[236:239], v[28:31]
    s_waitcnt vmcnt(19)
    v_mfma_f32_16x16x32_bf16 v[16:19], a[176:179], v[240:243], v[16:19]
    v_mfma_f32_16x16x32_bf16 v[20:23], a[180:183], v[240:243], v[20:23]
    s_waitcnt vmcnt(18)
    v_mfma_f32_16x16x32_bf16 v[24:27], a[176:179], v[244:247], v[24:27]
    v_mfma_f32_16x16x32_bf16 v[28:31], a[180:183], v[244:247], v[28:31]
    s_waitcnt vmcnt(17)
    v_mfma_f32_16x16x32_bf16 v[16:19], a[184:187], v[248:251], v[16:19]
    v_mfma_f32_16x16x32_bf16 v[20:23], a[188:191], v[248:251], v[20:23]
    s_waitcnt vmcnt(16)
    v_mfma_f32_16x16x32_bf16 v[24:27], a[184:187], v[252:255], v[24:27]
    v_mfma_f32_16x16x32_bf16 v[28:31], a[188:191], v[252:255], v[28:31]
    s_waitcnt vmcnt(15)
    v_mfma_f32_16x16x32_bf16 v[16:19], a[192:195], v[64:67], v[16:19]
    v_mfma_f32_16x16x32_bf16 v[20:23], a[196:199], v[64:67], v[20:23]
    s_waitcnt vmcnt(14)
    v_mfma_f32_16x16x32_bf16 v[24:27], a[192:195], v[68:71], v[24:27]
    v_mfma_f32_16x16x32_bf16 v[28:31], a[196:199], v[68:71], v[28:31]
    s_waitcnt vmcnt(13)
    v_mfma_f32_16x16x32_bf16 v[16:19], a[200:203], v[72:75], v[16:19]
    v_mfma_f32_16x16x32_bf16 v[20:23], a[204:207], v[72:75], v[20:23]
    s_waitcnt vmcnt(12)
    v_mfma_f32_16x16x32_bf16 v[24:27], a[200:203], v[76:79], v[24:27]
    v_mfma_f32_16x16x32_bf16 v[28:31], a[204:207], v[76:79], v[28:31]
    s_waitcnt vmcnt(11)
    v_mfma_f32_16x16x32_bf16 v[16:19], a[208:211], v[80:83], v[16:19]
    v_mfma_f32_16x16x32_bf16 v[20:23], a[212:215], v[80:83], v[20:23]
    s_waitcnt vmcnt(10)
    v_mfma_f32_16x16x32_bf16 v[24:27], a[208:211], v[84:87], v[24:27]
    v_mfma_f32_16x16x32_bf16 v[28:31], a[212:215], v[84:87], v[28:31]
    s_waitcnt vmcnt(9)
    v_mfma_f32_16x16x32_bf16 v[16:19], a[216:219], v[88:91], v[16:19]
    v_mfma_f32_16x16x32_bf16 v[20:23], a[220:223], v[88:91], v[20:23]
    s_waitcnt vmcnt(8)
    v_mfma_f32_16x16x32_bf16 v[24:27], a[216:219], v[92:95], v[24:27]
    v_mfma_f32_16x16x32_bf16 v[28:31], a[220:223], v[92:95], v[28:31]
    s_waitcnt vmcnt(7)
    v_mfma_f32_16x16x32_bf16 v[16:19], a[224:227], v[96:99], v[16:19]
    v_mfma_f32_16x16x32_bf16 v[20:23], a[228:231], v[96:99], v[20:23]
    s_waitcnt vmcnt(6)
    v_mfma_f32_16x16x32_bf16 v[24:27], a[224:227], v[100:103], v[24:27]
    v_mfma_f32_16x16x32_bf16 v[28:31], a[228:231], v[100:103], v[28:31]
    s_waitcnt vmcnt(5)
    v_mfma_f32_16x16x32_bf16 v[16:19], a[232:235], v[104:107], v[16:19]
    v_mfma_f32_16x16x32_bf16 v[20:23], a[236:239], v[104:107], v[20:23]
    s_waitcnt vmcnt(4)
    v_mfma_f32_16x16x32_bf16 v[24:27], a[232:235], v[108:111], v[24:27]
    v_mfma_f32_16x16x32_bf16 v[28:31], a[236:239], v[108:111], v[28:31]
    s_waitcnt vmcnt(3)
    v_mfma_f32_16x16x32_bf16 v[16:19], a[240:243], v[112:115], v[16:19]
    v_mfma_f32_16x16x32_bf16 v[20:23], a[244:247], v[112:115], v[20:23]
    s_waitcnt vmcnt(2)
    v_mfma_f32_16x16x32_bf16 v[24:27], a[240:243], v[116:119], v[24:27]
    v_mfma_f32_16x16x32_bf16 v[28:31], a[244:247], v[116:119], v[28:31]
    s_waitcnt vmcnt(1)
    v_mfma_f32_16x16x32_bf16 v[16:19], a[248:251], v[120:123], v[16:19]
    v_mfma_f32_16x16x32_bf16 v[20:23], a[252:255], v[120:123], v[20:23]
    s_waitcnt vmcnt(0)
    v_mfma_f32_16x16x32_bf16 v[24:27], a[248:251], v[124:127], v[24:27]
    v_mfma_f32_16x16x32_bf16 v[28:31], a[252:255], v[124:127], v[28:31]
    s_barrier
    s_nop 2
    ds_write_b128 v6, v[16:19] offset:0
    ds_write_b128 v6, v[20:23] offset:1024
    s_nop 0
    ds_write_b128 v6, v[24:27] offset:2048
    ds_write_b128 v6, v[28:31] offset:3072
    s_waitcnt lgkmcnt(0)
    s_barrier
    ds_read_b128 v[16:19], v7 offset:0
    ds_read_b128 v[20:23], v7 offset:4096
    ds_read_b128 v[24:27], v7 offset:8192
    ds_read_b128 v[28:31], v7 offset:12288
    v_cndmask_b32 v14, v14, v34, s[56:57]
    v_cndmask_b32 v15, v15, v35, s[56:57]
    v_sub_f32 v36, 1.0, v13
    v_cvt_pk_bf16_f32 v36, v36, v36
    v_and_b32 v36, 0xffff0000, v36
    v_lshlrev_b32 v40, 16, v14
    v_and_b32 v41, 0xffff0000, v14
    v_lshlrev_b32 v42, 16, v15
    v_and_b32 v43, 0xffff0000, v15
    v_mul_f32 v40, v36, v40
    v_cvt_pk_bf16_f32 v40, v40, v40
    v_and_b32 v40, 0xffff0000, v40
    v_mul_f32 v41, v36, v41
    v_cvt_pk_bf16_f32 v41, v41, v41
    v_and_b32 v41, 0xffff0000, v41
    v_mul_f32 v42, v36, v42
    v_cvt_pk_bf16_f32 v42, v42, v42
    v_and_b32 v42, 0xffff0000, v42
    v_mul_f32 v43, v36, v43
    v_cvt_pk_bf16_f32 v43, v43, v43
    v_and_b32 v43, 0xffff0000, v43
    s_waitcnt lgkmcnt(0)
    v_add_f32 v16, v16, v20
    v_add_f32 v24, v24, v28
    v_add_f32 v16, v16, v24
    v_cvt_pk_bf16_f32 v16, v16, v16
    v_and_b32 v16, 0xffff0000, v16
    v_mul_f32 v16, v13, v16
    v_cvt_pk_bf16_f32 v16, v16, v16
    v_and_b32 v16, 0xffff0000, v16
    v_add_f32 v16, v16, v40
    v_add_f32 v17, v17, v21
    v_add_f32 v25, v25, v29
    v_add_f32 v17, v17, v25
    v_cvt_pk_bf16_f32 v17, v17, v17
    v_and_b32 v17, 0xffff0000, v17
    v_mul_f32 v17, v13, v17
    v_cvt_pk_bf16_f32 v17, v17, v17
    v_and_b32 v17, 0xffff0000, v17
    v_add_f32 v17, v17, v41
    v_add_f32 v18, v18, v22
    v_add_f32 v26, v26, v30
    v_add_f32 v18, v18, v26
    v_cvt_pk_bf16_f32 v18, v18, v18
    v_and_b32 v18, 0xffff0000, v18
    v_mul_f32 v18, v13, v18
    v_cvt_pk_bf16_f32 v18, v18, v18
    v_and_b32 v18, 0xffff0000, v18
    v_add_f32 v18, v18, v42
    v_add_f32 v19, v19, v23
    v_add_f32 v27, v27, v31
    v_add_f32 v19, v19, v27
    v_cvt_pk_bf16_f32 v19, v19, v19
    v_and_b32 v19, 0xffff0000, v19
    v_mul_f32 v19, v13, v19
    v_cvt_pk_bf16_f32 v19, v19, v19
    v_and_b32 v19, 0xffff0000, v19
    v_add_f32 v19, v19, v43
    v_cvt_pk_bf16_f32 v44, v16, v17
    v_cvt_pk_bf16_f32 v45, v18, v19
    buffer_store_dwordx2 v[44:45], v8, s[24:27], s47 offen
    s_add_u32 s38, s38, s39
    s_cmp_lg_u32 s39, 3
    s_cbranch_scc1 WO_nx
    s_cmp_lt_u32 s38, 29
    s_cbranch_scc1 WO_loop
    s_mov_b32 s38, s76
    s_mov_b32 s39, 5
WO_nx:
    s_cmp_lt_u32 s38, s77
    s_cbranch_scc1 WO_loop
    s_waitcnt vmcnt(0)
    s_branch L_exit
L_exit:
    s_endpgm
.section .rodata,"a"
.p2align 6
.amdhsa_kernel gated_mix__memory_aug_recurrent_mem_tr__moe_arch_mod__prompt_kernel
  .amdhsa_next_free_vgpr 512
  .amdhsa_next_free_sgpr 102
  .amdhsa_accum_offset 256
  .amdhsa_group_segment_fixed_size 0
  .amdhsa_kernarg_size 128
  .amdhsa_user_sgpr_count 2
  .amdhsa_user_sgpr_kernarg_segment_ptr 1
  .amdhsa_system_sgpr_workgroup_id_x 1
  .amdhsa_float_denorm_mode_32 3
.end_amdhsa_kernel
```
